```python
import torch

def _softmax(x, axis=-1):
    return torch.softmax(x, dim=axis)
def _gelu(x):
    return torch.nn.functional.gelu(x, approximate="tanh")
def _silu(x):
    return torch.nn.functional.silu(x)
def _sigmoid(x):
    return torch.sigmoid(x)
def _layernorm(x, axis=-1, eps=1e-5):
    m = x.mean(dim=axis, keepdim=True)
    v = x.var(dim=axis, keepdim=True, unbiased=False)
    return (x - m) / torch.sqrt(v + eps)
def _scatter_add(tgt, idx, src, axis=0):
    return tgt.clone().index_add_(axis, idx, src)
def _segment_sum(src, seg, n):
    out = torch.zeros((n,) + src.shape[1:], dtype=src.dtype)
    return out.index_add_(0, seg, src)
def _pad(x, pw):
    flat = tuple(v for pair in reversed(pw) for v in pair)
    return torch.nn.functional.pad(x, flat)

kernel_name = 'parallel_sum__ssm_conv_h3__glu_gated_swiglu__prompt'

def setup_inputs():

    _w = (lambda a: (lambda t: t.to(torch.bfloat16) if t.is_floating_point() else t)(torch.as_tensor(a)))
    def _A_setup():
        B, S, D = 1, 2048, 1024
        ks = 4
        return {
            "q": _w((lambda *s: torch.randn(*s, dtype=torch.bfloat16) * 0.05)(B, S, D)),
            "k": _w((lambda *s: torch.randn(*s, dtype=torch.bfloat16) * 0.2)(B, S, D)),
            "v": _w((lambda *s: torch.randn(*s, dtype=torch.bfloat16) * 0.2)(B, S, D)),
            "shift_k": _w((lambda *s: torch.randn(*s, dtype=torch.bfloat16) * 0.2)(D, ks) * 0.5),
            "ssm_k": _w((lambda *s: torch.randn(*s, dtype=torch.bfloat16) * 0.4)(D, S) * (1.0 / S ** 0.5)),
            "ssm_D": _w((lambda *s: torch.randn(*s, dtype=torch.bfloat16) * 0.2)(D)),
        }
    _A_in = _A_setup()

    def _B_setup():
        B, S, D, F = 1, 2048, 1024, 3584
        return {
            "x": _w((lambda *s: torch.randn(*s, dtype=torch.bfloat16) * 0.05)(B, S, D)),
            "w1": _w((lambda *s: torch.randn(*s, dtype=torch.bfloat16) * 0.2)(D, F) * (2.0 / D) ** 0.5),
            "w3": _w((lambda *s: torch.randn(*s, dtype=torch.bfloat16) * 0.2)(D, F) * (2.0 / D) ** 0.5),
            "w2": _w((lambda *s: torch.randn(*s, dtype=torch.bfloat16) * 0.2)(F, D) * (2.0 / F) ** 0.5),
        }
    _B_in = _B_setup()

    return {
        "A_q": _A_in["q"],
        "A_k": _A_in["k"],
        "A_v": _A_in["v"],
        "A_shift_k": _A_in["shift_k"],
        "A_ssm_k": _A_in["ssm_k"],
        "A_ssm_D": _A_in["ssm_D"],
        "B_x": _B_in["x"],
        "B_w1": _B_in["w1"],
        "B_w3": _B_in["w3"],
        "B_w2": _B_in["w2"],
    }

def reference(A_q, A_k, A_v, A_shift_k, A_ssm_k, A_ssm_D, B_x, B_w1, B_w3, B_w2):
    def _A_ref(q, k, v, shift_k, ssm_k, ssm_D):
        B, S, D = q.shape
        ks = shift_k.shape[-1]
        k_pad = _pad(k, ((0, 0), (ks - 1, 0), (0, 0)))
        k_shift = torch.zeros_like(k)
        for t in range(ks):
            k_shift = k_shift + k_pad[:, t:t + S, :] * shift_k[:, ks - 1 - t][None, None, :]
        kv = k_shift * v
        L = 2 * S
        kv_pad = _pad(kv, ((0, 0), (0, S), (0, 0)))
        kf_pad = _pad(ssm_k, ((0, 0), (0, S)))
        kv_f = (lambda x, axes=(-2,-1): torch.fft.rfft2(x.float(), dim=axes))(kv_pad[:, None, :, :], axes=(1, 2))
        kf_f = (lambda x, axes=(-2,-1): torch.fft.rfft2(x.float(), dim=axes))(kf_pad[:, None, :], axes=(1, 2))
        kf_f = (lambda x, *d: x.permute(*d))(kf_f, 1, 2, 0)
        y_f = kv_f * kf_f[None, :, :, :]
        y = (lambda x, s, axes=(-2,-1): torch.fft.irfft2(x, s=s, dim=axes).to(torch.bfloat16))(y_f, (1, L), axes=(1, 2))[:, 0, :S, :]
        y = y + kv * ssm_D[None, None, :]
        return q * y

    def _B_ref(x, w1, w3, w2):
        gate = torch.einsum("bsd,df->bsf", x, w1)
        up = torch.einsum("bsd,df->bsf", x, w3)
        h = _silu(gate) * up
        out = torch.einsum("bsf,fd->bsd", h, w2)
        return out

    x = A_q
    xn = _layernorm(x, axis=-1)
    return x + _A_ref(xn, A_k, A_v, A_shift_k, A_ssm_k, A_ssm_D) + _B_ref(xn, B_w1, B_w3, B_w2)
```

```asm
; @launch grid=(256,1,1) block=(512,1,1) lds=163840
.amdgcn_target "amdgcn-amd-amdhsa--gfx950"
.text
.globl parallel_sum__ssm_conv_h3__glu_gated_swiglu__prompt_kernel
.p2align 8
.type parallel_sum__ssm_conv_h3__glu_gated_swiglu__prompt_kernel,@function
parallel_sum__ssm_conv_h3__glu_gated_swiglu__prompt_kernel:
s_cmp_ge_u32 s2, 256
s_cbranch_scc1 F_end
s_load_dwordx2 s[4:5], s[0:1], 0
s_load_dwordx4 s[16:19], s[0:1], 56
s_load_dwordx4 s[44:47], s[0:1], 88
s_load_dwordx4 s[52:55], s[0:1], 8
s_load_dwordx2 s[8:9], s[0:1], 24
s_load_dwordx2 s[10:11], s[0:1], 72
v_lshrrev_b32 v1, 6, v0
v_and_b32 v235, 63, v0
v_readfirstlane_b32 s24, v1
v_mov_b32 v2, v235
v_mov_b32 v254, 0
s_and_b32 s3, s2, 7
s_lshr_b32 s29, s2, 3
s_cmp_lg_u32 s24, 7
s_cbranch_scc1 F_nocpf
s_getpc_b64 s[64:65]
F_pcref:
s_sub_u32 s64, s64, F_pcref-parallel_sum__ssm_conv_h3__glu_gated_swiglu__prompt_kernel
s_subb_u32 s65, s65, 0
s_mul_i32 s66, s29, 1536
v_lshlrev_b32 v16, 4, v2
v_add_u32 v16, s66, v16
v_add_u32 v17, 1024, v16
v_min_u32 v16, F_end-parallel_sum__ssm_conv_h3__glu_gated_swiglu__prompt_kernel-16, v16
v_min_u32 v17, F_end-parallel_sum__ssm_conv_h3__glu_gated_swiglu__prompt_kernel-16, v17
global_load_dwordx4 v[220:223], v16, s[64:65]
global_load_dwordx4 v[220:223], v17, s[64:65]
F_nocpf:
s_and_b32 s32, s3, 1
s_lshl_b32 s32, s32, 2
s_and_b32 s33, s29, 3
s_add_u32 s32, s32, s33
s_lshr_b32 s33, s3, 1
s_lshl_b32 s33, s33, 3
s_lshr_b32 s34, s29, 2
s_add_u32 s33, s33, s34
s_and_b32 s35, s24, 3
v_lshrrev_b32 v3, 1, v2
s_lshr_b32 s34, s24, 1
s_and_b32 s34, s34, 1
s_lshl_b32 s34, s34, 2
v_xor_b32 v3, s34, v3
v_mul_u32_u24 v4, 37, v3
v_lshrrev_b32 v4, 8, v4
v_mul_u32_u24 v9, 7, v4
v_sub_u32 v9, v3, v9
s_lshl_b32 s34, s24, 2
v_add_u32 v11, s34, v4
v_mul_u32_u24 v11, 7168, v11
v_lshlrev_b32 v9, 5, v9
v_add_u32 v11, v11, v9
v_and_b32 v9, 1, v2
v_lshlrev_b32 v9, 4, v9
v_add_u32 v11, v11, v9
s_mul_i32 s34, s33, 224
v_add_u32 v11, s34, v11
v_cmp_gt_u32 vcc, 28, v3
v_mov_b32 v12, 0x80000000
v_lshrrev_b32 v3, 3, v2
v_lshlrev_b32 v3, 11, v3
v_cndmask_b32 v226, v12, v11, vcc
v_and_b32 v4, 7, v2
v_lshrrev_b32 v9, 4, v2
v_xor_b32 v11, v4, v9
v_lshlrev_b32 v11, 4, v11
v_add_u32 v224, v3, v11
v_or_b32 v9, 4, v9
v_xor_b32 v11, v4, v9
v_lshlrev_b32 v11, 4, v11
v_add_u32 v11, v3, v11
v_add_u32 v225, 15360, v11
s_lshl_b32 s25, s32, 19
s_lshl_b32 s34, s24, 15
s_add_u32 s25, s25, s34
s_and_b32 s34, s3, 1
s_mul_i32 s26, s34, 3670016
s_lshl_b32 s27, s34, 10
s_lshl_b32 s36, s24, 11
s_lshl_b32 s28, s24, 10
s_and_b32 s34, s32, 3
s_lshr_b32 s30, s24, 2
s_lshl_b32 s30, s30, 1
s_xor_b32 s30, s30, s34
s_cmp_eq_u32 s30, s35
s_cselect_b32 s71, s34, 0xff
s_waitcnt lgkmcnt(0)
s_mov_b32 s40, s4
s_and_b32 s41, s5, 0xffff
s_mov_b32 s42, 4194304
s_mov_b32 s43, 0x20000
s_mov_b32 s12, s46
s_and_b32 s13, s47, 0xffff
s_mov_b32 s14, 67108864
s_mov_b32 s15, 0x20000
s_cmp_lt_u32 s2, 112
s_cselect_b32 s86, 0, 112
s_cselect_b32 s87, 0, 1
s_sub_u32 s86, s2, s86
s_cmp_lt_u32 s86, 56
s_cselect_b32 s72, s16, s18
s_cselect_b32 s73, s17, s19
s_cselect_b32 s85, 0, 56
s_and_b32 s73, s73, 0xffff
s_mov_b32 s74, 7340032
s_mov_b32 s75, 0x20000
s_mov_b32 s20, s18
s_and_b32 s21, s19, 0xffff
s_mov_b32 s22, 7340032
s_mov_b32 s23, 0x20000
s_mov_b32 s16, s16
s_and_b32 s17, s17, 0xffff
s_mov_b32 s18, 7340032
s_mov_b32 s19, 0x20000
s_lshl_b32 s80, s2, 3
s_add_u32 s80, s80, s24
s_lshl_b32 s81, s80, 11
v_lshlrev_b32 v16, 5, v2
buffer_load_dwordx4 v[24:27], v16, s[40:43], s81 offen
buffer_load_dwordx4 v[28:31], v16, s[40:43], s81 offen offset:16
s_mov_b32 s48, s52
s_and_b32 s49, s53, 0xffff
s_mov_b32 s50, 4194304
s_mov_b32 s51, 0x20000
s_mov_b32 s52, s54
s_and_b32 s53, s55, 0xffff
s_mov_b32 s54, 4194304
s_mov_b32 s55, 0x20000
s_mov_b32 s60, s8
s_and_b32 s61, s9, 0xffff
s_mov_b32 s62, 8192
s_mov_b32 s63, 0x20000
s_mov_b32 s76, s10
s_and_b32 s77, s11, 0xffff
s_mov_b32 s78, 7340032
s_mov_b32 s79, 0x20000
v_lshrrev_b32 v18, 4, v2
v_lshlrev_b32 v18, 11, v18
v_and_b32 v19, 15, v2
s_lshl_b32 s82, s29, 17
s_lshl_b32 s83, s3, 8
s_add_u32 s82, s82, s83
s_add_u32 s83, s24, 0
s_lshl_b32 s84, s83, 13
s_add_u32 s84, s84, s82
s_sub_u32 s84, s84, 8192
s_cmp_lt_i32 s84, 0
s_cselect_b32 s84, 0x7f000000, s84
s_lshr_b32 s81, s83, 1
s_and_b32 s81, s81, 7
s_lshl_b32 s81, s81, 1
v_xor_b32 v20, s81, v19
v_lshlrev_b32 v20, 4, v20
v_add_u32 v20, v20, v18
s_lshl_b32 s81, s83, 10
s_add_u32 m0, s81, 65536
s_nop 0
buffer_load_dwordx4 v20, s[48:51], s84 offen lds
s_sub_u32 s81, s83, 1
s_max_i32 s81, s81, 0
s_lshr_b32 s81, s81, 1
s_and_b32 s81, s81, 7
s_lshl_b32 s81, s81, 1
v_xor_b32 v21, s81, v19
v_lshlrev_b32 v21, 4, v21
v_add_u32 v21, v21, v18
s_lshl_b32 s81, s83, 10
s_add_u32 s81, s81, 146432
s_cmp_eq_u32 s83, 0
s_cselect_b32 m0, 82944, s81
s_nop 0
buffer_load_dwordx4 v21, s[52:55], s84 offen lds
s_add_u32 s83, s24, 8
s_lshl_b32 s84, s83, 13
s_add_u32 s84, s84, s82
s_sub_u32 s84, s84, 8192
s_lshr_b32 s81, s83, 1
s_and_b32 s81, s81, 7
s_lshl_b32 s81, s81, 1
v_xor_b32 v20, s81, v19
v_lshlrev_b32 v20, 4, v20
v_add_u32 v20, v20, v18
s_lshl_b32 s81, s83, 10
s_add_u32 m0, s81, 65536
s_nop 0
buffer_load_dwordx4 v20, s[48:51], s84 offen lds
s_sub_u32 s81, s83, 1
s_max_i32 s81, s81, 0
s_lshr_b32 s81, s81, 1
s_and_b32 s81, s81, 7
s_lshl_b32 s81, s81, 1
v_xor_b32 v21, s81, v19
v_lshlrev_b32 v21, 4, v21
v_add_u32 v21, v21, v18
s_lshl_b32 s81, s83, 10
s_add_u32 s81, s81, 146432
s_cmp_eq_u32 s83, 0
s_cselect_b32 m0, 82944, s81
s_nop 0
buffer_load_dwordx4 v21, s[52:55], s84 offen lds
s_cmp_lg_u32 s24, 0
s_cbranch_scc1 F_kvdma_done
s_add_u32 s83, s24, 16
s_lshl_b32 s84, s83, 13
s_add_u32 s84, s84, s82
s_sub_u32 s84, s84, 8192
s_lshr_b32 s81, s83, 1
s_and_b32 s81, s81, 7
s_lshl_b32 s81, s81, 1
v_xor_b32 v20, s81, v19
v_lshlrev_b32 v20, 4, v20
v_add_u32 v20, v20, v18
s_lshl_b32 s81, s83, 10
s_add_u32 m0, s81, 65536
s_nop 0
buffer_load_dwordx4 v20, s[48:51], s84 offen lds
s_sub_u32 s81, s83, 1
s_max_i32 s81, s81, 0
s_lshr_b32 s81, s81, 1
s_and_b32 s81, s81, 7
s_lshl_b32 s81, s81, 1
v_xor_b32 v21, s81, v19
v_lshlrev_b32 v21, 4, v21
v_add_u32 v21, v21, v18
s_lshl_b32 s81, s83, 10
s_add_u32 s81, s81, 146432
s_cmp_eq_u32 s83, 0
s_cselect_b32 m0, 82944, s81
s_nop 0
buffer_load_dwordx4 v21, s[52:55], s84 offen lds
F_kvdma_done:
v_and_b32 v17, 7, v2
v_lshlrev_b32 v17, 1, v17
s_lshl_b32 s82, s3, 7
s_lshl_b32 s83, s24, 4
s_add_u32 s82, s82, s83
v_add_u32 v6, s82, v17
v_lshlrev_b32 v17, 3, v6
buffer_load_dwordx4 v[64:67], v17, s[60:63], 0 offen
s_add_u32 m0, s28, 98304
s_nop 0
buffer_load_dwordx4 v226, s[16:19], s26 offen lds
s_add_u32 m0, s28, 106496
s_nop 0
buffer_load_dwordx4 v226, s[20:23], s26 offen lds
s_add_u32 s26, s26, 229376
s_cmp_ge_u32 s26, 7340032
s_cselect_b32 s31, 7340032, 0
s_sub_u32 s26, s26, s31
s_mov_b32 m0, s36
s_add_u32 s30, s25, 0
s_add_u32 s30, s30, s27
buffer_load_dwordx4 v224, s[40:43], s30 offen lds
buffer_load_dwordx4 v225, s[40:43], s30 offen offset:1024 lds
s_add_u32 m0, s36, 16384
s_add_u32 s30, s25, 262144
s_add_u32 s30, s30, s27
buffer_load_dwordx4 v224, s[40:43], s30 offen lds
buffer_load_dwordx4 v225, s[40:43], s30 offen offset:1024 lds
s_add_u32 s27, s27, 128
s_and_b32 s27, s27, 2047
s_add_u32 s36, s36, 32768
s_cmp_ge_u32 s36, 98304
s_cselect_b32 s31, 98304, 0
s_sub_u32 s36, s36, s31
s_add_u32 m0, s28, 114688
s_nop 0
buffer_load_dwordx4 v226, s[16:19], s26 offen lds
s_add_u32 m0, s28, 122880
s_nop 0
buffer_load_dwordx4 v226, s[20:23], s26 offen lds
s_add_u32 s26, s26, 229376
s_cmp_ge_u32 s26, 7340032
s_cselect_b32 s31, 7340032, 0
s_sub_u32 s26, s26, s31
s_add_u32 m0, s28, 131072
s_nop 0
buffer_load_dwordx4 v226, s[16:19], s26 offen lds
s_add_u32 m0, s28, 139264
s_nop 0
buffer_load_dwordx4 v226, s[20:23], s26 offen lds
s_add_u32 s26, s26, 229376
s_cmp_ge_u32 s26, 7340032
s_cselect_b32 s31, 7340032, 0
s_sub_u32 s26, s26, s31
s_mov_b32 m0, s36
s_add_u32 s30, s25, 0
s_add_u32 s30, s30, s27
buffer_load_dwordx4 v224, s[40:43], s30 offen lds
buffer_load_dwordx4 v225, s[40:43], s30 offen offset:1024 lds
s_add_u32 m0, s36, 16384
s_add_u32 s30, s25, 262144
s_add_u32 s30, s30, s27
buffer_load_dwordx4 v224, s[40:43], s30 offen lds
buffer_load_dwordx4 v225, s[40:43], s30 offen offset:1024 lds
s_add_u32 s27, s27, 128
s_and_b32 s27, s27, 2047
s_add_u32 s36, s36, 32768
s_cmp_ge_u32 s36, 98304
s_cselect_b32 s31, 98304, 0
s_sub_u32 s36, s36, s31
v_and_b32 v3, 15, v2
v_lshrrev_b32 v4, 4, v2
v_lshrrev_b32 v9, 1, v3
v_xor_b32 v9, v9, v4
v_lshlrev_b32 v9, 4, v9
v_lshlrev_b32 v11, 7, v3
v_add_u32 v11, v11, v9
s_lshl_b32 s34, s35, 13
v_add_u32 v227, s34, v11
v_xor_b32 v228, 64, v227
s_mov_b32 s37, 0
v_mov_b32 v229, v227
v_mov_b32 v230, v228
v_bfe_u32 v9, v2, 2, 2
v_and_b32 v11, 3, v2
v_mul_u32_u24 v12, 7, v9
v_and_b32 v13, 1, v4
v_lshlrev_b32 v13, 2, v13
v_lshlrev_b32 v14, 11, v4
v_lshlrev_b32 v11, 3, v11
v_add_u32 v14, v14, v11
v_add_u32 v14, 98304, v14
s_lshr_b32 s34, s24, 2
s_lshl_b32 s34, s34, 2
s_add_u32 s30, s34, 0
v_add_u32 v15, s30, v12
v_xor_b32 v15, v15, v13
v_lshlrev_b32 v15, 5, v15
v_add_u32 v231, v14, v15
s_add_u32 s30, s34, 1
v_add_u32 v15, s30, v12
v_xor_b32 v15, v15, v13
v_lshlrev_b32 v15, 5, v15
v_add_u32 v232, v14, v15
s_add_u32 s30, s34, 2
v_add_u32 v15, s30, v12
v_xor_b32 v15, v15, v13
v_lshlrev_b32 v15, 5, v15
v_add_u32 v233, v14, v15
s_add_u32 s30, s34, 3
v_add_u32 v15, s30, v12
v_xor_b32 v15, v15, v13
v_lshlrev_b32 v15, 5, v15
v_add_u32 v234, v14, v15
s_lshr_b32 s59, s3, 1
s_lshl_b32 s59, s59, 2
s_lshr_b32 s34, s29, 3
s_add_u32 s59, s59, s34
s_and_b32 s70, s3, 1
s_lshl_b32 s70, s70, 3
s_and_b32 s34, s29, 7
s_add_u32 s70, s70, s34
s_lshl_b32 s34, s59, 4
s_add_u32 s70, s70, s34
s_lshl_b32 s70, s70, 7
s_add_u32 s70, s70, 1048576
v_lshrrev_b32 v3, 3, v2
v_and_b32 v4, 7, v2
v_lshlrev_b32 v7, 11, v3
v_lshlrev_b32 v8, 2, v4
v_add_u32 v7, v7, v8
v_xor_b32 v8, s24, v3
v_lshlrev_b32 v8, 5, v8
v_add_u32 v9, v7, v8
v_add_u32 v10, 65536, v9
v_add_u32 v12, 147456, v9
v_add_u32 v8, 1, v3
v_and_b32 v8, 7, v8
v_xor_b32 v8, s24, v8
v_lshlrev_b32 v8, 5, v8
v_add_u32 v11, v7, v8
v_add_u32 v11, 65536, v11
v_subrev_u32 v8, 1, v3
v_and_b32 v8, 7, v8
v_xor_b32 v8, s24, v8
v_lshlrev_b32 v8, 5, v8
v_add_u32 v13, v7, v8
v_add_u32 v13, 147200, v13
s_lshl_b32 s82, s24, 5
s_add_u32 s82, s82, 83712
v_lshlrev_b32 v8, 2, v4
v_add_u32 v8, s82, v8
v_cmp_eq_u32 vcc, 0, v3
s_lshl_b32 s82, s29, 6
v_lshlrev_b32 v5, 3, v3
v_add_u32 v5, s82, v5
v_cndmask_b32 v13, v13, v8, vcc
s_waitcnt vmcnt(14)
s_barrier
s_cmp_lt_u32 s24, 4
s_cbranch_scc1 F_np
s_setprio 1
F_np:
ds_read_b32 v72, v10 offset:0
ds_read_b32 v73, v10 offset:256
ds_read_b32 v74, v10 offset:512
ds_read_b32 v75, v10 offset:768
ds_read_b32 v76, v10 offset:1024
ds_read_b32 v77, v10 offset:1280
ds_read_b32 v78, v10 offset:1536
ds_read_b32 v79, v10 offset:1792
ds_read_b32 v80, v11 offset:2048
ds_read_b32 v81, v11 offset:2304
ds_read_b32 v82, v11 offset:2560
ds_read_b32 v83, v11 offset:2816
ds_read_b32 v84, v13
ds_read_b32 v85, v12 offset:0
ds_read_b32 v86, v12 offset:256
ds_read_b32 v87, v12 offset:512
ds_read_b32 v88, v12 offset:768
ds_read_b32 v89, v12 offset:1024
ds_read_b32 v90, v12 offset:1280
ds_read_b32 v91, v12 offset:1536
ds_read_b32 v92, v12 offset:1792
v_lshlrev_b32 v112, 16, v24
v_and_b32 v113, 0xffff0000, v24
v_lshlrev_b32 v114, 16, v25
v_and_b32 v115, 0xffff0000, v25
v_lshlrev_b32 v116, 16, v26
v_and_b32 v117, 0xffff0000, v26
v_lshlrev_b32 v118, 16, v27
v_and_b32 v119, 0xffff0000, v27
v_lshlrev_b32 v120, 16, v28
v_and_b32 v121, 0xffff0000, v28
v_lshlrev_b32 v122, 16, v29
v_and_b32 v123, 0xffff0000, v29
v_lshlrev_b32 v124, 16, v30
v_and_b32 v125, 0xffff0000, v30
v_lshlrev_b32 v126, 16, v31
v_and_b32 v127, 0xffff0000, v31
v_pk_add_f32 v[128:129], v[112:113], v[114:115]
v_pk_add_f32 v[130:131], v[116:117], v[118:119]
v_pk_add_f32 v[132:133], v[120:121], v[122:123]
v_pk_add_f32 v[134:135], v[124:125], v[126:127]
v_pk_add_f32 v[128:129], v[128:129], v[130:131]
v_pk_add_f32 v[132:133], v[132:133], v[134:135]
v_pk_add_f32 v[128:129], v[128:129], v[132:133]
v_add_f32 v128, v128, v129
s_nop 1
s_waitcnt lgkmcnt(0)
v_lshlrev_b32 v136, 16, v72
v_add_f32_dpp v128, v128, v128 row_shr:1 row_mask:0xf bank_mask:0xf
v_and_b32 v137, 0xffff0000, v72
v_lshlrev_b32 v138, 16, v73
s_nop 1
v_and_b32 v139, 0xffff0000, v73
v_lshlrev_b32 v140, 16, v74
v_add_f32_dpp v128, v128, v128 row_shr:2 row_mask:0xf bank_mask:0xf
v_and_b32 v141, 0xffff0000, v74
v_lshlrev_b32 v142, 16, v75
s_nop 1
v_and_b32 v143, 0xffff0000, v75
v_lshlrev_b32 v144, 16, v76
v_add_f32_dpp v128, v128, v128 row_shr:4 row_mask:0xf bank_mask:0xf
v_and_b32 v145, 0xffff0000, v76
v_lshlrev_b32 v146, 16, v77
s_nop 1
v_and_b32 v147, 0xffff0000, v77
v_lshlrev_b32 v148, 16, v78
v_add_f32_dpp v128, v128, v128 row_shr:8 row_mask:0xf bank_mask:0xf
v_and_b32 v149, 0xffff0000, v78
v_lshlrev_b32 v150, 16, v79
s_nop 1
v_and_b32 v151, 0xffff0000, v79
v_lshlrev_b32 v152, 16, v80
v_add_f32_dpp v128, v128, v128 row_bcast:15 row_mask:0xa bank_mask:0xf
v_and_b32 v153, 0xffff0000, v80
v_lshlrev_b32 v154, 16, v81
s_nop 1
v_and_b32 v155, 0xffff0000, v81
v_lshlrev_b32 v156, 16, v82
v_add_f32_dpp v128, v128, v128 row_bcast:31 row_mask:0xc bank_mask:0xf
v_and_b32 v157, 0xffff0000, v82
v_lshlrev_b32 v158, 16, v83
s_nop 1
v_and_b32 v159, 0xffff0000, v83
v_lshlrev_b32 v160, 16, v84
v_readlane_b32 s30, v128, 63
v_and_b32 v161, 0xffff0000, v84
v_lshlrev_b32 v162, 16, v85
s_nop 1
v_and_b32 v163, 0xffff0000, v85
v_lshlrev_b32 v164, 16, v86
v_mov_b32 v129, s30
v_and_b32 v165, 0xffff0000, v86
v_lshlrev_b32 v166, 16, v87
v_mul_f32 v129, 0x3a800000, v129
v_and_b32 v167, 0xffff0000, v87
v_lshlrev_b32 v168, 16, v88
v_mov_b32 v128, 0
v_and_b32 v169, 0xffff0000, v88
v_lshlrev_b32 v170, 16, v89
v_mov_b32 v130, 0
v_and_b32 v171, 0xffff0000, v89
v_lshlrev_b32 v172, 16, v90
v_sub_f32 v112, v112, v129
v_and_b32 v173, 0xffff0000, v90
v_lshlrev_b32 v174, 16, v91
v_sub_f32 v113, v113, v129
v_and_b32 v175, 0xffff0000, v91
v_lshlrev_b32 v176, 16, v92
v_sub_f32 v114, v114, v129
v_and_b32 v177, 0xffff0000, v92
v_lshlrev_b32 v178, 16, v64
v_sub_f32 v115, v115, v129
v_and_b32 v180, 0xffff0000, v64
v_lshlrev_b32 v182, 16, v65
v_sub_f32 v116, v116, v129
v_and_b32 v184, 0xffff0000, v65
v_lshlrev_b32 v179, 16, v66
v_sub_f32 v117, v117, v129
v_and_b32 v181, 0xffff0000, v66
v_lshlrev_b32 v183, 16, v67
v_sub_f32 v118, v118, v129
v_and_b32 v185, 0xffff0000, v67
v_pk_mul_f32 v[186:187], v[136:137], v[184:185]
v_sub_f32 v119, v119, v129
v_pk_mul_f32 v[188:189], v[138:139], v[184:185]
v_pk_mul_f32 v[190:191], v[140:141], v[184:185]
v_sub_f32 v120, v120, v129
v_pk_mul_f32 v[192:193], v[142:143], v[184:185]
v_pk_mul_f32 v[194:195], v[144:145], v[184:185]
v_sub_f32 v121, v121, v129
v_pk_mul_f32 v[196:197], v[146:147], v[184:185]
v_pk_mul_f32 v[198:199], v[148:149], v[184:185]
v_sub_f32 v122, v122, v129
v_pk_mul_f32 v[200:201], v[150:151], v[184:185]
v_pk_mul_f32 v[202:203], v[152:153], v[184:185]
v_sub_f32 v123, v123, v129
v_pk_fma_f32 v[186:187], v[138:139], v[182:183], v[186:187]
v_pk_fma_f32 v[188:189], v[140:141], v[182:183], v[188:189]
v_sub_f32 v124, v124, v129
v_pk_fma_f32 v[190:191], v[142:143], v[182:183], v[190:191]
v_pk_fma_f32 v[192:193], v[144:145], v[182:183], v[192:193]
v_sub_f32 v125, v125, v129
v_pk_fma_f32 v[194:195], v[146:147], v[182:183], v[194:195]
v_pk_fma_f32 v[196:197], v[148:149], v[182:183], v[196:197]
v_sub_f32 v126, v126, v129
v_pk_fma_f32 v[198:199], v[150:151], v[182:183], v[198:199]
v_pk_fma_f32 v[200:201], v[152:153], v[182:183], v[200:201]
v_sub_f32 v127, v127, v129
v_pk_fma_f32 v[202:203], v[154:155], v[182:183], v[202:203]
v_pk_fma_f32 v[186:187], v[140:141], v[180:181], v[186:187]
v_fmac_f32 v128, v112, v112
v_pk_fma_f32 v[188:189], v[142:143], v[180:181], v[188:189]
v_pk_fma_f32 v[190:191], v[144:145], v[180:181], v[190:191]
v_fmac_f32 v130, v113, v113
v_pk_fma_f32 v[192:193], v[146:147], v[180:181], v[192:193]
v_pk_fma_f32 v[194:195], v[148:149], v[180:181], v[194:195]
v_fmac_f32 v128, v114, v114
v_pk_fma_f32 v[196:197], v[150:151], v[180:181], v[196:197]
v_pk_fma_f32 v[198:199], v[152:153], v[180:181], v[198:199]
v_fmac_f32 v130, v115, v115
v_pk_fma_f32 v[200:201], v[154:155], v[180:181], v[200:201]
v_pk_fma_f32 v[202:203], v[156:157], v[180:181], v[202:203]
v_fmac_f32 v128, v116, v116
v_pk_fma_f32 v[186:187], v[142:143], v[178:179], v[186:187]
v_pk_fma_f32 v[188:189], v[144:145], v[178:179], v[188:189]
v_fmac_f32 v130, v117, v117
v_pk_fma_f32 v[190:191], v[146:147], v[178:179], v[190:191]
v_pk_fma_f32 v[192:193], v[148:149], v[178:179], v[192:193]
v_fmac_f32 v128, v118, v118
v_pk_fma_f32 v[194:195], v[150:151], v[178:179], v[194:195]
v_pk_fma_f32 v[196:197], v[152:153], v[178:179], v[196:197]
v_fmac_f32 v130, v119, v119
v_pk_fma_f32 v[198:199], v[154:155], v[178:179], v[198:199]
v_pk_fma_f32 v[200:201], v[156:157], v[178:179], v[200:201]
v_fmac_f32 v128, v120, v120
v_pk_fma_f32 v[202:203], v[158:159], v[178:179], v[202:203]
v_pk_mul_f32 v[186:187], v[186:187], v[160:161]
v_fmac_f32 v130, v121, v121
v_pk_mul_f32 v[188:189], v[188:189], v[162:163]
v_pk_mul_f32 v[190:191], v[190:191], v[164:165]
v_fmac_f32 v128, v122, v122
v_pk_mul_f32 v[192:193], v[192:193], v[166:167]
v_pk_mul_f32 v[194:195], v[194:195], v[168:169]
v_fmac_f32 v130, v123, v123
v_pk_mul_f32 v[196:197], v[196:197], v[170:171]
v_pk_mul_f32 v[198:199], v[198:199], v[172:173]
v_fmac_f32 v128, v124, v124
v_pk_mul_f32 v[200:201], v[200:201], v[174:175]
v_pk_mul_f32 v[202:203], v[202:203], v[176:177]
v_fmac_f32 v130, v125, v125
v_lshlrev_b32 v9, 12, v6
v_lshlrev_b32 v11, 1, v5
v_fmac_f32 v128, v126, v126
v_sub_u32 v11, 4080, v11
v_add_u32 v9, v9, v11
v_fmac_f32 v130, v127, v127
v_add_u32 v11, 4096, v9
s_mov_b32 s82, 4194304
v_add_f32 v128, v128, v130
s_mov_b32 s83, 8388608
v_cvt_pk_bf16_f32 v204, v202, v200
s_nop 1
v_cvt_pk_bf16_f32 v208, v200, v198
v_cvt_pk_bf16_f32 v205, v198, v196
v_add_f32_dpp v128, v128, v128 row_shr:1 row_mask:0xf bank_mask:0xf
v_cvt_pk_bf16_f32 v209, v196, v194
v_cvt_pk_bf16_f32 v206, v194, v192
s_nop 1
v_cvt_pk_bf16_f32 v210, v192, v190
v_cvt_pk_bf16_f32 v207, v190, v188
v_add_f32_dpp v128, v128, v128 row_shr:2 row_mask:0xf bank_mask:0xf
v_cvt_pk_bf16_f32 v211, v188, v186
buffer_store_dwordx4 v[204:207], v9, s[12:15], s82 offen sc1
s_nop 1
buffer_store_dwordx4 v[208:211], v9, s[12:15], s83 offen sc1
v_cvt_pk_bf16_f32 v212, v203, v201
v_add_f32_dpp v128, v128, v128 row_shr:4 row_mask:0xf bank_mask:0xf
v_cvt_pk_bf16_f32 v216, v201, v199
v_cvt_pk_bf16_f32 v213, v199, v197
s_nop 1
v_cvt_pk_bf16_f32 v217, v197, v195
v_cvt_pk_bf16_f32 v214, v195, v193
v_add_f32_dpp v128, v128, v128 row_shr:8 row_mask:0xf bank_mask:0xf
v_cvt_pk_bf16_f32 v218, v193, v191
v_cvt_pk_bf16_f32 v215, v191, v189
s_nop 1
v_cvt_pk_bf16_f32 v219, v189, v187
buffer_store_dwordx4 v[212:215], v11, s[12:15], s82 offen sc1
v_add_f32_dpp v128, v128, v128 row_bcast:15 row_mask:0xa bank_mask:0xf
buffer_store_dwordx4 v[216:219], v11, s[12:15], s83 offen sc1
s_nop 1
v_add_f32_dpp v128, v128, v128 row_bcast:31 row_mask:0xc bank_mask:0xf
s_nop 1
v_readlane_b32 s30, v128, 63
s_nop 1
v_mov_b32 v130, s30
v_mul_f32 v130, 0x3a800000, v130
v_cvt_pk_bf16_f32 v129, v129, v129
v_lshlrev_b32 v129, 16, v129
v_cvt_pk_bf16_f32 v130, v130, v130
v_lshlrev_b32 v130, 16, v130
v_add_f32 v130, 0x3727c5ac, v130
v_cvt_pk_bf16_f32 v130, v130, v130
v_lshlrev_b32 v130, 16, v130
v_sqrt_f32 v130, v130
s_nop 0
v_cvt_pk_bf16_f32 v130, v130, v130
v_lshlrev_b32 v130, 16, v130
v_rcp_f32 v130, v130
s_lshl_b32 s30, s80, 3
v_mov_b32 v131, 0
v_mov_b32 v132, v129
v_mov_b32 v133, v130
s_mov_b64 s[46:47], exec
s_mov_b64 exec, 1
buffer_store_dwordx2 v[132:133], v131, s[12:15], s30 offen sc1
buffer_store_dword v131, v131, s[12:15], s70 offen sc1
s_add_u32 s31, s70, 32768
buffer_store_dword v131, v131, s[12:15], s31 offen sc1
s_lshl_b32 s31, s2, 7
s_add_u32 s31, s31, 1114112
buffer_store_dword v131, v131, s[12:15], s31 offen sc1
s_mov_b64 exec, 0xfffffff
v_lshlrev_b32 v134, 2, v2
s_mul_i32 s31, s2, 112
s_add_u32 s31, s31, 2097152
buffer_store_dword v131, v134, s[12:15], s31 offen sc1
s_mov_b64 exec, s[46:47]
s_setprio 0
s_waitcnt vmcnt(17)
s_barrier
s_add_u32 m0, s28, 147456
s_nop 0
buffer_load_dwordx4 v226, s[16:19], s26 offen lds
s_add_u32 m0, s28, 155648
s_nop 0
buffer_load_dwordx4 v226, s[20:23], s26 offen lds
s_add_u32 s26, s26, 229376
s_cmp_ge_u32 s26, 7340032
s_cselect_b32 s31, 7340032, 0
s_sub_u32 s26, s26, s31
s_mov_b32 m0, s36
s_add_u32 s30, s25, 0
s_add_u32 s30, s30, s27
buffer_load_dwordx4 v224, s[40:43], s30 offen lds
buffer_load_dwordx4 v225, s[40:43], s30 offen offset:1024 lds
s_add_u32 m0, s36, 16384
s_add_u32 s30, s25, 262144
s_add_u32 s30, s30, s27
buffer_load_dwordx4 v224, s[40:43], s30 offen lds
buffer_load_dwordx4 v225, s[40:43], s30 offen offset:1024 lds
s_add_u32 s27, s27, 128
s_and_b32 s27, s27, 2047
s_add_u32 s36, s36, 32768
s_cmp_ge_u32 s36, 98304
s_cselect_b32 s31, 98304, 0
s_sub_u32 s36, s36, s31
v_mov_b32 v245, 0x3f803f80
v_mov_b32 v236, 0
v_mov_b32 v237, 0
v_mov_b32 v238, 0
v_mov_b32 v239, 0
v_mov_b32 v240, 0
v_mov_b32 v241, 0
v_mov_b32 v242, 0
v_mov_b32 v243, 0
s_cmp_ge_u32 s24, 4
s_cbranch_scc1 F_grpB
ds_read_b64_tr_b16 v[144:145], v231 offset:0
ds_read_b64_tr_b16 v[146:147], v231 offset:1024
ds_read_b64_tr_b16 v[148:149], v232 offset:0
ds_read_b64_tr_b16 v[150:151], v232 offset:1024
ds_read_b64_tr_b16 v[152:153], v233 offset:0
ds_read_b64_tr_b16 v[154:155], v233 offset:1024
ds_read_b64_tr_b16 v[156:157], v234 offset:0
ds_read_b64_tr_b16 v[158:159], v234 offset:1024
ds_read_b64_tr_b16 v[160:161], v231 offset:8192
ds_read_b64_tr_b16 v[162:163], v231 offset:9216
ds_read_b64_tr_b16 v[164:165], v232 offset:8192
ds_read_b64_tr_b16 v[166:167], v232 offset:9216
ds_read_b64_tr_b16 v[168:169], v233 offset:8192
ds_read_b64_tr_b16 v[170:171], v233 offset:9216
ds_read_b64_tr_b16 v[172:173], v234 offset:8192
ds_read_b64_tr_b16 v[174:175], v234 offset:9216
ds_read_b128 v[128:131], v229 offset:0
ds_read_b128 v[132:135], v229 offset:2048
ds_read_b128 v[136:139], v229 offset:4096
ds_read_b128 v[140:143], v229 offset:6144
s_mov_b32 s39, 0
s_waitcnt vmcnt(21) lgkmcnt(0)
s_barrier
s_cmp_lg_u32 s71, s39
s_cbranch_scc1 G1cs_0_0
v_dot2c_f32_bf16 v236, v144, v245
v_dot2c_f32_bf16 v237, v148, v245
v_dot2c_f32_bf16 v238, v152, v245
v_dot2c_f32_bf16 v239, v156, v245
v_dot2c_f32_bf16 v240, v160, v245
v_dot2c_f32_bf16 v241, v164, v245
v_dot2c_f32_bf16 v242, v168, v245
v_dot2c_f32_bf16 v243, v172, v245
v_dot2c_f32_bf16 v236, v145, v245
v_dot2c_f32_bf16 v237, v149, v245
v_dot2c_f32_bf16 v238, v153, v245
v_dot2c_f32_bf16 v239, v157, v245
v_dot2c_f32_bf16 v240, v161, v245
v_dot2c_f32_bf16 v241, v165, v245
v_dot2c_f32_bf16 v242, v169, v245
v_dot2c_f32_bf16 v243, v173, v245
v_dot2c_f32_bf16 v236, v146, v245
v_dot2c_f32_bf16 v237, v150, v245
v_dot2c_f32_bf16 v238, v154, v245
v_dot2c_f32_bf16 v239, v158, v245
v_dot2c_f32_bf16 v240, v162, v245
v_dot2c_f32_bf16 v241, v166, v245
v_dot2c_f32_bf16 v242, v170, v245
v_dot2c_f32_bf16 v243, v174, v245
v_dot2c_f32_bf16 v236, v147, v245
v_dot2c_f32_bf16 v237, v151, v245
v_dot2c_f32_bf16 v238, v155, v245
v_dot2c_f32_bf16 v239, v159, v245
v_dot2c_f32_bf16 v240, v163, v245
v_dot2c_f32_bf16 v241, v167, v245
v_dot2c_f32_bf16 v242, v171, v245
v_dot2c_f32_bf16 v243, v175, v245
G1cs_0_0:
v_mfma_f32_16x16x32_bf16 v[0:3], v[144:147], v[128:131], 0
v_mfma_f32_16x16x32_bf16 v[4:7], v[148:151], v[128:131], 0
ds_read_b64_tr_b16 v[192:193], v231 offset:16384
v_mfma_f32_16x16x32_bf16 v[8:11], v[152:155], v[128:131], 0
ds_read_b64_tr_b16 v[194:195], v231 offset:17408
v_mfma_f32_16x16x32_bf16 v[12:15], v[156:159], v[128:131], 0
ds_read_b64_tr_b16 v[196:197], v232 offset:16384
v_mfma_f32_16x16x32_bf16 v[16:19], v[160:163], v[128:131], 0
ds_read_b64_tr_b16 v[198:199], v232 offset:17408
v_mfma_f32_16x16x32_bf16 v[20:23], v[164:167], v[128:131], 0
ds_read_b64_tr_b16 v[200:201], v233 offset:16384
v_mfma_f32_16x16x32_bf16 v[24:27], v[168:171], v[128:131], 0
ds_read_b64_tr_b16 v[202:203], v233 offset:17408
v_mfma_f32_16x16x32_bf16 v[28:31], v[172:175], v[128:131], 0
ds_read_b64_tr_b16 v[204:205], v234 offset:16384
v_mfma_f32_16x16x32_bf16 v[32:35], v[144:147], v[132:135], 0
ds_read_b64_tr_b16 v[206:207], v234 offset:17408
v_mfma_f32_16x16x32_bf16 v[36:39], v[148:151], v[132:135], 0
ds_read_b64_tr_b16 v[208:209], v231 offset:24576
v_mfma_f32_16x16x32_bf16 v[40:43], v[152:155], v[132:135], 0
ds_read_b64_tr_b16 v[210:211], v231 offset:25600
v_mfma_f32_16x16x32_bf16 v[44:47], v[156:159], v[132:135], 0
ds_read_b64_tr_b16 v[212:213], v232 offset:24576
v_mfma_f32_16x16x32_bf16 v[48:51], v[160:163], v[132:135], 0
ds_read_b64_tr_b16 v[214:215], v232 offset:25600
v_mfma_f32_16x16x32_bf16 v[52:55], v[164:167], v[132:135], 0
ds_read_b64_tr_b16 v[216:217], v233 offset:24576
v_mfma_f32_16x16x32_bf16 v[56:59], v[168:171], v[132:135], 0
ds_read_b64_tr_b16 v[218:219], v233 offset:25600
v_mfma_f32_16x16x32_bf16 v[60:63], v[172:175], v[132:135], 0
ds_read_b64_tr_b16 v[220:221], v234 offset:24576
v_mfma_f32_16x16x32_bf16 v[64:67], v[144:147], v[136:139], 0
ds_read_b64_tr_b16 v[222:223], v234 offset:25600
s_add_u32 m0, s28, 98304
s_nop 0
buffer_load_dwordx4 v226, s[16:19], s26 offen lds
v_mfma_f32_16x16x32_bf16 v[68:71], v[148:151], v[136:139], 0
ds_read_b128 v[176:179], v230 offset:0
v_mfma_f32_16x16x32_bf16 v[72:75], v[152:155], v[136:139], 0
ds_read_b128 v[180:183], v230 offset:2048
v_mfma_f32_16x16x32_bf16 v[76:79], v[156:159], v[136:139], 0
ds_read_b128 v[184:187], v230 offset:4096
v_mfma_f32_16x16x32_bf16 v[80:83], v[160:163], v[136:139], 0
ds_read_b128 v[188:191], v230 offset:6144
s_add_u32 m0, s28, 106496
s_nop 0
buffer_load_dwordx4 v226, s[20:23], s26 offen lds
s_add_u32 s26, s26, 229376
s_cmp_ge_u32 s26, 7340032
s_cselect_b32 s31, 7340032, 0
s_sub_u32 s26, s26, s31
v_mfma_f32_16x16x32_bf16 v[84:87], v[164:167], v[136:139], 0
v_mfma_f32_16x16x32_bf16 v[88:91], v[168:171], v[136:139], 0
v_mfma_f32_16x16x32_bf16 v[92:95], v[172:175], v[136:139], 0
v_mfma_f32_16x16x32_bf16 v[96:99], v[144:147], v[140:143], 0
v_mfma_f32_16x16x32_bf16 v[100:103], v[148:151], v[140:143], 0
v_mfma_f32_16x16x32_bf16 v[104:107], v[152:155], v[140:143], 0
v_mfma_f32_16x16x32_bf16 v[108:111], v[156:159], v[140:143], 0
v_mfma_f32_16x16x32_bf16 v[112:115], v[160:163], v[140:143], 0
v_mfma_f32_16x16x32_bf16 v[116:119], v[164:167], v[140:143], 0
v_mfma_f32_16x16x32_bf16 v[120:123], v[168:171], v[140:143], 0
v_mfma_f32_16x16x32_bf16 v[124:127], v[172:175], v[140:143], 0
s_waitcnt vmcnt(17) lgkmcnt(0)
s_barrier
s_cmp_lg_u32 s71, s39
s_cbranch_scc1 G1cs_0_1
v_dot2c_f32_bf16 v236, v192, v245
v_dot2c_f32_bf16 v237, v196, v245
v_dot2c_f32_bf16 v238, v200, v245
v_dot2c_f32_bf16 v239, v204, v245
v_dot2c_f32_bf16 v240, v208, v245
v_dot2c_f32_bf16 v241, v212, v245
v_dot2c_f32_bf16 v242, v216, v245
v_dot2c_f32_bf16 v243, v220, v245
v_dot2c_f32_bf16 v236, v193, v245
v_dot2c_f32_bf16 v237, v197, v245
v_dot2c_f32_bf16 v238, v201, v245
v_dot2c_f32_bf16 v239, v205, v245
v_dot2c_f32_bf16 v240, v209, v245
v_dot2c_f32_bf16 v241, v213, v245
v_dot2c_f32_bf16 v242, v217, v245
v_dot2c_f32_bf16 v243, v221, v245
v_dot2c_f32_bf16 v236, v194, v245
v_dot2c_f32_bf16 v237, v198, v245
v_dot2c_f32_bf16 v238, v202, v245
v_dot2c_f32_bf16 v239, v206, v245
v_dot2c_f32_bf16 v240, v210, v245
v_dot2c_f32_bf16 v241, v214, v245
v_dot2c_f32_bf16 v242, v218, v245
v_dot2c_f32_bf16 v243, v222, v245
v_dot2c_f32_bf16 v236, v195, v245
v_dot2c_f32_bf16 v237, v199, v245
v_dot2c_f32_bf16 v238, v203, v245
v_dot2c_f32_bf16 v239, v207, v245
v_dot2c_f32_bf16 v240, v211, v245
v_dot2c_f32_bf16 v241, v215, v245
v_dot2c_f32_bf16 v242, v219, v245
v_dot2c_f32_bf16 v243, v223, v245
G1cs_0_1:
v_mfma_f32_16x16x32_bf16 v[0:3], v[192:195], v[176:179], v[0:3]
s_add_u32 s37, s37, 32768
s_cmp_ge_u32 s37, 98304
s_cselect_b32 s31, 98304, 0
s_sub_u32 s37, s37, s31
v_add_u32 v229, s37, v227
v_add_u32 v230, s37, v228
v_mfma_f32_16x16x32_bf16 v[4:7], v[196:199], v[176:179], v[4:7]
ds_read_b64_tr_b16 v[144:145], v231 offset:32768
v_mfma_f32_16x16x32_bf16 v[8:11], v[200:203], v[176:179], v[8:11]
ds_read_b64_tr_b16 v[146:147], v231 offset:33792
v_mfma_f32_16x16x32_bf16 v[12:15], v[204:207], v[176:179], v[12:15]
ds_read_b64_tr_b16 v[148:149], v232 offset:32768
v_mfma_f32_16x16x32_bf16 v[16:19], v[208:211], v[176:179], v[16:19]
ds_read_b64_tr_b16 v[150:151], v232 offset:33792
v_mfma_f32_16x16x32_bf16 v[20:23], v[212:215], v[176:179], v[20:23]
ds_read_b64_tr_b16 v[152:153], v233 offset:32768
v_mfma_f32_16x16x32_bf16 v[24:27], v[216:219], v[176:179], v[24:27]
ds_read_b64_tr_b16 v[154:155], v233 offset:33792
v_mfma_f32_16x16x32_bf16 v[28:31], v[220:223], v[176:179], v[28:31]
ds_read_b64_tr_b16 v[156:157], v234 offset:32768
v_mfma_f32_16x16x32_bf16 v[32:35], v[192:195], v[180:183], v[32:35]
ds_read_b64_tr_b16 v[158:159], v234 offset:33792
v_mfma_f32_16x16x32_bf16 v[36:39], v[196:199], v[180:183], v[36:39]
ds_read_b64_tr_b16 v[160:161], v231 offset:40960
v_mfma_f32_16x16x32_bf16 v[40:43], v[200:203], v[180:183], v[40:43]
ds_read_b64_tr_b16 v[162:163], v231 offset:41984
v_mfma_f32_16x16x32_bf16 v[44:47], v[204:207], v[180:183], v[44:47]
ds_read_b64_tr_b16 v[164:165], v232 offset:40960
v_mfma_f32_16x16x32_bf16 v[48:51], v[208:211], v[180:183], v[48:51]
ds_read_b64_tr_b16 v[166:167], v232 offset:41984
v_mfma_f32_16x16x32_bf16 v[52:55], v[212:215], v[180:183], v[52:55]
ds_read_b64_tr_b16 v[168:169], v233 offset:40960
v_mfma_f32_16x16x32_bf16 v[56:59], v[216:219], v[180:183], v[56:59]
ds_read_b64_tr_b16 v[170:171], v233 offset:41984
v_mfma_f32_16x16x32_bf16 v[60:63], v[220:223], v[180:183], v[60:63]
ds_read_b64_tr_b16 v[172:173], v234 offset:40960
v_mfma_f32_16x16x32_bf16 v[64:67], v[192:195], v[184:187], v[64:67]
ds_read_b64_tr_b16 v[174:175], v234 offset:41984
s_add_u32 m0, s28, 114688
s_nop 0
buffer_load_dwordx4 v226, s[16:19], s26 offen lds
v_mfma_f32_16x16x32_bf16 v[68:71], v[196:199], v[184:187], v[68:71]
ds_read_b128 v[128:131], v229 offset:0
v_mfma_f32_16x16x32_bf16 v[72:75], v[200:203], v[184:187], v[72:75]
ds_read_b128 v[132:135], v229 offset:2048
v_mfma_f32_16x16x32_bf16 v[76:79], v[204:207], v[184:187], v[76:79]
ds_read_b128 v[136:139], v229 offset:4096
v_mfma_f32_16x16x32_bf16 v[80:83], v[208:211], v[184:187], v[80:83]
ds_read_b128 v[140:143], v229 offset:6144
s_add_u32 m0, s28, 122880
s_nop 0
buffer_load_dwordx4 v226, s[20:23], s26 offen lds
s_add_u32 s26, s26, 229376
s_cmp_ge_u32 s26, 7340032
s_cselect_b32 s31, 7340032, 0
s_sub_u32 s26, s26, s31
v_mfma_f32_16x16x32_bf16 v[84:87], v[212:215], v[184:187], v[84:87]
v_mfma_f32_16x16x32_bf16 v[88:91], v[216:219], v[184:187], v[88:91]
v_mfma_f32_16x16x32_bf16 v[92:95], v[220:223], v[184:187], v[92:95]
v_mfma_f32_16x16x32_bf16 v[96:99], v[192:195], v[188:191], v[96:99]
s_mov_b32 m0, s36
s_add_u32 s30, s25, 0
s_add_u32 s30, s30, s27
buffer_load_dwordx4 v224, s[40:43], s30 offen lds
v_mfma_f32_16x16x32_bf16 v[100:103], v[196:199], v[188:191], v[100:103]
v_mfma_f32_16x16x32_bf16 v[104:107], v[200:203], v[188:191], v[104:107]
v_mfma_f32_16x16x32_bf16 v[108:111], v[204:207], v[188:191], v[108:111]
v_mfma_f32_16x16x32_bf16 v[112:115], v[208:211], v[188:191], v[112:115]
buffer_load_dwordx4 v225, s[40:43], s30 offen offset:1024 lds
v_mfma_f32_16x16x32_bf16 v[116:119], v[212:215], v[188:191], v[116:119]
v_mfma_f32_16x16x32_bf16 v[120:123], v[216:219], v[188:191], v[120:123]
v_mfma_f32_16x16x32_bf16 v[124:127], v[220:223], v[188:191], v[124:127]
s_waitcnt vmcnt(10) lgkmcnt(0)
s_barrier
s_cmp_lg_u32 s71, s39
s_cbranch_scc1 G1cs_0_2
v_dot2c_f32_bf16 v236, v144, v245
v_dot2c_f32_bf16 v237, v148, v245
v_dot2c_f32_bf16 v238, v152, v245
v_dot2c_f32_bf16 v239, v156, v245
v_dot2c_f32_bf16 v240, v160, v245
v_dot2c_f32_bf16 v241, v164, v245
v_dot2c_f32_bf16 v242, v168, v245
v_dot2c_f32_bf16 v243, v172, v245
v_dot2c_f32_bf16 v236, v145, v245
v_dot2c_f32_bf16 v237, v149, v245
v_dot2c_f32_bf16 v238, v153, v245
v_dot2c_f32_bf16 v239, v157, v245
v_dot2c_f32_bf16 v240, v161, v245
v_dot2c_f32_bf16 v241, v165, v245
v_dot2c_f32_bf16 v242, v169, v245
v_dot2c_f32_bf16 v243, v173, v245
v_dot2c_f32_bf16 v236, v146, v245
v_dot2c_f32_bf16 v237, v150, v245
v_dot2c_f32_bf16 v238, v154, v245
v_dot2c_f32_bf16 v239, v158, v245
v_dot2c_f32_bf16 v240, v162, v245
v_dot2c_f32_bf16 v241, v166, v245
v_dot2c_f32_bf16 v242, v170, v245
v_dot2c_f32_bf16 v243, v174, v245
v_dot2c_f32_bf16 v236, v147, v245
v_dot2c_f32_bf16 v237, v151, v245
v_dot2c_f32_bf16 v238, v155, v245
v_dot2c_f32_bf16 v239, v159, v245
v_dot2c_f32_bf16 v240, v163, v245
v_dot2c_f32_bf16 v241, v167, v245
v_dot2c_f32_bf16 v242, v171, v245
v_dot2c_f32_bf16 v243, v175, v245
G1cs_0_2:
v_mfma_f32_16x16x32_bf16 v[0:3], v[144:147], v[128:131], v[0:3]
v_mfma_f32_16x16x32_bf16 v[4:7], v[148:151], v[128:131], v[4:7]
ds_read_b64_tr_b16 v[192:193], v231 offset:49152
v_mfma_f32_16x16x32_bf16 v[8:11], v[152:155], v[128:131], v[8:11]
ds_read_b64_tr_b16 v[194:195], v231 offset:50176
v_mfma_f32_16x16x32_bf16 v[12:15], v[156:159], v[128:131], v[12:15]
ds_read_b64_tr_b16 v[196:197], v232 offset:49152
v_mfma_f32_16x16x32_bf16 v[16:19], v[160:163], v[128:131], v[16:19]
ds_read_b64_tr_b16 v[198:199], v232 offset:50176
v_mfma_f32_16x16x32_bf16 v[20:23], v[164:167], v[128:131], v[20:23]
ds_read_b64_tr_b16 v[200:201], v233 offset:49152
v_mfma_f32_16x16x32_bf16 v[24:27], v[168:171], v[128:131], v[24:27]
ds_read_b64_tr_b16 v[202:203], v233 offset:50176
v_mfma_f32_16x16x32_bf16 v[28:31], v[172:175], v[128:131], v[28:31]
ds_read_b64_tr_b16 v[204:205], v234 offset:49152
v_mfma_f32_16x16x32_bf16 v[32:35], v[144:147], v[132:135], v[32:35]
ds_read_b64_tr_b16 v[206:207], v234 offset:50176
v_mfma_f32_16x16x32_bf16 v[36:39], v[148:151], v[132:135], v[36:39]
ds_read_b64_tr_b16 v[208:209], v231 offset:57344
v_mfma_f32_16x16x32_bf16 v[40:43], v[152:155], v[132:135], v[40:43]
ds_read_b64_tr_b16 v[210:211], v231 offset:58368
v_mfma_f32_16x16x32_bf16 v[44:47], v[156:159], v[132:135], v[44:47]
ds_read_b64_tr_b16 v[212:213], v232 offset:57344
v_mfma_f32_16x16x32_bf16 v[48:51], v[160:163], v[132:135], v[48:51]
ds_read_b64_tr_b16 v[214:215], v232 offset:58368
v_mfma_f32_16x16x32_bf16 v[52:55], v[164:167], v[132:135], v[52:55]
ds_read_b64_tr_b16 v[216:217], v233 offset:57344
v_mfma_f32_16x16x32_bf16 v[56:59], v[168:171], v[132:135], v[56:59]
ds_read_b64_tr_b16 v[218:219], v233 offset:58368
v_mfma_f32_16x16x32_bf16 v[60:63], v[172:175], v[132:135], v[60:63]
ds_read_b64_tr_b16 v[220:221], v234 offset:57344
v_mfma_f32_16x16x32_bf16 v[64:67], v[144:147], v[136:139], v[64:67]
ds_read_b64_tr_b16 v[222:223], v234 offset:58368
s_add_u32 m0, s28, 131072
s_nop 0
buffer_load_dwordx4 v226, s[16:19], s26 offen lds
v_mfma_f32_16x16x32_bf16 v[68:71], v[148:151], v[136:139], v[68:71]
ds_read_b128 v[176:179], v230 offset:0
v_mfma_f32_16x16x32_bf16 v[72:75], v[152:155], v[136:139], v[72:75]
ds_read_b128 v[180:183], v230 offset:2048
v_mfma_f32_16x16x32_bf16 v[76:79], v[156:159], v[136:139], v[76:79]
ds_read_b128 v[184:187], v230 offset:4096
v_mfma_f32_16x16x32_bf16 v[80:83], v[160:163], v[136:139], v[80:83]
ds_read_b128 v[188:191], v230 offset:6144
s_add_u32 m0, s28, 139264
s_nop 0
buffer_load_dwordx4 v226, s[20:23], s26 offen lds
s_add_u32 s26, s26, 229376
s_cmp_ge_u32 s26, 7340032
s_cselect_b32 s31, 7340032, 0
s_sub_u32 s26, s26, s31
v_mfma_f32_16x16x32_bf16 v[84:87], v[164:167], v[136:139], v[84:87]
v_mfma_f32_16x16x32_bf16 v[88:91], v[168:171], v[136:139], v[88:91]
v_mfma_f32_16x16x32_bf16 v[92:95], v[172:175], v[136:139], v[92:95]
v_mfma_f32_16x16x32_bf16 v[96:99], v[144:147], v[140:143], v[96:99]
s_add_u32 m0, s36, 16384
s_add_u32 s30, s25, 262144
s_add_u32 s30, s30, s27
buffer_load_dwordx4 v224, s[40:43], s30 offen lds
v_mfma_f32_16x16x32_bf16 v[100:103], v[148:151], v[140:143], v[100:103]
v_mfma_f32_16x16x32_bf16 v[104:107], v[152:155], v[140:143], v[104:107]
v_mfma_f32_16x16x32_bf16 v[108:111], v[156:159], v[140:143], v[108:111]
v_mfma_f32_16x16x32_bf16 v[112:115], v[160:163], v[140:143], v[112:115]
buffer_load_dwordx4 v225, s[40:43], s30 offen offset:1024 lds
s_add_u32 s27, s27, 128
s_and_b32 s27, s27, 2047
s_add_u32 s36, s36, 32768
s_cmp_ge_u32 s36, 98304
s_cselect_b32 s31, 98304, 0
s_sub_u32 s36, s36, s31
v_mfma_f32_16x16x32_bf16 v[116:119], v[164:167], v[140:143], v[116:119]
v_mfma_f32_16x16x32_bf16 v[120:123], v[168:171], v[140:143], v[120:123]
v_mfma_f32_16x16x32_bf16 v[124:127], v[172:175], v[140:143], v[124:127]
s_waitcnt vmcnt(8) lgkmcnt(0)
s_barrier
s_cmp_lg_u32 s24, 0
s_cbranch_scc1 SIG_1
v_mov_b32 v254, 0
v_mov_b32 v255, 1
s_mov_b64 s[46:47], exec
s_mov_b64 exec, 1
global_atomic_add v254, v255, s[44:45] sc1
s_mov_b64 exec, s[46:47]
SIG_1:
s_cmp_lg_u32 s71, s39
s_cbranch_scc1 G1cs_0_3
v_dot2c_f32_bf16 v236, v192, v245
v_dot2c_f32_bf16 v237, v196, v245
v_dot2c_f32_bf16 v238, v200, v245
v_dot2c_f32_bf16 v239, v204, v245
v_dot2c_f32_bf16 v240, v208, v245
v_dot2c_f32_bf16 v241, v212, v245
v_dot2c_f32_bf16 v242, v216, v245
v_dot2c_f32_bf16 v243, v220, v245
v_dot2c_f32_bf16 v236, v193, v245
v_dot2c_f32_bf16 v237, v197, v245
v_dot2c_f32_bf16 v238, v201, v245
v_dot2c_f32_bf16 v239, v205, v245
v_dot2c_f32_bf16 v240, v209, v245
v_dot2c_f32_bf16 v241, v213, v245
v_dot2c_f32_bf16 v242, v217, v245
v_dot2c_f32_bf16 v243, v221, v245
v_dot2c_f32_bf16 v236, v194, v245
v_dot2c_f32_bf16 v237, v198, v245
v_dot2c_f32_bf16 v238, v202, v245
v_dot2c_f32_bf16 v239, v206, v245
v_dot2c_f32_bf16 v240, v210, v245
v_dot2c_f32_bf16 v241, v214, v245
v_dot2c_f32_bf16 v242, v218, v245
v_dot2c_f32_bf16 v243, v222, v245
v_dot2c_f32_bf16 v236, v195, v245
v_dot2c_f32_bf16 v237, v199, v245
v_dot2c_f32_bf16 v238, v203, v245
v_dot2c_f32_bf16 v239, v207, v245
v_dot2c_f32_bf16 v240, v211, v245
v_dot2c_f32_bf16 v241, v215, v245
v_dot2c_f32_bf16 v242, v219, v245
v_dot2c_f32_bf16 v243, v223, v245
G1cs_0_3:
v_mfma_f32_16x16x32_bf16 v[0:3], v[192:195], v[176:179], v[0:3]
s_add_u32 s37, s37, 32768
s_cmp_ge_u32 s37, 98304
s_cselect_b32 s31, 98304, 0
s_sub_u32 s37, s37, s31
v_add_u32 v229, s37, v227
v_add_u32 v230, s37, v228
v_mfma_f32_16x16x32_bf16 v[4:7], v[196:199], v[176:179], v[4:7]
ds_read_b64_tr_b16 v[144:145], v231 offset:0
v_mfma_f32_16x16x32_bf16 v[8:11], v[200:203], v[176:179], v[8:11]
ds_read_b64_tr_b16 v[146:147], v231 offset:1024
v_mfma_f32_16x16x32_bf16 v[12:15], v[204:207], v[176:179], v[12:15]
ds_read_b64_tr_b16 v[148:149], v232 offset:0
v_mfma_f32_16x16x32_bf16 v[16:19], v[208:211], v[176:179], v[16:19]
ds_read_b64_tr_b16 v[150:151], v232 offset:1024
v_mfma_f32_16x16x32_bf16 v[20:23], v[212:215], v[176:179], v[20:23]
ds_read_b64_tr_b16 v[152:153], v233 offset:0
v_mfma_f32_16x16x32_bf16 v[24:27], v[216:219], v[176:179], v[24:27]
ds_read_b64_tr_b16 v[154:155], v233 offset:1024
v_mfma_f32_16x16x32_bf16 v[28:31], v[220:223], v[176:179], v[28:31]
ds_read_b64_tr_b16 v[156:157], v234 offset:0
v_mfma_f32_16x16x32_bf16 v[32:35], v[192:195], v[180:183], v[32:35]
ds_read_b64_tr_b16 v[158:159], v234 offset:1024
v_mfma_f32_16x16x32_bf16 v[36:39], v[196:199], v[180:183], v[36:39]
ds_read_b64_tr_b16 v[160:161], v231 offset:8192
v_mfma_f32_16x16x32_bf16 v[40:43], v[200:203], v[180:183], v[40:43]
ds_read_b64_tr_b16 v[162:163], v231 offset:9216
v_mfma_f32_16x16x32_bf16 v[44:47], v[204:207], v[180:183], v[44:47]
ds_read_b64_tr_b16 v[164:165], v232 offset:8192
v_mfma_f32_16x16x32_bf16 v[48:51], v[208:211], v[180:183], v[48:51]
ds_read_b64_tr_b16 v[166:167], v232 offset:9216
v_mfma_f32_16x16x32_bf16 v[52:55], v[212:215], v[180:183], v[52:55]
ds_read_b64_tr_b16 v[168:169], v233 offset:8192
v_mfma_f32_16x16x32_bf16 v[56:59], v[216:219], v[180:183], v[56:59]
ds_read_b64_tr_b16 v[170:171], v233 offset:9216
v_mfma_f32_16x16x32_bf16 v[60:63], v[220:223], v[180:183], v[60:63]
ds_read_b64_tr_b16 v[172:173], v234 offset:8192
v_mfma_f32_16x16x32_bf16 v[64:67], v[192:195], v[184:187], v[64:67]
ds_read_b64_tr_b16 v[174:175], v234 offset:9216
s_add_u32 m0, s28, 147456
s_nop 0
buffer_load_dwordx4 v226, s[16:19], s26 offen lds
v_mfma_f32_16x16x32_bf16 v[68:71], v[196:199], v[184:187], v[68:71]
ds_read_b128 v[128:131], v229 offset:0
v_mfma_f32_16x16x32_bf16 v[72:75], v[200:203], v[184:187], v[72:75]
ds_read_b128 v[132:135], v229 offset:2048
v_mfma_f32_16x16x32_bf16 v[76:79], v[204:207], v[184:187], v[76:79]
ds_read_b128 v[136:139], v229 offset:4096
v_mfma_f32_16x16x32_bf16 v[80:83], v[208:211], v[184:187], v[80:83]
ds_read_b128 v[140:143], v229 offset:6144
s_add_u32 m0, s28, 155648
s_nop 0
buffer_load_dwordx4 v226, s[20:23], s26 offen lds
s_add_u32 s26, s26, 229376
s_cmp_ge_u32 s26, 7340032
s_cselect_b32 s31, 7340032, 0
s_sub_u32 s26, s26, s31
v_mfma_f32_16x16x32_bf16 v[84:87], v[212:215], v[184:187], v[84:87]
v_mfma_f32_16x16x32_bf16 v[88:91], v[216:219], v[184:187], v[88:91]
v_mfma_f32_16x16x32_bf16 v[92:95], v[220:223], v[184:187], v[92:95]
v_mfma_f32_16x16x32_bf16 v[96:99], v[192:195], v[188:191], v[96:99]
s_mov_b32 m0, s36
s_add_u32 s30, s25, 0
s_add_u32 s30, s30, s27
buffer_load_dwordx4 v224, s[40:43], s30 offen lds
v_mfma_f32_16x16x32_bf16 v[100:103], v[196:199], v[188:191], v[100:103]
v_mfma_f32_16x16x32_bf16 v[104:107], v[200:203], v[188:191], v[104:107]
v_mfma_f32_16x16x32_bf16 v[108:111], v[204:207], v[188:191], v[108:111]
v_mfma_f32_16x16x32_bf16 v[112:115], v[208:211], v[188:191], v[112:115]
buffer_load_dwordx4 v225, s[40:43], s30 offen offset:1024 lds
v_mfma_f32_16x16x32_bf16 v[116:119], v[212:215], v[188:191], v[116:119]
v_mfma_f32_16x16x32_bf16 v[120:123], v[216:219], v[188:191], v[120:123]
v_mfma_f32_16x16x32_bf16 v[124:127], v[220:223], v[188:191], v[124:127]
s_mov_b32 s39, 1
G1L0_loop:
s_waitcnt vmcnt(10) lgkmcnt(0)
s_barrier
s_cmp_lg_u32 s39, 2
s_cbranch_scc1 EVps_0_4
s_cmp_lg_u32 s24, 0
s_cbranch_scc1 PI_2
v_mov_b32 v254, 0
global_load_dword v255, v254, s[44:45] sc1
PI_2:
EVps_0_4:
s_cmp_lg_u32 s39, 3
s_cbranch_scc1 EVpc_0_4
s_cmp_lg_u32 s24, 0
s_cbranch_scc1 PC_3_done
s_mov_b32 s48, 0
PC_3_chk:
v_readfirstlane_b32 s49, v255
s_add_u32 s48, s48, 1
s_cmp_ge_u32 s49, 256
s_cbranch_scc1 PC_3_done
s_cmp_ge_u32 s48, 0x40000
s_cbranch_scc1 PC_3_done
s_sleep 4
global_load_dword v255, v254, s[44:45] sc1
s_waitcnt vmcnt(0)
s_branch PC_3_chk
PC_3_done:
EVpc_0_4:
s_cmp_lg_u32 s39, 4
s_cbranch_scc1 EVcs_0_4
s_cmp_eq_u32 s71, 0xff
s_cbranch_scc1 EVcs_0_4
v_mov_b32 v244, v236
s_nop 1
v_permlane16_swap_b32 v244, v236
s_nop 1
v_add_f32 v236, v236, v244
v_mov_b32 v244, v236
s_nop 1
v_permlane32_swap_b32 v244, v236
s_nop 1
v_add_f32 v236, v236, v244
v_mov_b32 v244, v237
s_nop 1
v_permlane16_swap_b32 v244, v237
s_nop 1
v_add_f32 v237, v237, v244
v_mov_b32 v244, v237
s_nop 1
v_permlane32_swap_b32 v244, v237
s_nop 1
v_add_f32 v237, v237, v244
v_mov_b32 v244, v238
s_nop 1
v_permlane16_swap_b32 v244, v238
s_nop 1
v_add_f32 v238, v238, v244
v_mov_b32 v244, v238
s_nop 1
v_permlane32_swap_b32 v244, v238
s_nop 1
v_add_f32 v238, v238, v244
v_mov_b32 v244, v239
s_nop 1
v_permlane16_swap_b32 v244, v239
s_nop 1
v_add_f32 v239, v239, v244
v_mov_b32 v244, v239
s_nop 1
v_permlane32_swap_b32 v244, v239
s_nop 1
v_add_f32 v239, v239, v244
v_mov_b32 v244, v240
s_nop 1
v_permlane16_swap_b32 v244, v240
s_nop 1
v_add_f32 v240, v240, v244
v_mov_b32 v244, v240
s_nop 1
v_permlane32_swap_b32 v244, v240
s_nop 1
v_add_f32 v240, v240, v244
v_mov_b32 v244, v241
s_nop 1
v_permlane16_swap_b32 v244, v241
s_nop 1
v_add_f32 v241, v241, v244
v_mov_b32 v244, v241
s_nop 1
v_permlane32_swap_b32 v244, v241
s_nop 1
v_add_f32 v241, v241, v244
v_mov_b32 v244, v242
s_nop 1
v_permlane16_swap_b32 v244, v242
s_nop 1
v_add_f32 v242, v242, v244
v_mov_b32 v244, v242
s_nop 1
v_permlane32_swap_b32 v244, v242
s_nop 1
v_add_f32 v242, v242, v244
v_mov_b32 v244, v243
s_nop 1
v_permlane16_swap_b32 v244, v243
s_nop 1
v_add_f32 v243, v243, v244
v_mov_b32 v244, v243
s_nop 1
v_permlane32_swap_b32 v244, v243
s_nop 1
v_add_f32 v243, v243, v244
v_lshlrev_b32 v244, 2, v235
s_mul_i32 s82, s33, 112
s_add_u32 s82, s82, 0
s_lshl_b32 s82, s82, 2
s_add_u32 s82, s82, 2097152
s_mov_b64 s[46:47], exec
s_mov_b64 exec, 0xffff
s_add_u32 s83, s82, 0
buffer_atomic_add_f32 v236, v244, s[12:15], s83 offen sc1
s_add_u32 s83, s82, 64
buffer_atomic_add_f32 v237, v244, s[12:15], s83 offen sc1
s_add_u32 s83, s82, 128
buffer_atomic_add_f32 v238, v244, s[12:15], s83 offen sc1
s_add_u32 s83, s82, 192
buffer_atomic_add_f32 v239, v244, s[12:15], s83 offen sc1
s_add_u32 s83, s82, 14336
buffer_atomic_add_f32 v240, v244, s[12:15], s83 offen sc1
s_add_u32 s83, s82, 14400
buffer_atomic_add_f32 v241, v244, s[12:15], s83 offen sc1
s_add_u32 s83, s82, 14464
buffer_atomic_add_f32 v242, v244, s[12:15], s83 offen sc1
s_add_u32 s83, s82, 14528
buffer_atomic_add_f32 v243, v244, s[12:15], s83 offen sc1
s_mov_b64 exec, s[46:47]
EVcs_0_4:
s_cmp_lg_u32 s39, 5
s_cbranch_scc1 EVsp_0_4
s_cmp_lg_u32 s24, 0
s_cbranch_scc1 EVsp_0_4
v_and_b32 v236, 31, v235
v_and_b32 v237, 7, v236
v_lshlrev_b32 v237, 2, v237
s_lshr_b32 s82, s2, 5
s_and_b32 s83, s82, 3
v_or_b32 v237, s83, v237
v_lshlrev_b32 v237, 3, v237
v_lshrrev_b32 v238, 3, v236
v_lshlrev_b32 v238, 1, v238
s_lshr_b32 s83, s82, 2
v_or_b32 v238, s83, v238
v_add_u32 v237, v237, v238
s_lshl_b32 s83, s3, 5
v_add_u32 v238, s83, v236
v_cmp_gt_u32 vcc, 32, v235
v_mov_b32 v239, 1
s_nop 0
v_cndmask_b32 v237, v238, v237, vcc
v_lshlrev_b32 v237, 7, v237
s_mov_b32 s82, 1114112
buffer_atomic_add v239, v237, s[12:15], s82 offen sc1
v_and_b32 v236, 7, v235
v_and_b32 v238, 3, v236
s_and_b32 s83, s33, 7
s_lshl_b32 s83, s83, 2
v_or_b32 v238, s83, v238
v_lshlrev_b32 v238, 3, v238
v_lshrrev_b32 v240, 2, v236
s_lshr_b32 s83, s33, 3
s_lshl_b32 s83, s83, 1
v_or_b32 v240, s83, v240
v_add_u32 v238, v238, v240
v_lshlrev_b32 v238, 7, v238
s_mov_b64 s[46:47], exec
s_mov_b64 exec, 0xff
buffer_atomic_add v239, v238, s[12:15], s82 offen sc1
s_mov_b64 exec, s[46:47]
EVsp_0_4:
s_cmp_lg_u32 s71, s39
s_cbranch_scc1 G1cs_0_4
v_dot2c_f32_bf16 v236, v144, v245
v_dot2c_f32_bf16 v237, v148, v245
v_dot2c_f32_bf16 v238, v152, v245
v_dot2c_f32_bf16 v239, v156, v245
v_dot2c_f32_bf16 v240, v160, v245
v_dot2c_f32_bf16 v241, v164, v245
v_dot2c_f32_bf16 v242, v168, v245
v_dot2c_f32_bf16 v243, v172, v245
v_dot2c_f32_bf16 v236, v145, v245
v_dot2c_f32_bf16 v237, v149, v245
v_dot2c_f32_bf16 v238, v153, v245
v_dot2c_f32_bf16 v239, v157, v245
v_dot2c_f32_bf16 v240, v161, v245
v_dot2c_f32_bf16 v241, v165, v245
v_dot2c_f32_bf16 v242, v169, v245
v_dot2c_f32_bf16 v243, v173, v245
v_dot2c_f32_bf16 v236, v146, v245
v_dot2c_f32_bf16 v237, v150, v245
v_dot2c_f32_bf16 v238, v154, v245
v_dot2c_f32_bf16 v239, v158, v245
v_dot2c_f32_bf16 v240, v162, v245
v_dot2c_f32_bf16 v241, v166, v245
v_dot2c_f32_bf16 v242, v170, v245
v_dot2c_f32_bf16 v243, v174, v245
v_dot2c_f32_bf16 v236, v147, v245
v_dot2c_f32_bf16 v237, v151, v245
v_dot2c_f32_bf16 v238, v155, v245
v_dot2c_f32_bf16 v239, v159, v245
v_dot2c_f32_bf16 v240, v163, v245
v_dot2c_f32_bf16 v241, v167, v245
v_dot2c_f32_bf16 v242, v171, v245
v_dot2c_f32_bf16 v243, v175, v245
G1cs_0_4:
v_mfma_f32_16x16x32_bf16 v[0:3], v[144:147], v[128:131], v[0:3]
v_mfma_f32_16x16x32_bf16 v[4:7], v[148:151], v[128:131], v[4:7]
ds_read_b64_tr_b16 v[192:193], v231 offset:16384
v_mfma_f32_16x16x32_bf16 v[8:11], v[152:155], v[128:131], v[8:11]
ds_read_b64_tr_b16 v[194:195], v231 offset:17408
v_mfma_f32_16x16x32_bf16 v[12:15], v[156:159], v[128:131], v[12:15]
ds_read_b64_tr_b16 v[196:197], v232 offset:16384
v_mfma_f32_16x16x32_bf16 v[16:19], v[160:163], v[128:131], v[16:19]
ds_read_b64_tr_b16 v[198:199], v232 offset:17408
v_mfma_f32_16x16x32_bf16 v[20:23], v[164:167], v[128:131], v[20:23]
ds_read_b64_tr_b16 v[200:201], v233 offset:16384
v_mfma_f32_16x16x32_bf16 v[24:27], v[168:171], v[128:131], v[24:27]
ds_read_b64_tr_b16 v[202:203], v233 offset:17408
v_mfma_f32_16x16x32_bf16 v[28:31], v[172:175], v[128:131], v[28:31]
ds_read_b64_tr_b16 v[204:205], v234 offset:16384
v_mfma_f32_16x16x32_bf16 v[32:35], v[144:147], v[132:135], v[32:35]
ds_read_b64_tr_b16 v[206:207], v234 offset:17408
v_mfma_f32_16x16x32_bf16 v[36:39], v[148:151], v[132:135], v[36:39]
ds_read_b64_tr_b16 v[208:209], v231 offset:24576
v_mfma_f32_16x16x32_bf16 v[40:43], v[152:155], v[132:135], v[40:43]
ds_read_b64_tr_b16 v[210:211], v231 offset:25600
v_mfma_f32_16x16x32_bf16 v[44:47], v[156:159], v[132:135], v[44:47]
ds_read_b64_tr_b16 v[212:213], v232 offset:24576
v_mfma_f32_16x16x32_bf16 v[48:51], v[160:163], v[132:135], v[48:51]
ds_read_b64_tr_b16 v[214:215], v232 offset:25600
v_mfma_f32_16x16x32_bf16 v[52:55], v[164:167], v[132:135], v[52:55]
ds_read_b64_tr_b16 v[216:217], v233 offset:24576
v_mfma_f32_16x16x32_bf16 v[56:59], v[168:171], v[132:135], v[56:59]
ds_read_b64_tr_b16 v[218:219], v233 offset:25600
v_mfma_f32_16x16x32_bf16 v[60:63], v[172:175], v[132:135], v[60:63]
ds_read_b64_tr_b16 v[220:221], v234 offset:24576
v_mfma_f32_16x16x32_bf16 v[64:67], v[144:147], v[136:139], v[64:67]
ds_read_b64_tr_b16 v[222:223], v234 offset:25600
s_add_u32 m0, s28, 98304
s_nop 0
buffer_load_dwordx4 v226, s[16:19], s26 offen lds
v_mfma_f32_16x16x32_bf16 v[68:71], v[148:151], v[136:139], v[68:71]
ds_read_b128 v[176:179], v230 offset:0
v_mfma_f32_16x16x32_bf16 v[72:75], v[152:155], v[136:139], v[72:75]
ds_read_b128 v[180:183], v230 offset:2048
v_mfma_f32_16x16x32_bf16 v[76:79], v[156:159], v[136:139], v[76:79]
ds_read_b128 v[184:187], v230 offset:4096
v_mfma_f32_16x16x32_bf16 v[80:83], v[160:163], v[136:139], v[80:83]
ds_read_b128 v[188:191], v230 offset:6144
s_add_u32 m0, s28, 106496
s_nop 0
buffer_load_dwordx4 v226, s[20:23], s26 offen lds
s_add_u32 s26, s26, 229376
s_cmp_ge_u32 s26, 7340032
s_cselect_b32 s31, 7340032, 0
s_sub_u32 s26, s26, s31
v_mfma_f32_16x16x32_bf16 v[84:87], v[164:167], v[136:139], v[84:87]
v_mfma_f32_16x16x32_bf16 v[88:91], v[168:171], v[136:139], v[88:91]
v_mfma_f32_16x16x32_bf16 v[92:95], v[172:175], v[136:139], v[92:95]
v_mfma_f32_16x16x32_bf16 v[96:99], v[144:147], v[140:143], v[96:99]
s_add_u32 m0, s36, 16384
s_add_u32 s30, s25, 262144
s_add_u32 s30, s30, s27
buffer_load_dwordx4 v224, s[40:43], s30 offen lds
v_mfma_f32_16x16x32_bf16 v[100:103], v[148:151], v[140:143], v[100:103]
v_mfma_f32_16x16x32_bf16 v[104:107], v[152:155], v[140:143], v[104:107]
v_mfma_f32_16x16x32_bf16 v[108:111], v[156:159], v[140:143], v[108:111]
v_mfma_f32_16x16x32_bf16 v[112:115], v[160:163], v[140:143], v[112:115]
buffer_load_dwordx4 v225, s[40:43], s30 offen offset:1024 lds
s_add_u32 s27, s27, 128
s_and_b32 s27, s27, 2047
s_add_u32 s36, s36, 32768
s_cmp_ge_u32 s36, 98304
s_cselect_b32 s31, 98304, 0
s_sub_u32 s36, s36, s31
v_mfma_f32_16x16x32_bf16 v[116:119], v[164:167], v[140:143], v[116:119]
v_mfma_f32_16x16x32_bf16 v[120:123], v[168:171], v[140:143], v[120:123]
v_mfma_f32_16x16x32_bf16 v[124:127], v[172:175], v[140:143], v[124:127]
s_waitcnt vmcnt(8) lgkmcnt(0)
s_barrier
s_cmp_lg_u32 s71, s39
s_cbranch_scc1 G1cs_0_5
v_dot2c_f32_bf16 v236, v192, v245
v_dot2c_f32_bf16 v237, v196, v245
v_dot2c_f32_bf16 v238, v200, v245
v_dot2c_f32_bf16 v239, v204, v245
v_dot2c_f32_bf16 v240, v208, v245
v_dot2c_f32_bf16 v241, v212, v245
v_dot2c_f32_bf16 v242, v216, v245
v_dot2c_f32_bf16 v243, v220, v245
v_dot2c_f32_bf16 v236, v193, v245
v_dot2c_f32_bf16 v237, v197, v245
v_dot2c_f32_bf16 v238, v201, v245
v_dot2c_f32_bf16 v239, v205, v245
v_dot2c_f32_bf16 v240, v209, v245
v_dot2c_f32_bf16 v241, v213, v245
v_dot2c_f32_bf16 v242, v217, v245
v_dot2c_f32_bf16 v243, v221, v245
v_dot2c_f32_bf16 v236, v194, v245
v_dot2c_f32_bf16 v237, v198, v245
v_dot2c_f32_bf16 v238, v202, v245
v_dot2c_f32_bf16 v239, v206, v245
v_dot2c_f32_bf16 v240, v210, v245
v_dot2c_f32_bf16 v241, v214, v245
v_dot2c_f32_bf16 v242, v218, v245
v_dot2c_f32_bf16 v243, v222, v245
v_dot2c_f32_bf16 v236, v195, v245
v_dot2c_f32_bf16 v237, v199, v245
v_dot2c_f32_bf16 v238, v203, v245
v_dot2c_f32_bf16 v239, v207, v245
v_dot2c_f32_bf16 v240, v211, v245
v_dot2c_f32_bf16 v241, v215, v245
v_dot2c_f32_bf16 v242, v219, v245
v_dot2c_f32_bf16 v243, v223, v245
G1cs_0_5:
v_mfma_f32_16x16x32_bf16 v[0:3], v[192:195], v[176:179], v[0:3]
s_add_u32 s37, s37, 32768
s_cmp_ge_u32 s37, 98304
s_cselect_b32 s31, 98304, 0
s_sub_u32 s37, s37, s31
v_add_u32 v229, s37, v227
v_add_u32 v230, s37, v228
v_mfma_f32_16x16x32_bf16 v[4:7], v[196:199], v[176:179], v[4:7]
ds_read_b64_tr_b16 v[144:145], v231 offset:32768
v_mfma_f32_16x16x32_bf16 v[8:11], v[200:203], v[176:179], v[8:11]
ds_read_b64_tr_b16 v[146:147], v231 offset:33792
v_mfma_f32_16x16x32_bf16 v[12:15], v[204:207], v[176:179], v[12:15]
ds_read_b64_tr_b16 v[148:149], v232 offset:32768
v_mfma_f32_16x16x32_bf16 v[16:19], v[208:211], v[176:179], v[16:19]
ds_read_b64_tr_b16 v[150:151], v232 offset:33792
v_mfma_f32_16x16x32_bf16 v[20:23], v[212:215], v[176:179], v[20:23]
ds_read_b64_tr_b16 v[152:153], v233 offset:32768
v_mfma_f32_16x16x32_bf16 v[24:27], v[216:219], v[176:179], v[24:27]
ds_read_b64_tr_b16 v[154:155], v233 offset:33792
v_mfma_f32_16x16x32_bf16 v[28:31], v[220:223], v[176:179], v[28:31]
ds_read_b64_tr_b16 v[156:157], v234 offset:32768
v_mfma_f32_16x16x32_bf16 v[32:35], v[192:195], v[180:183], v[32:35]
ds_read_b64_tr_b16 v[158:159], v234 offset:33792
v_mfma_f32_16x16x32_bf16 v[36:39], v[196:199], v[180:183], v[36:39]
ds_read_b64_tr_b16 v[160:161], v231 offset:40960
v_mfma_f32_16x16x32_bf16 v[40:43], v[200:203], v[180:183], v[40:43]
ds_read_b64_tr_b16 v[162:163], v231 offset:41984
v_mfma_f32_16x16x32_bf16 v[44:47], v[204:207], v[180:183], v[44:47]
ds_read_b64_tr_b16 v[164:165], v232 offset:40960
v_mfma_f32_16x16x32_bf16 v[48:51], v[208:211], v[180:183], v[48:51]
ds_read_b64_tr_b16 v[166:167], v232 offset:41984
v_mfma_f32_16x16x32_bf16 v[52:55], v[212:215], v[180:183], v[52:55]
ds_read_b64_tr_b16 v[168:169], v233 offset:40960
v_mfma_f32_16x16x32_bf16 v[56:59], v[216:219], v[180:183], v[56:59]
ds_read_b64_tr_b16 v[170:171], v233 offset:41984
v_mfma_f32_16x16x32_bf16 v[60:63], v[220:223], v[180:183], v[60:63]
ds_read_b64_tr_b16 v[172:173], v234 offset:40960
v_mfma_f32_16x16x32_bf16 v[64:67], v[192:195], v[184:187], v[64:67]
ds_read_b64_tr_b16 v[174:175], v234 offset:41984
s_add_u32 m0, s28, 114688
s_nop 0
buffer_load_dwordx4 v226, s[16:19], s26 offen lds
v_mfma_f32_16x16x32_bf16 v[68:71], v[196:199], v[184:187], v[68:71]
ds_read_b128 v[128:131], v229 offset:0
v_mfma_f32_16x16x32_bf16 v[72:75], v[200:203], v[184:187], v[72:75]
ds_read_b128 v[132:135], v229 offset:2048
v_mfma_f32_16x16x32_bf16 v[76:79], v[204:207], v[184:187], v[76:79]
ds_read_b128 v[136:139], v229 offset:4096
v_mfma_f32_16x16x32_bf16 v[80:83], v[208:211], v[184:187], v[80:83]
ds_read_b128 v[140:143], v229 offset:6144
s_add_u32 m0, s28, 122880
s_nop 0
buffer_load_dwordx4 v226, s[20:23], s26 offen lds
s_add_u32 s26, s26, 229376
s_cmp_ge_u32 s26, 7340032
s_cselect_b32 s31, 7340032, 0
s_sub_u32 s26, s26, s31
v_mfma_f32_16x16x32_bf16 v[84:87], v[212:215], v[184:187], v[84:87]
v_mfma_f32_16x16x32_bf16 v[88:91], v[216:219], v[184:187], v[88:91]
v_mfma_f32_16x16x32_bf16 v[92:95], v[220:223], v[184:187], v[92:95]
v_mfma_f32_16x16x32_bf16 v[96:99], v[192:195], v[188:191], v[96:99]
s_mov_b32 m0, s36
s_add_u32 s30, s25, 0
s_add_u32 s30, s30, s27
buffer_load_dwordx4 v224, s[40:43], s30 offen lds
v_mfma_f32_16x16x32_bf16 v[100:103], v[196:199], v[188:191], v[100:103]
v_mfma_f32_16x16x32_bf16 v[104:107], v[200:203], v[188:191], v[104:107]
v_mfma_f32_16x16x32_bf16 v[108:111], v[204:207], v[188:191], v[108:111]
v_mfma_f32_16x16x32_bf16 v[112:115], v[208:211], v[188:191], v[112:115]
buffer_load_dwordx4 v225, s[40:43], s30 offen offset:1024 lds
v_mfma_f32_16x16x32_bf16 v[116:119], v[212:215], v[188:191], v[116:119]
v_mfma_f32_16x16x32_bf16 v[120:123], v[216:219], v[188:191], v[120:123]
v_mfma_f32_16x16x32_bf16 v[124:127], v[220:223], v[188:191], v[124:127]
s_waitcnt vmcnt(10) lgkmcnt(0)
s_barrier
s_cmp_lg_u32 s71, s39
s_cbranch_scc1 G1cs_0_6
v_dot2c_f32_bf16 v236, v144, v245
v_dot2c_f32_bf16 v237, v148, v245
v_dot2c_f32_bf16 v238, v152, v245
v_dot2c_f32_bf16 v239, v156, v245
v_dot2c_f32_bf16 v240, v160, v245
v_dot2c_f32_bf16 v241, v164, v245
v_dot2c_f32_bf16 v242, v168, v245
v_dot2c_f32_bf16 v243, v172, v245
v_dot2c_f32_bf16 v236, v145, v245
v_dot2c_f32_bf16 v237, v149, v245
v_dot2c_f32_bf16 v238, v153, v245
v_dot2c_f32_bf16 v239, v157, v245
v_dot2c_f32_bf16 v240, v161, v245
v_dot2c_f32_bf16 v241, v165, v245
v_dot2c_f32_bf16 v242, v169, v245
v_dot2c_f32_bf16 v243, v173, v245
v_dot2c_f32_bf16 v236, v146, v245
v_dot2c_f32_bf16 v237, v150, v245
v_dot2c_f32_bf16 v238, v154, v245
v_dot2c_f32_bf16 v239, v158, v245
v_dot2c_f32_bf16 v240, v162, v245
v_dot2c_f32_bf16 v241, v166, v245
v_dot2c_f32_bf16 v242, v170, v245
v_dot2c_f32_bf16 v243, v174, v245
v_dot2c_f32_bf16 v236, v147, v245
v_dot2c_f32_bf16 v237, v151, v245
v_dot2c_f32_bf16 v238, v155, v245
v_dot2c_f32_bf16 v239, v159, v245
v_dot2c_f32_bf16 v240, v163, v245
v_dot2c_f32_bf16 v241, v167, v245
v_dot2c_f32_bf16 v242, v171, v245
v_dot2c_f32_bf16 v243, v175, v245
G1cs_0_6:
v_mfma_f32_16x16x32_bf16 v[0:3], v[144:147], v[128:131], v[0:3]
v_mfma_f32_16x16x32_bf16 v[4:7], v[148:151], v[128:131], v[4:7]
ds_read_b64_tr_b16 v[192:193], v231 offset:49152
v_mfma_f32_16x16x32_bf16 v[8:11], v[152:155], v[128:131], v[8:11]
ds_read_b64_tr_b16 v[194:195], v231 offset:50176
v_mfma_f32_16x16x32_bf16 v[12:15], v[156:159], v[128:131], v[12:15]
ds_read_b64_tr_b16 v[196:197], v232 offset:49152
v_mfma_f32_16x16x32_bf16 v[16:19], v[160:163], v[128:131], v[16:19]
ds_read_b64_tr_b16 v[198:199], v232 offset:50176
v_mfma_f32_16x16x32_bf16 v[20:23], v[164:167], v[128:131], v[20:23]
ds_read_b64_tr_b16 v[200:201], v233 offset:49152
v_mfma_f32_16x16x32_bf16 v[24:27], v[168:171], v[128:131], v[24:27]
ds_read_b64_tr_b16 v[202:203], v233 offset:50176
v_mfma_f32_16x16x32_bf16 v[28:31], v[172:175], v[128:131], v[28:31]
ds_read_b64_tr_b16 v[204:205], v234 offset:49152
v_mfma_f32_16x16x32_bf16 v[32:35], v[144:147], v[132:135], v[32:35]
ds_read_b64_tr_b16 v[206:207], v234 offset:50176
v_mfma_f32_16x16x32_bf16 v[36:39], v[148:151], v[132:135], v[36:39]
ds_read_b64_tr_b16 v[208:209], v231 offset:57344
v_mfma_f32_16x16x32_bf16 v[40:43], v[152:155], v[132:135], v[40:43]
ds_read_b64_tr_b16 v[210:211], v231 offset:58368
v_mfma_f32_16x16x32_bf16 v[44:47], v[156:159], v[132:135], v[44:47]
ds_read_b64_tr_b16 v[212:213], v232 offset:57344
v_mfma_f32_16x16x32_bf16 v[48:51], v[160:163], v[132:135], v[48:51]
ds_read_b64_tr_b16 v[214:215], v232 offset:58368
v_mfma_f32_16x16x32_bf16 v[52:55], v[164:167], v[132:135], v[52:55]
ds_read_b64_tr_b16 v[216:217], v233 offset:57344
v_mfma_f32_16x16x32_bf16 v[56:59], v[168:171], v[132:135], v[56:59]
ds_read_b64_tr_b16 v[218:219], v233 offset:58368
v_mfma_f32_16x16x32_bf16 v[60:63], v[172:175], v[132:135], v[60:63]
ds_read_b64_tr_b16 v[220:221], v234 offset:57344
v_mfma_f32_16x16x32_bf16 v[64:67], v[144:147], v[136:139], v[64:67]
ds_read_b64_tr_b16 v[222:223], v234 offset:58368
s_add_u32 m0, s28, 131072
s_nop 0
buffer_load_dwordx4 v226, s[16:19], s26 offen lds
v_mfma_f32_16x16x32_bf16 v[68:71], v[148:151], v[136:139], v[68:71]
ds_read_b128 v[176:179], v230 offset:0
v_mfma_f32_16x16x32_bf16 v[72:75], v[152:155], v[136:139], v[72:75]
ds_read_b128 v[180:183], v230 offset:2048
v_mfma_f32_16x16x32_bf16 v[76:79], v[156:159], v[136:139], v[76:79]
ds_read_b128 v[184:187], v230 offset:4096
v_mfma_f32_16x16x32_bf16 v[80:83], v[160:163], v[136:139], v[80:83]
ds_read_b128 v[188:191], v230 offset:6144
s_add_u32 m0, s28, 139264
s_nop 0
buffer_load_dwordx4 v226, s[20:23], s26 offen lds
s_add_u32 s26, s26, 229376
s_cmp_ge_u32 s26, 7340032
s_cselect_b32 s31, 7340032, 0
s_sub_u32 s26, s26, s31
v_mfma_f32_16x16x32_bf16 v[84:87], v[164:167], v[136:139], v[84:87]
v_mfma_f32_16x16x32_bf16 v[88:91], v[168:171], v[136:139], v[88:91]
v_mfma_f32_16x16x32_bf16 v[92:95], v[172:175], v[136:139], v[92:95]
v_mfma_f32_16x16x32_bf16 v[96:99], v[144:147], v[140:143], v[96:99]
s_add_u32 m0, s36, 16384
s_add_u32 s30, s25, 262144
s_add_u32 s30, s30, s27
buffer_load_dwordx4 v224, s[40:43], s30 offen lds
v_mfma_f32_16x16x32_bf16 v[100:103], v[148:151], v[140:143], v[100:103]
v_mfma_f32_16x16x32_bf16 v[104:107], v[152:155], v[140:143], v[104:107]
v_mfma_f32_16x16x32_bf16 v[108:111], v[156:159], v[140:143], v[108:111]
v_mfma_f32_16x16x32_bf16 v[112:115], v[160:163], v[140:143], v[112:115]
buffer_load_dwordx4 v225, s[40:43], s30 offen offset:1024 lds
s_add_u32 s27, s27, 128
s_and_b32 s27, s27, 2047
s_add_u32 s36, s36, 32768
s_cmp_ge_u32 s36, 98304
s_cselect_b32 s31, 98304, 0
s_sub_u32 s36, s36, s31
v_mfma_f32_16x16x32_bf16 v[116:119], v[164:167], v[140:143], v[116:119]
v_mfma_f32_16x16x32_bf16 v[120:123], v[168:171], v[140:143], v[120:123]
v_mfma_f32_16x16x32_bf16 v[124:127], v[172:175], v[140:143], v[124:127]
s_waitcnt vmcnt(8) lgkmcnt(0)
s_barrier
s_cmp_lg_u32 s71, s39
s_cbranch_scc1 G1cs_0_7
v_dot2c_f32_bf16 v236, v192, v245
v_dot2c_f32_bf16 v237, v196, v245
v_dot2c_f32_bf16 v238, v200, v245
v_dot2c_f32_bf16 v239, v204, v245
v_dot2c_f32_bf16 v240, v208, v245
v_dot2c_f32_bf16 v241, v212, v245
v_dot2c_f32_bf16 v242, v216, v245
v_dot2c_f32_bf16 v243, v220, v245
v_dot2c_f32_bf16 v236, v193, v245
v_dot2c_f32_bf16 v237, v197, v245
v_dot2c_f32_bf16 v238, v201, v245
v_dot2c_f32_bf16 v239, v205, v245
v_dot2c_f32_bf16 v240, v209, v245
v_dot2c_f32_bf16 v241, v213, v245
v_dot2c_f32_bf16 v242, v217, v245
v_dot2c_f32_bf16 v243, v221, v245
v_dot2c_f32_bf16 v236, v194, v245
v_dot2c_f32_bf16 v237, v198, v245
v_dot2c_f32_bf16 v238, v202, v245
v_dot2c_f32_bf16 v239, v206, v245
v_dot2c_f32_bf16 v240, v210, v245
v_dot2c_f32_bf16 v241, v214, v245
v_dot2c_f32_bf16 v242, v218, v245
v_dot2c_f32_bf16 v243, v222, v245
v_dot2c_f32_bf16 v236, v195, v245
v_dot2c_f32_bf16 v237, v199, v245
v_dot2c_f32_bf16 v238, v203, v245
v_dot2c_f32_bf16 v239, v207, v245
v_dot2c_f32_bf16 v240, v211, v245
v_dot2c_f32_bf16 v241, v215, v245
v_dot2c_f32_bf16 v242, v219, v245
v_dot2c_f32_bf16 v243, v223, v245
G1cs_0_7:
v_mfma_f32_16x16x32_bf16 v[0:3], v[192:195], v[176:179], v[0:3]
s_add_u32 s37, s37, 32768
s_cmp_ge_u32 s37, 98304
s_cselect_b32 s31, 98304, 0
s_sub_u32 s37, s37, s31
v_add_u32 v229, s37, v227
v_add_u32 v230, s37, v228
v_mfma_f32_16x16x32_bf16 v[4:7], v[196:199], v[176:179], v[4:7]
ds_read_b64_tr_b16 v[144:145], v231 offset:0
v_mfma_f32_16x16x32_bf16 v[8:11], v[200:203], v[176:179], v[8:11]
ds_read_b64_tr_b16 v[146:147], v231 offset:1024
v_mfma_f32_16x16x32_bf16 v[12:15], v[204:207], v[176:179], v[12:15]
ds_read_b64_tr_b16 v[148:149], v232 offset:0
v_mfma_f32_16x16x32_bf16 v[16:19], v[208:211], v[176:179], v[16:19]
ds_read_b64_tr_b16 v[150:151], v232 offset:1024
v_mfma_f32_16x16x32_bf16 v[20:23], v[212:215], v[176:179], v[20:23]
ds_read_b64_tr_b16 v[152:153], v233 offset:0
v_mfma_f32_16x16x32_bf16 v[24:27], v[216:219], v[176:179], v[24:27]
ds_read_b64_tr_b16 v[154:155], v233 offset:1024
v_mfma_f32_16x16x32_bf16 v[28:31], v[220:223], v[176:179], v[28:31]
ds_read_b64_tr_b16 v[156:157], v234 offset:0
v_mfma_f32_16x16x32_bf16 v[32:35], v[192:195], v[180:183], v[32:35]
ds_read_b64_tr_b16 v[158:159], v234 offset:1024
v_mfma_f32_16x16x32_bf16 v[36:39], v[196:199], v[180:183], v[36:39]
ds_read_b64_tr_b16 v[160:161], v231 offset:8192
v_mfma_f32_16x16x32_bf16 v[40:43], v[200:203], v[180:183], v[40:43]
ds_read_b64_tr_b16 v[162:163], v231 offset:9216
v_mfma_f32_16x16x32_bf16 v[44:47], v[204:207], v[180:183], v[44:47]
ds_read_b64_tr_b16 v[164:165], v232 offset:8192
v_mfma_f32_16x16x32_bf16 v[48:51], v[208:211], v[180:183], v[48:51]
ds_read_b64_tr_b16 v[166:167], v232 offset:9216
v_mfma_f32_16x16x32_bf16 v[52:55], v[212:215], v[180:183], v[52:55]
ds_read_b64_tr_b16 v[168:169], v233 offset:8192
v_mfma_f32_16x16x32_bf16 v[56:59], v[216:219], v[180:183], v[56:59]
ds_read_b64_tr_b16 v[170:171], v233 offset:9216
v_mfma_f32_16x16x32_bf16 v[60:63], v[220:223], v[180:183], v[60:63]
ds_read_b64_tr_b16 v[172:173], v234 offset:8192
v_mfma_f32_16x16x32_bf16 v[64:67], v[192:195], v[184:187], v[64:67]
ds_read_b64_tr_b16 v[174:175], v234 offset:9216
s_add_u32 m0, s28, 147456
s_nop 0
buffer_load_dwordx4 v226, s[16:19], s26 offen lds
v_mfma_f32_16x16x32_bf16 v[68:71], v[196:199], v[184:187], v[68:71]
ds_read_b128 v[128:131], v229 offset:0
v_mfma_f32_16x16x32_bf16 v[72:75], v[200:203], v[184:187], v[72:75]
ds_read_b128 v[132:135], v229 offset:2048
v_mfma_f32_16x16x32_bf16 v[76:79], v[204:207], v[184:187], v[76:79]
ds_read_b128 v[136:139], v229 offset:4096
v_mfma_f32_16x16x32_bf16 v[80:83], v[208:211], v[184:187], v[80:83]
ds_read_b128 v[140:143], v229 offset:6144
s_add_u32 m0, s28, 155648
s_nop 0
buffer_load_dwordx4 v226, s[20:23], s26 offen lds
s_add_u32 s26, s26, 229376
s_cmp_ge_u32 s26, 7340032
s_cselect_b32 s31, 7340032, 0
s_sub_u32 s26, s26, s31
v_mfma_f32_16x16x32_bf16 v[84:87], v[212:215], v[184:187], v[84:87]
v_mfma_f32_16x16x32_bf16 v[88:91], v[216:219], v[184:187], v[88:91]
v_mfma_f32_16x16x32_bf16 v[92:95], v[220:223], v[184:187], v[92:95]
v_mfma_f32_16x16x32_bf16 v[96:99], v[192:195], v[188:191], v[96:99]
s_mov_b32 m0, s36
s_add_u32 s30, s25, 0
s_add_u32 s30, s30, s27
buffer_load_dwordx4 v224, s[40:43], s30 offen lds
v_mfma_f32_16x16x32_bf16 v[100:103], v[196:199], v[188:191], v[100:103]
v_mfma_f32_16x16x32_bf16 v[104:107], v[200:203], v[188:191], v[104:107]
v_mfma_f32_16x16x32_bf16 v[108:111], v[204:207], v[188:191], v[108:111]
v_mfma_f32_16x16x32_bf16 v[112:115], v[208:211], v[188:191], v[112:115]
buffer_load_dwordx4 v225, s[40:43], s30 offen offset:1024 lds
v_mfma_f32_16x16x32_bf16 v[116:119], v[212:215], v[188:191], v[116:119]
v_mfma_f32_16x16x32_bf16 v[120:123], v[216:219], v[188:191], v[120:123]
v_mfma_f32_16x16x32_bf16 v[124:127], v[220:223], v[188:191], v[124:127]
s_add_u32 s39, s39, 1
s_cmp_lt_u32 s39, 6
s_cbranch_scc1 G1L0_loop
s_waitcnt vmcnt(10) lgkmcnt(0)
s_barrier
s_lshl_b32 s82, s2, 7
s_add_u32 s82, s82, 1114112
s_cmp_lg_u32 s24, 0
s_cbranch_scc1 PI_12
v_mov_b32 v254, s82
buffer_load_dword v255, v254, s[12:15], 0 offen sc1
PI_12:
v_mfma_f32_16x16x32_bf16 v[0:3], v[144:147], v[128:131], v[0:3]
v_mfma_f32_16x16x32_bf16 v[4:7], v[148:151], v[128:131], v[4:7]
ds_read_b64_tr_b16 v[192:193], v231 offset:16384
v_mfma_f32_16x16x32_bf16 v[8:11], v[152:155], v[128:131], v[8:11]
ds_read_b64_tr_b16 v[194:195], v231 offset:17408
v_mfma_f32_16x16x32_bf16 v[12:15], v[156:159], v[128:131], v[12:15]
ds_read_b64_tr_b16 v[196:197], v232 offset:16384
v_mfma_f32_16x16x32_bf16 v[16:19], v[160:163], v[128:131], v[16:19]
ds_read_b64_tr_b16 v[198:199], v232 offset:17408
v_mfma_f32_16x16x32_bf16 v[20:23], v[164:167], v[128:131], v[20:23]
ds_read_b64_tr_b16 v[200:201], v233 offset:16384
v_mfma_f32_16x16x32_bf16 v[24:27], v[168:171], v[128:131], v[24:27]
ds_read_b64_tr_b16 v[202:203], v233 offset:17408
v_mfma_f32_16x16x32_bf16 v[28:31], v[172:175], v[128:131], v[28:31]
ds_read_b64_tr_b16 v[204:205], v234 offset:16384
v_mfma_f32_16x16x32_bf16 v[32:35], v[144:147], v[132:135], v[32:35]
ds_read_b64_tr_b16 v[206:207], v234 offset:17408
v_mfma_f32_16x16x32_bf16 v[36:39], v[148:151], v[132:135], v[36:39]
ds_read_b64_tr_b16 v[208:209], v231 offset:24576
v_mfma_f32_16x16x32_bf16 v[40:43], v[152:155], v[132:135], v[40:43]
ds_read_b64_tr_b16 v[210:211], v231 offset:25600
v_mfma_f32_16x16x32_bf16 v[44:47], v[156:159], v[132:135], v[44:47]
ds_read_b64_tr_b16 v[212:213], v232 offset:24576
v_mfma_f32_16x16x32_bf16 v[48:51], v[160:163], v[132:135], v[48:51]
ds_read_b64_tr_b16 v[214:215], v232 offset:25600
v_mfma_f32_16x16x32_bf16 v[52:55], v[164:167], v[132:135], v[52:55]
ds_read_b64_tr_b16 v[216:217], v233 offset:24576
v_mfma_f32_16x16x32_bf16 v[56:59], v[168:171], v[132:135], v[56:59]
ds_read_b64_tr_b16 v[218:219], v233 offset:25600
v_mfma_f32_16x16x32_bf16 v[60:63], v[172:175], v[132:135], v[60:63]
ds_read_b64_tr_b16 v[220:221], v234 offset:24576
v_mfma_f32_16x16x32_bf16 v[64:67], v[144:147], v[136:139], v[64:67]
ds_read_b64_tr_b16 v[222:223], v234 offset:25600
s_add_u32 m0, s28, 98304
s_nop 0
buffer_load_dwordx4 v226, s[16:19], s26 offen lds
v_mfma_f32_16x16x32_bf16 v[68:71], v[148:151], v[136:139], v[68:71]
ds_read_b128 v[176:179], v230 offset:0
v_mfma_f32_16x16x32_bf16 v[72:75], v[152:155], v[136:139], v[72:75]
ds_read_b128 v[180:183], v230 offset:2048
v_mfma_f32_16x16x32_bf16 v[76:79], v[156:159], v[136:139], v[76:79]
ds_read_b128 v[184:187], v230 offset:4096
v_mfma_f32_16x16x32_bf16 v[80:83], v[160:163], v[136:139], v[80:83]
ds_read_b128 v[188:191], v230 offset:6144
s_add_u32 m0, s28, 106496
s_nop 0
buffer_load_dwordx4 v226, s[20:23], s26 offen lds
s_add_u32 s26, s26, 229376
s_cmp_ge_u32 s26, 7340032
s_cselect_b32 s31, 7340032, 0
s_sub_u32 s26, s26, s31
v_mfma_f32_16x16x32_bf16 v[84:87], v[164:167], v[136:139], v[84:87]
v_mfma_f32_16x16x32_bf16 v[88:91], v[168:171], v[136:139], v[88:91]
v_mfma_f32_16x16x32_bf16 v[92:95], v[172:175], v[136:139], v[92:95]
v_mfma_f32_16x16x32_bf16 v[96:99], v[144:147], v[140:143], v[96:99]
s_add_u32 m0, s36, 16384
s_add_u32 s30, s25, 262144
s_add_u32 s30, s30, s27
buffer_load_dwordx4 v224, s[40:43], s30 offen lds
v_mfma_f32_16x16x32_bf16 v[100:103], v[148:151], v[140:143], v[100:103]
v_mfma_f32_16x16x32_bf16 v[104:107], v[152:155], v[140:143], v[104:107]
v_mfma_f32_16x16x32_bf16 v[108:111], v[156:159], v[140:143], v[108:111]
v_mfma_f32_16x16x32_bf16 v[112:115], v[160:163], v[140:143], v[112:115]
buffer_load_dwordx4 v225, s[40:43], s30 offen offset:1024 lds
s_add_u32 s27, s27, 128
s_and_b32 s27, s27, 2047
s_add_u32 s36, s36, 32768
s_cmp_ge_u32 s36, 98304
s_cselect_b32 s31, 98304, 0
s_sub_u32 s36, s36, s31
v_mfma_f32_16x16x32_bf16 v[116:119], v[164:167], v[140:143], v[116:119]
v_mfma_f32_16x16x32_bf16 v[120:123], v[168:171], v[140:143], v[120:123]
v_mfma_f32_16x16x32_bf16 v[124:127], v[172:175], v[140:143], v[124:127]
s_waitcnt vmcnt(8) lgkmcnt(0)
s_barrier
v_mfma_f32_16x16x32_bf16 v[0:3], v[192:195], v[176:179], v[0:3]
s_add_u32 s37, s37, 32768
s_cmp_ge_u32 s37, 98304
s_cselect_b32 s31, 98304, 0
s_sub_u32 s37, s37, s31
v_add_u32 v229, s37, v227
v_add_u32 v230, s37, v228
v_mfma_f32_16x16x32_bf16 v[4:7], v[196:199], v[176:179], v[4:7]
ds_read_b64_tr_b16 v[144:145], v231 offset:32768
v_mfma_f32_16x16x32_bf16 v[8:11], v[200:203], v[176:179], v[8:11]
ds_read_b64_tr_b16 v[146:147], v231 offset:33792
v_mfma_f32_16x16x32_bf16 v[12:15], v[204:207], v[176:179], v[12:15]
ds_read_b64_tr_b16 v[148:149], v232 offset:32768
v_mfma_f32_16x16x32_bf16 v[16:19], v[208:211], v[176:179], v[16:19]
ds_read_b64_tr_b16 v[150:151], v232 offset:33792
v_mfma_f32_16x16x32_bf16 v[20:23], v[212:215], v[176:179], v[20:23]
ds_read_b64_tr_b16 v[152:153], v233 offset:32768
v_mfma_f32_16x16x32_bf16 v[24:27], v[216:219], v[176:179], v[24:27]
ds_read_b64_tr_b16 v[154:155], v233 offset:33792
v_mfma_f32_16x16x32_bf16 v[28:31], v[220:223], v[176:179], v[28:31]
ds_read_b64_tr_b16 v[156:157], v234 offset:32768
v_mfma_f32_16x16x32_bf16 v[32:35], v[192:195], v[180:183], v[32:35]
ds_read_b64_tr_b16 v[158:159], v234 offset:33792
v_mfma_f32_16x16x32_bf16 v[36:39], v[196:199], v[180:183], v[36:39]
ds_read_b64_tr_b16 v[160:161], v231 offset:40960
v_mfma_f32_16x16x32_bf16 v[40:43], v[200:203], v[180:183], v[40:43]
ds_read_b64_tr_b16 v[162:163], v231 offset:41984
v_mfma_f32_16x16x32_bf16 v[44:47], v[204:207], v[180:183], v[44:47]
ds_read_b64_tr_b16 v[164:165], v232 offset:40960
v_mfma_f32_16x16x32_bf16 v[48:51], v[208:211], v[180:183], v[48:51]
ds_read_b64_tr_b16 v[166:167], v232 offset:41984
v_mfma_f32_16x16x32_bf16 v[52:55], v[212:215], v[180:183], v[52:55]
ds_read_b64_tr_b16 v[168:169], v233 offset:40960
v_mfma_f32_16x16x32_bf16 v[56:59], v[216:219], v[180:183], v[56:59]
ds_read_b64_tr_b16 v[170:171], v233 offset:41984
v_mfma_f32_16x16x32_bf16 v[60:63], v[220:223], v[180:183], v[60:63]
ds_read_b64_tr_b16 v[172:173], v234 offset:40960
v_mfma_f32_16x16x32_bf16 v[64:67], v[192:195], v[184:187], v[64:67]
ds_read_b64_tr_b16 v[174:175], v234 offset:41984
s_add_u32 m0, s28, 114688
s_nop 0
buffer_load_dwordx4 v226, s[16:19], s26 offen lds
v_mfma_f32_16x16x32_bf16 v[68:71], v[196:199], v[184:187], v[68:71]
ds_read_b128 v[128:131], v229 offset:0
v_mfma_f32_16x16x32_bf16 v[72:75], v[200:203], v[184:187], v[72:75]
ds_read_b128 v[132:135], v229 offset:2048
v_mfma_f32_16x16x32_bf16 v[76:79], v[204:207], v[184:187], v[76:79]
ds_read_b128 v[136:139], v229 offset:4096
v_mfma_f32_16x16x32_bf16 v[80:83], v[208:211], v[184:187], v[80:83]
ds_read_b128 v[140:143], v229 offset:6144
s_add_u32 m0, s28, 122880
s_nop 0
buffer_load_dwordx4 v226, s[20:23], s26 offen lds
s_add_u32 s26, s26, 229376
s_cmp_ge_u32 s26, 7340032
s_cselect_b32 s31, 7340032, 0
s_sub_u32 s26, s26, s31
v_mfma_f32_16x16x32_bf16 v[84:87], v[212:215], v[184:187], v[84:87]
v_mfma_f32_16x16x32_bf16 v[88:91], v[216:219], v[184:187], v[88:91]
v_mfma_f32_16x16x32_bf16 v[92:95], v[220:223], v[184:187], v[92:95]
v_mfma_f32_16x16x32_bf16 v[96:99], v[192:195], v[188:191], v[96:99]
s_mov_b32 m0, s36
s_add_u32 s30, s25, 0
s_add_u32 s30, s30, s27
buffer_load_dwordx4 v224, s[40:43], s30 offen lds
v_mfma_f32_16x16x32_bf16 v[100:103], v[196:199], v[188:191], v[100:103]
v_mfma_f32_16x16x32_bf16 v[104:107], v[200:203], v[188:191], v[104:107]
v_mfma_f32_16x16x32_bf16 v[108:111], v[204:207], v[188:191], v[108:111]
v_mfma_f32_16x16x32_bf16 v[112:115], v[208:211], v[188:191], v[112:115]
buffer_load_dwordx4 v225, s[40:43], s30 offen offset:1024 lds
v_mfma_f32_16x16x32_bf16 v[116:119], v[212:215], v[188:191], v[116:119]
v_mfma_f32_16x16x32_bf16 v[120:123], v[216:219], v[188:191], v[120:123]
v_mfma_f32_16x16x32_bf16 v[124:127], v[220:223], v[188:191], v[124:127]
s_waitcnt vmcnt(10) lgkmcnt(0)
s_barrier
v_mfma_f32_16x16x32_bf16 v[0:3], v[144:147], v[128:131], v[0:3]
v_mfma_f32_16x16x32_bf16 v[4:7], v[148:151], v[128:131], v[4:7]
ds_read_b64_tr_b16 v[192:193], v231 offset:49152
v_mfma_f32_16x16x32_bf16 v[8:11], v[152:155], v[128:131], v[8:11]
ds_read_b64_tr_b16 v[194:195], v231 offset:50176
v_mfma_f32_16x16x32_bf16 v[12:15], v[156:159], v[128:131], v[12:15]
ds_read_b64_tr_b16 v[196:197], v232 offset:49152
v_mfma_f32_16x16x32_bf16 v[16:19], v[160:163], v[128:131], v[16:19]
ds_read_b64_tr_b16 v[198:199], v232 offset:50176
v_mfma_f32_16x16x32_bf16 v[20:23], v[164:167], v[128:131], v[20:23]
ds_read_b64_tr_b16 v[200:201], v233 offset:49152
v_mfma_f32_16x16x32_bf16 v[24:27], v[168:171], v[128:131], v[24:27]
ds_read_b64_tr_b16 v[202:203], v233 offset:50176
v_mfma_f32_16x16x32_bf16 v[28:31], v[172:175], v[128:131], v[28:31]
ds_read_b64_tr_b16 v[204:205], v234 offset:49152
v_mfma_f32_16x16x32_bf16 v[32:35], v[144:147], v[132:135], v[32:35]
ds_read_b64_tr_b16 v[206:207], v234 offset:50176
v_mfma_f32_16x16x32_bf16 v[36:39], v[148:151], v[132:135], v[36:39]
ds_read_b64_tr_b16 v[208:209], v231 offset:57344
v_mfma_f32_16x16x32_bf16 v[40:43], v[152:155], v[132:135], v[40:43]
ds_read_b64_tr_b16 v[210:211], v231 offset:58368
v_mfma_f32_16x16x32_bf16 v[44:47], v[156:159], v[132:135], v[44:47]
ds_read_b64_tr_b16 v[212:213], v232 offset:57344
v_mfma_f32_16x16x32_bf16 v[48:51], v[160:163], v[132:135], v[48:51]
ds_read_b64_tr_b16 v[214:215], v232 offset:58368
v_mfma_f32_16x16x32_bf16 v[52:55], v[164:167], v[132:135], v[52:55]
ds_read_b64_tr_b16 v[216:217], v233 offset:57344
v_mfma_f32_16x16x32_bf16 v[56:59], v[168:171], v[132:135], v[56:59]
ds_read_b64_tr_b16 v[218:219], v233 offset:58368
v_mfma_f32_16x16x32_bf16 v[60:63], v[172:175], v[132:135], v[60:63]
ds_read_b64_tr_b16 v[220:221], v234 offset:57344
v_mfma_f32_16x16x32_bf16 v[64:67], v[144:147], v[136:139], v[64:67]
ds_read_b64_tr_b16 v[222:223], v234 offset:58368
s_add_u32 m0, s28, 131072
s_nop 0
buffer_load_dwordx4 v226, s[16:19], s26 offen lds
v_mfma_f32_16x16x32_bf16 v[68:71], v[148:151], v[136:139], v[68:71]
ds_read_b128 v[176:179], v230 offset:0
v_mfma_f32_16x16x32_bf16 v[72:75], v[152:155], v[136:139], v[72:75]
ds_read_b128 v[180:183], v230 offset:2048
v_mfma_f32_16x16x32_bf16 v[76:79], v[156:159], v[136:139], v[76:79]
ds_read_b128 v[184:187], v230 offset:4096
v_mfma_f32_16x16x32_bf16 v[80:83], v[160:163], v[136:139], v[80:83]
ds_read_b128 v[188:191], v230 offset:6144
s_add_u32 m0, s28, 139264
s_nop 0
buffer_load_dwordx4 v226, s[20:23], s26 offen lds
s_add_u32 s26, s26, 229376
s_cmp_ge_u32 s26, 7340032
s_cselect_b32 s31, 7340032, 0
s_sub_u32 s26, s26, s31
v_mfma_f32_16x16x32_bf16 v[84:87], v[164:167], v[136:139], v[84:87]
v_mfma_f32_16x16x32_bf16 v[88:91], v[168:171], v[136:139], v[88:91]
v_mfma_f32_16x16x32_bf16 v[92:95], v[172:175], v[136:139], v[92:95]
v_mfma_f32_16x16x32_bf16 v[96:99], v[144:147], v[140:143], v[96:99]
s_add_u32 m0, s36, 16384
s_add_u32 s30, s25, 262144
s_add_u32 s30, s30, s27
buffer_load_dwordx4 v224, s[40:43], s30 offen lds
v_mfma_f32_16x16x32_bf16 v[100:103], v[148:151], v[140:143], v[100:103]
v_mfma_f32_16x16x32_bf16 v[104:107], v[152:155], v[140:143], v[104:107]
v_mfma_f32_16x16x32_bf16 v[108:111], v[156:159], v[140:143], v[108:111]
v_mfma_f32_16x16x32_bf16 v[112:115], v[160:163], v[140:143], v[112:115]
buffer_load_dwordx4 v225, s[40:43], s30 offen offset:1024 lds
s_add_u32 s27, s27, 128
s_and_b32 s27, s27, 2047
s_add_u32 s36, s36, 32768
s_cmp_ge_u32 s36, 98304
s_cselect_b32 s31, 98304, 0
s_sub_u32 s36, s36, s31
v_mfma_f32_16x16x32_bf16 v[116:119], v[164:167], v[140:143], v[116:119]
v_mfma_f32_16x16x32_bf16 v[120:123], v[168:171], v[140:143], v[120:123]
v_mfma_f32_16x16x32_bf16 v[124:127], v[172:175], v[140:143], v[124:127]
s_waitcnt vmcnt(8) lgkmcnt(0)
s_barrier
s_cmp_lg_u32 s24, 0
s_cbranch_scc1 PC_13_done
s_mov_b32 s48, 0
PC_13_chk:
v_readfirstlane_b32 s49, v255
s_add_u32 s48, s48, 1
s_cmp_ge_u32 s49, 72
s_cbranch_scc1 PC_13_done
s_cmp_ge_u32 s48, 0x40000
s_cbranch_scc1 PC_13_done
s_sleep 4
buffer_load_dword v255, v254, s[12:15], 0 offen sc1
s_waitcnt vmcnt(0)
s_branch PC_13_chk
PC_13_done:
v_mfma_f32_16x16x32_bf16 v[0:3], v[192:195], v[176:179], v[0:3]
s_add_u32 s37, s37, 32768
s_cmp_ge_u32 s37, 98304
s_cselect_b32 s31, 98304, 0
s_sub_u32 s37, s37, s31
v_add_u32 v229, s37, v227
v_add_u32 v230, s37, v228
v_mfma_f32_16x16x32_bf16 v[4:7], v[196:199], v[176:179], v[4:7]
ds_read_b64_tr_b16 v[144:145], v231 offset:0
v_mfma_f32_16x16x32_bf16 v[8:11], v[200:203], v[176:179], v[8:11]
ds_read_b64_tr_b16 v[146:147], v231 offset:1024
v_mfma_f32_16x16x32_bf16 v[12:15], v[204:207], v[176:179], v[12:15]
ds_read_b64_tr_b16 v[148:149], v232 offset:0
v_mfma_f32_16x16x32_bf16 v[16:19], v[208:211], v[176:179], v[16:19]
ds_read_b64_tr_b16 v[150:151], v232 offset:1024
v_mfma_f32_16x16x32_bf16 v[20:23], v[212:215], v[176:179], v[20:23]
ds_read_b64_tr_b16 v[152:153], v233 offset:0
v_mfma_f32_16x16x32_bf16 v[24:27], v[216:219], v[176:179], v[24:27]
ds_read_b64_tr_b16 v[154:155], v233 offset:1024
v_mfma_f32_16x16x32_bf16 v[28:31], v[220:223], v[176:179], v[28:31]
ds_read_b64_tr_b16 v[156:157], v234 offset:0
v_mfma_f32_16x16x32_bf16 v[32:35], v[192:195], v[180:183], v[32:35]
ds_read_b64_tr_b16 v[158:159], v234 offset:1024
v_mfma_f32_16x16x32_bf16 v[36:39], v[196:199], v[180:183], v[36:39]
ds_read_b64_tr_b16 v[160:161], v231 offset:8192
v_mfma_f32_16x16x32_bf16 v[40:43], v[200:203], v[180:183], v[40:43]
ds_read_b64_tr_b16 v[162:163], v231 offset:9216
v_mfma_f32_16x16x32_bf16 v[44:47], v[204:207], v[180:183], v[44:47]
ds_read_b64_tr_b16 v[164:165], v232 offset:8192
v_mfma_f32_16x16x32_bf16 v[48:51], v[208:211], v[180:183], v[48:51]
ds_read_b64_tr_b16 v[166:167], v232 offset:9216
v_mfma_f32_16x16x32_bf16 v[52:55], v[212:215], v[180:183], v[52:55]
ds_read_b64_tr_b16 v[168:169], v233 offset:8192
v_mfma_f32_16x16x32_bf16 v[56:59], v[216:219], v[180:183], v[56:59]
ds_read_b64_tr_b16 v[170:171], v233 offset:9216
v_mfma_f32_16x16x32_bf16 v[60:63], v[220:223], v[180:183], v[60:63]
ds_read_b64_tr_b16 v[172:173], v234 offset:8192
v_mfma_f32_16x16x32_bf16 v[64:67], v[192:195], v[184:187], v[64:67]
ds_read_b64_tr_b16 v[174:175], v234 offset:9216
s_add_u32 m0, s28, 147456
s_nop 0
buffer_load_dwordx4 v226, s[16:19], s26 offen lds
v_mfma_f32_16x16x32_bf16 v[68:71], v[196:199], v[184:187], v[68:71]
ds_read_b128 v[128:131], v229 offset:0
v_mfma_f32_16x16x32_bf16 v[72:75], v[200:203], v[184:187], v[72:75]
ds_read_b128 v[132:135], v229 offset:2048
v_mfma_f32_16x16x32_bf16 v[76:79], v[204:207], v[184:187], v[76:79]
ds_read_b128 v[136:139], v229 offset:4096
v_mfma_f32_16x16x32_bf16 v[80:83], v[208:211], v[184:187], v[80:83]
ds_read_b128 v[140:143], v229 offset:6144
s_add_u32 m0, s28, 155648
s_nop 0
buffer_load_dwordx4 v226, s[20:23], s26 offen lds
s_add_u32 s26, s26, 229376
s_cmp_ge_u32 s26, 7340032
s_cselect_b32 s31, 7340032, 0
s_sub_u32 s26, s26, s31
v_mfma_f32_16x16x32_bf16 v[84:87], v[212:215], v[184:187], v[84:87]
v_mfma_f32_16x16x32_bf16 v[88:91], v[216:219], v[184:187], v[88:91]
v_mfma_f32_16x16x32_bf16 v[92:95], v[220:223], v[184:187], v[92:95]
v_mfma_f32_16x16x32_bf16 v[96:99], v[192:195], v[188:191], v[96:99]
v_mfma_f32_16x16x32_bf16 v[100:103], v[196:199], v[188:191], v[100:103]
v_mfma_f32_16x16x32_bf16 v[104:107], v[200:203], v[188:191], v[104:107]
v_mfma_f32_16x16x32_bf16 v[108:111], v[204:207], v[188:191], v[108:111]
v_mfma_f32_16x16x32_bf16 v[112:115], v[208:211], v[188:191], v[112:115]
v_mfma_f32_16x16x32_bf16 v[116:119], v[212:215], v[188:191], v[116:119]
v_mfma_f32_16x16x32_bf16 v[120:123], v[216:219], v[188:191], v[120:123]
v_mfma_f32_16x16x32_bf16 v[124:127], v[220:223], v[188:191], v[124:127]
s_waitcnt vmcnt(8) lgkmcnt(0)
s_barrier
v_and_b32 v253, 15, v235
v_lshlrev_b32 v253, 3, v253
s_lshl_b32 s82, s32, 11
s_lshl_b32 s83, s35, 9
s_add_u32 s82, s82, s83
buffer_load_dwordx2 v[236:237], v253, s[12:15], s82 offen offset:0 sc1
buffer_load_dwordx2 v[238:239], v253, s[12:15], s82 offen offset:128 sc1
buffer_load_dwordx2 v[240:241], v253, s[12:15], s82 offen offset:256 sc1
buffer_load_dwordx2 v[242:243], v253, s[12:15], s82 offen offset:384 sc1
v_lshlrev_b32 v253, 2, v235
s_mul_i32 s82, s33, 112
s_add_u32 s82, s82, 0
s_lshl_b32 s82, s82, 2
s_add_u32 s82, s82, 2097152
s_add_u32 s83, s82, 0
buffer_load_dword v244, v253, s[12:15], s83 offen sc1
s_add_u32 s83, s82, 14336
buffer_load_dword v245, v253, s[12:15], s83 offen sc1
v_mfma_f32_16x16x32_bf16 v[0:3], v[144:147], v[128:131], v[0:3]
v_mfma_f32_16x16x32_bf16 v[4:7], v[148:151], v[128:131], v[4:7]
ds_read_b64_tr_b16 v[192:193], v231 offset:16384
v_mfma_f32_16x16x32_bf16 v[8:11], v[152:155], v[128:131], v[8:11]
ds_read_b64_tr_b16 v[194:195], v231 offset:17408
v_mfma_f32_16x16x32_bf16 v[12:15], v[156:159], v[128:131], v[12:15]
ds_read_b64_tr_b16 v[196:197], v232 offset:16384
v_mfma_f32_16x16x32_bf16 v[16:19], v[160:163], v[128:131], v[16:19]
ds_read_b64_tr_b16 v[198:199], v232 offset:17408
v_mfma_f32_16x16x32_bf16 v[20:23], v[164:167], v[128:131], v[20:23]
ds_read_b64_tr_b16 v[200:201], v233 offset:16384
v_mfma_f32_16x16x32_bf16 v[24:27], v[168:171], v[128:131], v[24:27]
ds_read_b64_tr_b16 v[202:203], v233 offset:17408
v_mfma_f32_16x16x32_bf16 v[28:31], v[172:175], v[128:131], v[28:31]
ds_read_b64_tr_b16 v[204:205], v234 offset:16384
v_mfma_f32_16x16x32_bf16 v[32:35], v[144:147], v[132:135], v[32:35]
ds_read_b64_tr_b16 v[206:207], v234 offset:17408
v_mfma_f32_16x16x32_bf16 v[36:39], v[148:151], v[132:135], v[36:39]
ds_read_b64_tr_b16 v[208:209], v231 offset:24576
v_mfma_f32_16x16x32_bf16 v[40:43], v[152:155], v[132:135], v[40:43]
ds_read_b64_tr_b16 v[210:211], v231 offset:25600
v_mfma_f32_16x16x32_bf16 v[44:47], v[156:159], v[132:135], v[44:47]
ds_read_b64_tr_b16 v[212:213], v232 offset:24576
v_mfma_f32_16x16x32_bf16 v[48:51], v[160:163], v[132:135], v[48:51]
ds_read_b64_tr_b16 v[214:215], v232 offset:25600
v_mfma_f32_16x16x32_bf16 v[52:55], v[164:167], v[132:135], v[52:55]
ds_read_b64_tr_b16 v[216:217], v233 offset:24576
v_mfma_f32_16x16x32_bf16 v[56:59], v[168:171], v[132:135], v[56:59]
ds_read_b64_tr_b16 v[218:219], v233 offset:25600
v_mfma_f32_16x16x32_bf16 v[60:63], v[172:175], v[132:135], v[60:63]
ds_read_b64_tr_b16 v[220:221], v234 offset:24576
v_mfma_f32_16x16x32_bf16 v[64:67], v[144:147], v[136:139], v[64:67]
ds_read_b64_tr_b16 v[222:223], v234 offset:25600
v_mfma_f32_16x16x32_bf16 v[68:71], v[148:151], v[136:139], v[68:71]
ds_read_b128 v[176:179], v230 offset:0
v_mfma_f32_16x16x32_bf16 v[72:75], v[152:155], v[136:139], v[72:75]
ds_read_b128 v[180:183], v230 offset:2048
v_mfma_f32_16x16x32_bf16 v[76:79], v[156:159], v[136:139], v[76:79]
ds_read_b128 v[184:187], v230 offset:4096
v_mfma_f32_16x16x32_bf16 v[80:83], v[160:163], v[136:139], v[80:83]
ds_read_b128 v[188:191], v230 offset:6144
v_mfma_f32_16x16x32_bf16 v[84:87], v[164:167], v[136:139], v[84:87]
v_mfma_f32_16x16x32_bf16 v[88:91], v[168:171], v[136:139], v[88:91]
v_mfma_f32_16x16x32_bf16 v[92:95], v[172:175], v[136:139], v[92:95]
v_mfma_f32_16x16x32_bf16 v[96:99], v[144:147], v[140:143], v[96:99]
v_mfma_f32_16x16x32_bf16 v[100:103], v[148:151], v[140:143], v[100:103]
v_mfma_f32_16x16x32_bf16 v[104:107], v[152:155], v[140:143], v[104:107]
v_mfma_f32_16x16x32_bf16 v[108:111], v[156:159], v[140:143], v[108:111]
v_mfma_f32_16x16x32_bf16 v[112:115], v[160:163], v[140:143], v[112:115]
v_mfma_f32_16x16x32_bf16 v[116:119], v[164:167], v[140:143], v[116:119]
v_mfma_f32_16x16x32_bf16 v[120:123], v[168:171], v[140:143], v[120:123]
v_mfma_f32_16x16x32_bf16 v[124:127], v[172:175], v[140:143], v[124:127]
s_waitcnt vmcnt(8) lgkmcnt(0)
s_barrier
s_load_dwordx4 s[4:7], s[0:1], 32
v_mfma_f32_16x16x32_bf16 v[0:3], v[192:195], v[176:179], v[0:3]
s_add_u32 s37, s37, 32768
s_cmp_ge_u32 s37, 98304
s_cselect_b32 s31, 98304, 0
s_sub_u32 s37, s37, s31
v_add_u32 v229, s37, v227
v_add_u32 v230, s37, v228
v_mfma_f32_16x16x32_bf16 v[4:7], v[196:199], v[176:179], v[4:7]
ds_read_b64_tr_b16 v[144:145], v231 offset:32768
v_mfma_f32_16x16x32_bf16 v[8:11], v[200:203], v[176:179], v[8:11]
ds_read_b64_tr_b16 v[146:147], v231 offset:33792
v_mfma_f32_16x16x32_bf16 v[12:15], v[204:207], v[176:179], v[12:15]
ds_read_b64_tr_b16 v[148:149], v232 offset:32768
v_mfma_f32_16x16x32_bf16 v[16:19], v[208:211], v[176:179], v[16:19]
ds_read_b64_tr_b16 v[150:151], v232 offset:33792
v_mfma_f32_16x16x32_bf16 v[20:23], v[212:215], v[176:179], v[20:23]
ds_read_b64_tr_b16 v[152:153], v233 offset:32768
v_mfma_f32_16x16x32_bf16 v[24:27], v[216:219], v[176:179], v[24:27]
ds_read_b64_tr_b16 v[154:155], v233 offset:33792
v_mfma_f32_16x16x32_bf16 v[28:31], v[220:223], v[176:179], v[28:31]
ds_read_b64_tr_b16 v[156:157], v234 offset:32768
v_mfma_f32_16x16x32_bf16 v[32:35], v[192:195], v[180:183], v[32:35]
ds_read_b64_tr_b16 v[158:159], v234 offset:33792
v_mfma_f32_16x16x32_bf16 v[36:39], v[196:199], v[180:183], v[36:39]
ds_read_b64_tr_b16 v[160:161], v231 offset:40960
v_mfma_f32_16x16x32_bf16 v[40:43], v[200:203], v[180:183], v[40:43]
ds_read_b64_tr_b16 v[162:163], v231 offset:41984
v_mfma_f32_16x16x32_bf16 v[44:47], v[204:207], v[180:183], v[44:47]
ds_read_b64_tr_b16 v[164:165], v232 offset:40960
v_mfma_f32_16x16x32_bf16 v[48:51], v[208:211], v[180:183], v[48:51]
ds_read_b64_tr_b16 v[166:167], v232 offset:41984
v_mfma_f32_16x16x32_bf16 v[52:55], v[212:215], v[180:183], v[52:55]
ds_read_b64_tr_b16 v[168:169], v233 offset:40960
v_mfma_f32_16x16x32_bf16 v[56:59], v[216:219], v[180:183], v[56:59]
ds_read_b64_tr_b16 v[170:171], v233 offset:41984
v_mfma_f32_16x16x32_bf16 v[60:63], v[220:223], v[180:183], v[60:63]
ds_read_b64_tr_b16 v[172:173], v234 offset:40960
v_mfma_f32_16x16x32_bf16 v[64:67], v[192:195], v[184:187], v[64:67]
ds_read_b64_tr_b16 v[174:175], v234 offset:41984
v_mfma_f32_16x16x32_bf16 v[68:71], v[196:199], v[184:187], v[68:71]
ds_read_b128 v[128:131], v229 offset:0
v_mfma_f32_16x16x32_bf16 v[72:75], v[200:203], v[184:187], v[72:75]
ds_read_b128 v[132:135], v229 offset:2048
v_mfma_f32_16x16x32_bf16 v[76:79], v[204:207], v[184:187], v[76:79]
ds_read_b128 v[136:139], v229 offset:4096
v_mfma_f32_16x16x32_bf16 v[80:83], v[208:211], v[184:187], v[80:83]
ds_read_b128 v[140:143], v229 offset:6144
v_mfma_f32_16x16x32_bf16 v[84:87], v[212:215], v[184:187], v[84:87]
v_mfma_f32_16x16x32_bf16 v[88:91], v[216:219], v[184:187], v[88:91]
v_mfma_f32_16x16x32_bf16 v[92:95], v[220:223], v[184:187], v[92:95]
v_mfma_f32_16x16x32_bf16 v[96:99], v[192:195], v[188:191], v[96:99]
v_mfma_f32_16x16x32_bf16 v[100:103], v[196:199], v[188:191], v[100:103]
v_mfma_f32_16x16x32_bf16 v[104:107], v[200:203], v[188:191], v[104:107]
v_mfma_f32_16x16x32_bf16 v[108:111], v[204:207], v[188:191], v[108:111]
v_mfma_f32_16x16x32_bf16 v[112:115], v[208:211], v[188:191], v[112:115]
v_mfma_f32_16x16x32_bf16 v[116:119], v[212:215], v[188:191], v[116:119]
v_mfma_f32_16x16x32_bf16 v[120:123], v[216:219], v[188:191], v[120:123]
v_mfma_f32_16x16x32_bf16 v[124:127], v[220:223], v[188:191], v[124:127]
s_waitcnt vmcnt(6) lgkmcnt(0)
s_barrier
s_mov_b32 s72, s4
s_and_b32 s73, s5, 0xffff
s_mov_b32 s74, 4194304
s_mov_b32 s75, 0x20000
s_mov_b32 s76, s6
s_and_b32 s77, s7, 0xffff
s_mov_b32 s78, 2048
s_mov_b32 s79, 0x20000
s_and_b32 s50, s24, 3
s_lshr_b32 s51, s24, 2
s_lshl_b32 s52, s2, 2
s_add_u32 s52, s52, s50
s_mul_i32 s53, s50, 20736
s_add_u32 s53, s53, 32768
s_lshl_b32 s54, s52, 12
v_lshlrev_b32 v255, 4, v235
s_lshl_b32 s55, s51, 2
v_add_u32 v253, s55, v255
s_mul_i32 s55, s51, 8320
s_add_u32 s55, s55, s53
s_add_u32 m0, s55, 0
s_add_u32 s56, s54, 4194304
buffer_load_dwordx4 v253, s[12:15], s56 offen offset:0 sc1 lds
buffer_load_dwordx4 v253, s[12:15], s56 offen offset:1024 sc1 lds
buffer_load_dwordx4 v253, s[12:15], s56 offen offset:2048 sc1 lds
buffer_load_dwordx4 v253, s[12:15], s56 offen offset:3072 sc1 lds
s_mul_i32 s55, s51, 8320
s_add_u32 s55, s55, s53
s_add_u32 m0, s55, 4160
s_add_u32 s56, s54, 8388608
buffer_load_dwordx4 v253, s[12:15], s56 offen offset:0 sc1 lds
buffer_load_dwordx4 v253, s[12:15], s56 offen offset:1024 sc1 lds
buffer_load_dwordx4 v253, s[12:15], s56 offen offset:2048 sc1 lds
buffer_load_dwordx4 v253, s[12:15], s56 offen offset:3072 sc1 lds
s_lshl_b32 s55, s51, 11
s_add_u32 s56, s54, s55
s_add_u32 s55, s55, s53
s_add_u32 m0, s55, 16640
s_nop 0
buffer_load_dwordx4 v255, s[72:75], s56 offen offset:0 lds
buffer_load_dwordx4 v255, s[72:75], s56 offen offset:1024 lds
s_lshl_b32 s55, s52, 1
v_mov_b32 v254, s55
buffer_load_ushort v254, v254, s[76:79], 0 offen
v_mfma_f32_16x16x32_bf16 v[0:3], v[144:147], v[128:131], v[0:3]
v_mfma_f32_16x16x32_bf16 v[4:7], v[148:151], v[128:131], v[4:7]
ds_read_b64_tr_b16 v[192:193], v231 offset:49152
v_mfma_f32_16x16x32_bf16 v[8:11], v[152:155], v[128:131], v[8:11]
ds_read_b64_tr_b16 v[194:195], v231 offset:50176
v_mfma_f32_16x16x32_bf16 v[12:15], v[156:159], v[128:131], v[12:15]
ds_read_b64_tr_b16 v[196:197], v232 offset:49152
v_mfma_f32_16x16x32_bf16 v[16:19], v[160:163], v[128:131], v[16:19]
ds_read_b64_tr_b16 v[198:199], v232 offset:50176
v_mfma_f32_16x16x32_bf16 v[20:23], v[164:167], v[128:131], v[20:23]
ds_read_b64_tr_b16 v[200:201], v233 offset:49152
v_mfma_f32_16x16x32_bf16 v[24:27], v[168:171], v[128:131], v[24:27]
ds_read_b64_tr_b16 v[202:203], v233 offset:50176
v_mfma_f32_16x16x32_bf16 v[28:31], v[172:175], v[128:131], v[28:31]
ds_read_b64_tr_b16 v[204:205], v234 offset:49152
v_mfma_f32_16x16x32_bf16 v[32:35], v[144:147], v[132:135], v[32:35]
ds_read_b64_tr_b16 v[206:207], v234 offset:50176
v_mfma_f32_16x16x32_bf16 v[36:39], v[148:151], v[132:135], v[36:39]
ds_read_b64_tr_b16 v[208:209], v231 offset:57344
v_mfma_f32_16x16x32_bf16 v[40:43], v[152:155], v[132:135], v[40:43]
ds_read_b64_tr_b16 v[210:211], v231 offset:58368
v_mfma_f32_16x16x32_bf16 v[44:47], v[156:159], v[132:135], v[44:47]
ds_read_b64_tr_b16 v[212:213], v232 offset:57344
v_mfma_f32_16x16x32_bf16 v[48:51], v[160:163], v[132:135], v[48:51]
ds_read_b64_tr_b16 v[214:215], v232 offset:58368
v_mfma_f32_16x16x32_bf16 v[52:55], v[164:167], v[132:135], v[52:55]
ds_read_b64_tr_b16 v[216:217], v233 offset:57344
v_mfma_f32_16x16x32_bf16 v[56:59], v[168:171], v[132:135], v[56:59]
ds_read_b64_tr_b16 v[218:219], v233 offset:58368
v_mfma_f32_16x16x32_bf16 v[60:63], v[172:175], v[132:135], v[60:63]
ds_read_b64_tr_b16 v[220:221], v234 offset:57344
v_mfma_f32_16x16x32_bf16 v[64:67], v[144:147], v[136:139], v[64:67]
ds_read_b64_tr_b16 v[222:223], v234 offset:58368
v_mfma_f32_16x16x32_bf16 v[68:71], v[148:151], v[136:139], v[68:71]
ds_read_b128 v[176:179], v230 offset:0
v_mfma_f32_16x16x32_bf16 v[72:75], v[152:155], v[136:139], v[72:75]
ds_read_b128 v[180:183], v230 offset:2048
v_mfma_f32_16x16x32_bf16 v[76:79], v[156:159], v[136:139], v[76:79]
ds_read_b128 v[184:187], v230 offset:4096
v_mfma_f32_16x16x32_bf16 v[80:83], v[160:163], v[136:139], v[80:83]
ds_read_b128 v[188:191], v230 offset:6144
v_mfma_f32_16x16x32_bf16 v[84:87], v[164:167], v[136:139], v[84:87]
v_mfma_f32_16x16x32_bf16 v[88:91], v[168:171], v[136:139], v[88:91]
v_mfma_f32_16x16x32_bf16 v[92:95], v[172:175], v[136:139], v[92:95]
v_mfma_f32_16x16x32_bf16 v[96:99], v[144:147], v[140:143], v[96:99]
v_mfma_f32_16x16x32_bf16 v[100:103], v[148:151], v[140:143], v[100:103]
v_mfma_f32_16x16x32_bf16 v[104:107], v[152:155], v[140:143], v[104:107]
v_mfma_f32_16x16x32_bf16 v[108:111], v[156:159], v[140:143], v[108:111]
v_mfma_f32_16x16x32_bf16 v[112:115], v[160:163], v[140:143], v[112:115]
v_mfma_f32_16x16x32_bf16 v[116:119], v[164:167], v[140:143], v[116:119]
v_mfma_f32_16x16x32_bf16 v[120:123], v[168:171], v[140:143], v[120:123]
v_mfma_f32_16x16x32_bf16 v[124:127], v[172:175], v[140:143], v[124:127]
s_waitcnt lgkmcnt(0)
v_mfma_f32_16x16x32_bf16 v[0:3], v[192:195], v[176:179], v[0:3]
v_mfma_f32_16x16x32_bf16 v[4:7], v[196:199], v[176:179], v[4:7]
v_mfma_f32_16x16x32_bf16 v[8:11], v[200:203], v[176:179], v[8:11]
v_mfma_f32_16x16x32_bf16 v[12:15], v[204:207], v[176:179], v[12:15]
v_mfma_f32_16x16x32_bf16 v[16:19], v[208:211], v[176:179], v[16:19]
v_mfma_f32_16x16x32_bf16 v[20:23], v[212:215], v[176:179], v[20:23]
v_mfma_f32_16x16x32_bf16 v[24:27], v[216:219], v[176:179], v[24:27]
v_mfma_f32_16x16x32_bf16 v[28:31], v[220:223], v[176:179], v[28:31]
v_mfma_f32_16x16x32_bf16 v[32:35], v[192:195], v[180:183], v[32:35]
v_mfma_f32_16x16x32_bf16 v[36:39], v[196:199], v[180:183], v[36:39]
v_mfma_f32_16x16x32_bf16 v[40:43], v[200:203], v[180:183], v[40:43]
v_mfma_f32_16x16x32_bf16 v[44:47], v[204:207], v[180:183], v[44:47]
v_mfma_f32_16x16x32_bf16 v[48:51], v[208:211], v[180:183], v[48:51]
v_mfma_f32_16x16x32_bf16 v[52:55], v[212:215], v[180:183], v[52:55]
v_mfma_f32_16x16x32_bf16 v[56:59], v[216:219], v[180:183], v[56:59]
v_mfma_f32_16x16x32_bf16 v[60:63], v[220:223], v[180:183], v[60:63]
v_mfma_f32_16x16x32_bf16 v[64:67], v[192:195], v[184:187], v[64:67]
v_mfma_f32_16x16x32_bf16 v[68:71], v[196:199], v[184:187], v[68:71]
v_mfma_f32_16x16x32_bf16 v[72:75], v[200:203], v[184:187], v[72:75]
v_mfma_f32_16x16x32_bf16 v[76:79], v[204:207], v[184:187], v[76:79]
v_mfma_f32_16x16x32_bf16 v[80:83], v[208:211], v[184:187], v[80:83]
v_mfma_f32_16x16x32_bf16 v[84:87], v[212:215], v[184:187], v[84:87]
v_mfma_f32_16x16x32_bf16 v[88:91], v[216:219], v[184:187], v[88:91]
v_mfma_f32_16x16x32_bf16 v[92:95], v[220:223], v[184:187], v[92:95]
v_mfma_f32_16x16x32_bf16 v[96:99], v[192:195], v[188:191], v[96:99]
v_mfma_f32_16x16x32_bf16 v[100:103], v[196:199], v[188:191], v[100:103]
v_mfma_f32_16x16x32_bf16 v[104:107], v[200:203], v[188:191], v[104:107]
v_mfma_f32_16x16x32_bf16 v[108:111], v[204:207], v[188:191], v[108:111]
v_mfma_f32_16x16x32_bf16 v[112:115], v[208:211], v[188:191], v[112:115]
v_mfma_f32_16x16x32_bf16 v[116:119], v[212:215], v[188:191], v[116:119]
v_mfma_f32_16x16x32_bf16 v[120:123], v[216:219], v[188:191], v[120:123]
v_mfma_f32_16x16x32_bf16 v[124:127], v[220:223], v[188:191], v[124:127]
s_waitcnt vmcnt(11)
s_load_dwordx2 s[64:65], s[0:1], 72
v_lshlrev_b32 v224, 4, v235
s_lshl_b32 s82, s2, 15
s_lshl_b32 s83, s24, 12
s_add_u32 s82, s82, s83
s_waitcnt lgkmcnt(0)
s_mov_b32 s60, s64
s_and_b32 s61, s65, 0xffff
s_mov_b32 s62, 7340032
s_mov_b32 s63, 0x20000
buffer_load_dwordx4 v[228:231], v224, s[60:63], s82 offen offset:0
buffer_load_dwordx4 v[228:231], v224, s[60:63], s82 offen offset:1024
buffer_load_dwordx4 v[228:231], v224, s[60:63], s82 offen offset:2048
buffer_load_dwordx4 v[228:231], v224, s[60:63], s82 offen offset:3072
v_lshlrev_b32 v152, 2, v235
s_lshl_b32 s30, s24, 9
s_add_u32 s30, s30, 115712
v_add_u32 v152, s30, v152
ds_write_b32 v152, v244
ds_write_b32 v152, v245 offset:256
v_lshrrev_b32 v153, 4, v235
v_lshlrev_b32 v153, 4, v153
v_add_u32 v153, s30, v153
s_waitcnt lgkmcnt(0)
ds_read_b128 v[176:179], v153 offset:0
ds_read_b128 v[180:183], v153 offset:64
ds_read_b128 v[184:187], v153 offset:128
ds_read_b128 v[188:191], v153 offset:192
ds_read_b128 v[192:195], v153 offset:256
ds_read_b128 v[196:199], v153 offset:320
ds_read_b128 v[200:203], v153 offset:384
ds_read_b128 v[204:207], v153 offset:448
v_lshrrev_b32 v154, 4, v235
v_and_b32 v155, 1, v154
v_lshlrev_b32 v155, 10, v155
v_lshrrev_b32 v154, 1, v154
v_lshlrev_b32 v154, 8, v154
v_add_u32 v155, v155, v154
v_and_b32 v154, 15, v235
v_lshlrev_b32 v154, 4, v154
v_add_u32 v155, v155, v154
s_mul_i32 s38, s33, 7
s_lshl_b32 s39, s32, 1
s_lshr_b32 s30, s35, 1
s_add_u32 s39, s39, s30
s_mul_i32 s39, s39, 917504
s_and_b32 s30, s35, 1
s_lshl_b32 s30, s30, 12
s_add_u32 s39, s39, s30
s_add_u32 s39, s39, 16777216
s_mov_b32 s83, 0xbfb8aa3b
v_mul_f32 v136, s83, v237
v_mul_f32 v137, v237, v237
v_mul_f32 v138, s83, v239
v_mul_f32 v139, v239, v239
v_mul_f32 v140, s83, v241
v_mul_f32 v141, v241, v241
v_mul_f32 v142, s83, v243
v_mul_f32 v143, v243, v243
s_waitcnt lgkmcnt(0)
v_pk_fma_f32 v[0:1], v[236:237], v[176:177], v[0:1] op_sel_hi:[0,1,1] neg_lo:[1,0,0] neg_hi:[1,0,0]
v_pk_fma_f32 v[16:17], v[236:237], v[192:193], v[16:17] op_sel_hi:[0,1,1] neg_lo:[1,0,0] neg_hi:[1,0,0]
v_pk_fma_f32 v[2:3], v[236:237], v[178:179], v[2:3] op_sel_hi:[0,1,1] neg_lo:[1,0,0] neg_hi:[1,0,0]
v_pk_fma_f32 v[18:19], v[236:237], v[194:195], v[18:19] op_sel_hi:[0,1,1] neg_lo:[1,0,0] neg_hi:[1,0,0]
v_pk_fma_f32 v[4:5], v[236:237], v[180:181], v[4:5] op_sel_hi:[0,1,1] neg_lo:[1,0,0] neg_hi:[1,0,0]
v_pk_fma_f32 v[20:21], v[236:237], v[196:197], v[20:21] op_sel_hi:[0,1,1] neg_lo:[1,0,0] neg_hi:[1,0,0]
v_pk_fma_f32 v[6:7], v[236:237], v[182:183], v[6:7] op_sel_hi:[0,1,1] neg_lo:[1,0,0] neg_hi:[1,0,0]
v_pk_fma_f32 v[22:23], v[236:237], v[198:199], v[22:23] op_sel_hi:[0,1,1] neg_lo:[1,0,0] neg_hi:[1,0,0]
v_pk_fma_f32 v[8:9], v[236:237], v[184:185], v[8:9] op_sel_hi:[0,1,1] neg_lo:[1,0,0] neg_hi:[1,0,0]
v_pk_fma_f32 v[24:25], v[236:237], v[200:201], v[24:25] op_sel_hi:[0,1,1] neg_lo:[1,0,0] neg_hi:[1,0,0]
v_pk_fma_f32 v[10:11], v[236:237], v[186:187], v[10:11] op_sel_hi:[0,1,1] neg_lo:[1,0,0] neg_hi:[1,0,0]
v_pk_fma_f32 v[26:27], v[236:237], v[202:203], v[26:27] op_sel_hi:[0,1,1] neg_lo:[1,0,0] neg_hi:[1,0,0]
v_pk_fma_f32 v[12:13], v[236:237], v[188:189], v[12:13] op_sel_hi:[0,1,1] neg_lo:[1,0,0] neg_hi:[1,0,0]
v_pk_fma_f32 v[28:29], v[236:237], v[204:205], v[28:29] op_sel_hi:[0,1,1] neg_lo:[1,0,0] neg_hi:[1,0,0]
v_pk_fma_f32 v[14:15], v[236:237], v[190:191], v[14:15] op_sel_hi:[0,1,1] neg_lo:[1,0,0] neg_hi:[1,0,0]
v_pk_fma_f32 v[30:31], v[236:237], v[206:207], v[30:31] op_sel_hi:[0,1,1] neg_lo:[1,0,0] neg_hi:[1,0,0]
v_pk_mul_f32 v[156:157], v[0:1], v[136:137] op_sel_hi:[1,0]
v_pk_mul_f32 v[158:159], v[2:3], v[136:137] op_sel_hi:[1,0]
v_pk_mul_f32 v[160:161], v[4:5], v[136:137] op_sel_hi:[1,0]
v_pk_mul_f32 v[162:163], v[6:7], v[136:137] op_sel_hi:[1,0]
v_pk_mul_f32 v[164:165], v[8:9], v[136:137] op_sel_hi:[1,0]
v_pk_mul_f32 v[166:167], v[10:11], v[136:137] op_sel_hi:[1,0]
v_pk_mul_f32 v[168:169], v[12:13], v[136:137] op_sel_hi:[1,0]
v_pk_mul_f32 v[170:171], v[14:15], v[136:137] op_sel_hi:[1,0]
v_exp_f32 v156, v156
v_exp_f32 v157, v157
v_exp_f32 v158, v158
v_exp_f32 v159, v159
v_exp_f32 v160, v160
v_exp_f32 v161, v161
v_exp_f32 v162, v162
v_exp_f32 v163, v163
v_exp_f32 v164, v164
v_exp_f32 v165, v165
v_exp_f32 v166, v166
v_exp_f32 v167, v167
v_exp_f32 v168, v168
v_exp_f32 v169, v169
v_exp_f32 v170, v170
v_exp_f32 v171, v171
v_pk_mul_f32 v[208:209], v[0:1], v[16:17]
v_pk_mul_f32 v[210:211], v[2:3], v[18:19]
v_pk_mul_f32 v[212:213], v[4:5], v[20:21]
v_pk_mul_f32 v[214:215], v[6:7], v[22:23]
v_pk_mul_f32 v[216:217], v[8:9], v[24:25]
v_pk_mul_f32 v[218:219], v[10:11], v[26:27]
v_pk_mul_f32 v[220:221], v[12:13], v[28:29]
v_pk_mul_f32 v[222:223], v[14:15], v[30:31]
v_pk_add_f32 v[156:157], v[156:157], 1.0 op_sel_hi:[1,0]
v_pk_add_f32 v[158:159], v[158:159], 1.0 op_sel_hi:[1,0]
v_pk_add_f32 v[160:161], v[160:161], 1.0 op_sel_hi:[1,0]
v_pk_add_f32 v[162:163], v[162:163], 1.0 op_sel_hi:[1,0]
v_pk_add_f32 v[164:165], v[164:165], 1.0 op_sel_hi:[1,0]
v_pk_add_f32 v[166:167], v[166:167], 1.0 op_sel_hi:[1,0]
v_pk_add_f32 v[168:169], v[168:169], 1.0 op_sel_hi:[1,0]
v_pk_add_f32 v[170:171], v[170:171], 1.0 op_sel_hi:[1,0]
v_rcp_f32 v156, v156
v_rcp_f32 v157, v157
v_rcp_f32 v158, v158
v_rcp_f32 v159, v159
v_rcp_f32 v160, v160
v_rcp_f32 v161, v161
v_rcp_f32 v162, v162
v_rcp_f32 v163, v163
v_rcp_f32 v164, v164
v_rcp_f32 v165, v165
v_rcp_f32 v166, v166
v_rcp_f32 v167, v167
v_rcp_f32 v168, v168
v_rcp_f32 v169, v169
v_rcp_f32 v170, v170
v_rcp_f32 v171, v171
v_pk_mul_f32 v[208:209], v[208:209], v[136:137] op_sel:[0,1] op_sel_hi:[1,1]
v_pk_mul_f32 v[210:211], v[210:211], v[136:137] op_sel:[0,1] op_sel_hi:[1,1]
v_pk_mul_f32 v[212:213], v[212:213], v[136:137] op_sel:[0,1] op_sel_hi:[1,1]
v_pk_mul_f32 v[214:215], v[214:215], v[136:137] op_sel:[0,1] op_sel_hi:[1,1]
v_pk_mul_f32 v[216:217], v[216:217], v[136:137] op_sel:[0,1] op_sel_hi:[1,1]
v_pk_mul_f32 v[218:219], v[218:219], v[136:137] op_sel:[0,1] op_sel_hi:[1,1]
v_pk_mul_f32 v[220:221], v[220:221], v[136:137] op_sel:[0,1] op_sel_hi:[1,1]
v_pk_mul_f32 v[222:223], v[222:223], v[136:137] op_sel:[0,1] op_sel_hi:[1,1]
v_pk_mul_f32 v[208:209], v[208:209], v[156:157]
v_pk_mul_f32 v[210:211], v[210:211], v[158:159]
v_pk_mul_f32 v[212:213], v[212:213], v[160:161]
v_pk_mul_f32 v[214:215], v[214:215], v[162:163]
v_pk_mul_f32 v[216:217], v[216:217], v[164:165]
v_pk_mul_f32 v[218:219], v[218:219], v[166:167]
v_pk_mul_f32 v[220:221], v[220:221], v[168:169]
v_pk_mul_f32 v[222:223], v[222:223], v[170:171]
v_cvt_pk_bf16_f32 v0, v208, v209
v_cvt_pk_bf16_f32 v1, v210, v211
v_cvt_pk_bf16_f32 v4, v212, v213
v_cvt_pk_bf16_f32 v5, v214, v215
v_cvt_pk_bf16_f32 v8, v216, v217
v_cvt_pk_bf16_f32 v9, v218, v219
v_cvt_pk_bf16_f32 v12, v220, v221
v_cvt_pk_bf16_f32 v13, v222, v223
v_pk_fma_f32 v[32:33], v[238:239], v[176:177], v[32:33] op_sel_hi:[0,1,1] neg_lo:[1,0,0] neg_hi:[1,0,0]
v_pk_fma_f32 v[48:49], v[238:239], v[192:193], v[48:49] op_sel_hi:[0,1,1] neg_lo:[1,0,0] neg_hi:[1,0,0]
v_pk_fma_f32 v[34:35], v[238:239], v[178:179], v[34:35] op_sel_hi:[0,1,1] neg_lo:[1,0,0] neg_hi:[1,0,0]
v_pk_fma_f32 v[50:51], v[238:239], v[194:195], v[50:51] op_sel_hi:[0,1,1] neg_lo:[1,0,0] neg_hi:[1,0,0]
v_pk_fma_f32 v[36:37], v[238:239], v[180:181], v[36:37] op_sel_hi:[0,1,1] neg_lo:[1,0,0] neg_hi:[1,0,0]
v_pk_fma_f32 v[52:53], v[238:239], v[196:197], v[52:53] op_sel_hi:[0,1,1] neg_lo:[1,0,0] neg_hi:[1,0,0]
v_pk_fma_f32 v[38:39], v[238:239], v[182:183], v[38:39] op_sel_hi:[0,1,1] neg_lo:[1,0,0] neg_hi:[1,0,0]
v_pk_fma_f32 v[54:55], v[238:239], v[198:199], v[54:55] op_sel_hi:[0,1,1] neg_lo:[1,0,0] neg_hi:[1,0,0]
v_pk_fma_f32 v[40:41], v[238:239], v[184:185], v[40:41] op_sel_hi:[0,1,1] neg_lo:[1,0,0] neg_hi:[1,0,0]
v_pk_fma_f32 v[56:57], v[238:239], v[200:201], v[56:57] op_sel_hi:[0,1,1] neg_lo:[1,0,0] neg_hi:[1,0,0]
v_pk_fma_f32 v[42:43], v[238:239], v[186:187], v[42:43] op_sel_hi:[0,1,1] neg_lo:[1,0,0] neg_hi:[1,0,0]
v_pk_fma_f32 v[58:59], v[238:239], v[202:203], v[58:59] op_sel_hi:[0,1,1] neg_lo:[1,0,0] neg_hi:[1,0,0]
v_pk_fma_f32 v[44:45], v[238:239], v[188:189], v[44:45] op_sel_hi:[0,1,1] neg_lo:[1,0,0] neg_hi:[1,0,0]
v_pk_fma_f32 v[60:61], v[238:239], v[204:205], v[60:61] op_sel_hi:[0,1,1] neg_lo:[1,0,0] neg_hi:[1,0,0]
v_pk_fma_f32 v[46:47], v[238:239], v[190:191], v[46:47] op_sel_hi:[0,1,1] neg_lo:[1,0,0] neg_hi:[1,0,0]
v_pk_fma_f32 v[62:63], v[238:239], v[206:207], v[62:63] op_sel_hi:[0,1,1] neg_lo:[1,0,0] neg_hi:[1,0,0]
v_pk_mul_f32 v[156:157], v[32:33], v[138:139] op_sel_hi:[1,0]
v_pk_mul_f32 v[158:159], v[34:35], v[138:139] op_sel_hi:[1,0]
v_pk_mul_f32 v[160:161], v[36:37], v[138:139] op_sel_hi:[1,0]
v_pk_mul_f32 v[162:163], v[38:39], v[138:139] op_sel_hi:[1,0]
v_pk_mul_f32 v[164:165], v[40:41], v[138:139] op_sel_hi:[1,0]
v_pk_mul_f32 v[166:167], v[42:43], v[138:139] op_sel_hi:[1,0]
v_pk_mul_f32 v[168:169], v[44:45], v[138:139] op_sel_hi:[1,0]
v_pk_mul_f32 v[170:171], v[46:47], v[138:139] op_sel_hi:[1,0]
v_exp_f32 v156, v156
v_exp_f32 v157, v157
v_exp_f32 v158, v158
v_exp_f32 v159, v159
v_exp_f32 v160, v160
v_exp_f32 v161, v161
v_exp_f32 v162, v162
v_exp_f32 v163, v163
v_exp_f32 v164, v164
v_exp_f32 v165, v165
v_exp_f32 v166, v166
v_exp_f32 v167, v167
v_exp_f32 v168, v168
v_exp_f32 v169, v169
v_exp_f32 v170, v170
v_exp_f32 v171, v171
v_pk_mul_f32 v[208:209], v[32:33], v[48:49]
v_pk_mul_f32 v[210:211], v[34:35], v[50:51]
v_pk_mul_f32 v[212:213], v[36:37], v[52:53]
v_pk_mul_f32 v[214:215], v[38:39], v[54:55]
v_pk_mul_f32 v[216:217], v[40:41], v[56:57]
v_pk_mul_f32 v[218:219], v[42:43], v[58:59]
v_pk_mul_f32 v[220:221], v[44:45], v[60:61]
v_pk_mul_f32 v[222:223], v[46:47], v[62:63]
v_pk_add_f32 v[156:157], v[156:157], 1.0 op_sel_hi:[1,0]
v_pk_add_f32 v[158:159], v[158:159], 1.0 op_sel_hi:[1,0]
v_pk_add_f32 v[160:161], v[160:161], 1.0 op_sel_hi:[1,0]
v_pk_add_f32 v[162:163], v[162:163], 1.0 op_sel_hi:[1,0]
v_pk_add_f32 v[164:165], v[164:165], 1.0 op_sel_hi:[1,0]
v_pk_add_f32 v[166:167], v[166:167], 1.0 op_sel_hi:[1,0]
v_pk_add_f32 v[168:169], v[168:169], 1.0 op_sel_hi:[1,0]
v_pk_add_f32 v[170:171], v[170:171], 1.0 op_sel_hi:[1,0]
v_rcp_f32 v156, v156
v_rcp_f32 v157, v157
v_rcp_f32 v158, v158
v_rcp_f32 v159, v159
v_rcp_f32 v160, v160
v_rcp_f32 v161, v161
v_rcp_f32 v162, v162
v_rcp_f32 v163, v163
v_rcp_f32 v164, v164
v_rcp_f32 v165, v165
v_rcp_f32 v166, v166
v_rcp_f32 v167, v167
v_rcp_f32 v168, v168
v_rcp_f32 v169, v169
v_rcp_f32 v170, v170
v_rcp_f32 v171, v171
v_pk_mul_f32 v[208:209], v[208:209], v[138:139] op_sel:[0,1] op_sel_hi:[1,1]
v_pk_mul_f32 v[210:211], v[210:211], v[138:139] op_sel:[0,1] op_sel_hi:[1,1]
v_pk_mul_f32 v[212:213], v[212:213], v[138:139] op_sel:[0,1] op_sel_hi:[1,1]
v_pk_mul_f32 v[214:215], v[214:215], v[138:139] op_sel:[0,1] op_sel_hi:[1,1]
v_pk_mul_f32 v[216:217], v[216:217], v[138:139] op_sel:[0,1] op_sel_hi:[1,1]
v_pk_mul_f32 v[218:219], v[218:219], v[138:139] op_sel:[0,1] op_sel_hi:[1,1]
v_pk_mul_f32 v[220:221], v[220:221], v[138:139] op_sel:[0,1] op_sel_hi:[1,1]
v_pk_mul_f32 v[222:223], v[222:223], v[138:139] op_sel:[0,1] op_sel_hi:[1,1]
v_pk_mul_f32 v[208:209], v[208:209], v[156:157]
v_pk_mul_f32 v[210:211], v[210:211], v[158:159]
v_pk_mul_f32 v[212:213], v[212:213], v[160:161]
v_pk_mul_f32 v[214:215], v[214:215], v[162:163]
v_pk_mul_f32 v[216:217], v[216:217], v[164:165]
v_pk_mul_f32 v[218:219], v[218:219], v[166:167]
v_pk_mul_f32 v[220:221], v[220:221], v[168:169]
v_pk_mul_f32 v[222:223], v[222:223], v[170:171]
v_cvt_pk_bf16_f32 v32, v208, v209
v_cvt_pk_bf16_f32 v33, v210, v211
v_cvt_pk_bf16_f32 v36, v212, v213
v_cvt_pk_bf16_f32 v37, v214, v215
v_cvt_pk_bf16_f32 v40, v216, v217
v_cvt_pk_bf16_f32 v41, v218, v219
v_cvt_pk_bf16_f32 v44, v220, v221
v_cvt_pk_bf16_f32 v45, v222, v223
v_mov_b32 v2, v32
v_mov_b32 v3, v33
s_add_u32 s30, s38, 0
s_lshr_b32 s31, s30, 1
s_lshl_b32 s31, s31, 13
v_permlane16_swap_b32 v0, v2
v_permlane16_swap_b32 v1, v3
s_and_b32 s30, s30, 1
s_lshl_b32 s30, s30, 9
s_add_u32 s30, s30, s31
s_add_u32 s30, s30, s39
buffer_store_dwordx4 v[0:3], v155, s[12:15], s30 offen offset:0 sc1
v_mov_b32 v6, v36
v_mov_b32 v7, v37
s_add_u32 s30, s38, 1
s_lshr_b32 s31, s30, 1
s_lshl_b32 s31, s31, 13
v_permlane16_swap_b32 v4, v6
v_permlane16_swap_b32 v5, v7
s_and_b32 s30, s30, 1
s_lshl_b32 s30, s30, 9
s_add_u32 s30, s30, s31
s_add_u32 s30, s30, s39
buffer_store_dwordx4 v[4:7], v155, s[12:15], s30 offen offset:0 sc1
v_mov_b32 v10, v40
v_mov_b32 v11, v41
s_add_u32 s30, s38, 2
s_lshr_b32 s31, s30, 1
s_lshl_b32 s31, s31, 13
v_permlane16_swap_b32 v8, v10
v_permlane16_swap_b32 v9, v11
s_and_b32 s30, s30, 1
s_lshl_b32 s30, s30, 9
s_add_u32 s30, s30, s31
s_add_u32 s30, s30, s39
buffer_store_dwordx4 v[8:11], v155, s[12:15], s30 offen offset:0 sc1
v_mov_b32 v14, v44
v_mov_b32 v15, v45
s_add_u32 s30, s38, 3
s_lshr_b32 s31, s30, 1
s_lshl_b32 s31, s31, 13
v_permlane16_swap_b32 v12, v14
v_permlane16_swap_b32 v13, v15
s_and_b32 s30, s30, 1
s_lshl_b32 s30, s30, 9
s_add_u32 s30, s30, s31
s_add_u32 s30, s30, s39
buffer_store_dwordx4 v[12:15], v155, s[12:15], s30 offen offset:0 sc1
v_pk_fma_f32 v[64:65], v[240:241], v[176:177], v[64:65] op_sel_hi:[0,1,1] neg_lo:[1,0,0] neg_hi:[1,0,0]
v_pk_fma_f32 v[80:81], v[240:241], v[192:193], v[80:81] op_sel_hi:[0,1,1] neg_lo:[1,0,0] neg_hi:[1,0,0]
v_pk_fma_f32 v[66:67], v[240:241], v[178:179], v[66:67] op_sel_hi:[0,1,1] neg_lo:[1,0,0] neg_hi:[1,0,0]
v_pk_fma_f32 v[82:83], v[240:241], v[194:195], v[82:83] op_sel_hi:[0,1,1] neg_lo:[1,0,0] neg_hi:[1,0,0]
v_pk_fma_f32 v[68:69], v[240:241], v[180:181], v[68:69] op_sel_hi:[0,1,1] neg_lo:[1,0,0] neg_hi:[1,0,0]
v_pk_fma_f32 v[84:85], v[240:241], v[196:197], v[84:85] op_sel_hi:[0,1,1] neg_lo:[1,0,0] neg_hi:[1,0,0]
v_pk_fma_f32 v[70:71], v[240:241], v[182:183], v[70:71] op_sel_hi:[0,1,1] neg_lo:[1,0,0] neg_hi:[1,0,0]
v_pk_fma_f32 v[86:87], v[240:241], v[198:199], v[86:87] op_sel_hi:[0,1,1] neg_lo:[1,0,0] neg_hi:[1,0,0]
v_pk_fma_f32 v[72:73], v[240:241], v[184:185], v[72:73] op_sel_hi:[0,1,1] neg_lo:[1,0,0] neg_hi:[1,0,0]
v_pk_fma_f32 v[88:89], v[240:241], v[200:201], v[88:89] op_sel_hi:[0,1,1] neg_lo:[1,0,0] neg_hi:[1,0,0]
v_pk_fma_f32 v[74:75], v[240:241], v[186:187], v[74:75] op_sel_hi:[0,1,1] neg_lo:[1,0,0] neg_hi:[1,0,0]
v_pk_fma_f32 v[90:91], v[240:241], v[202:203], v[90:91] op_sel_hi:[0,1,1] neg_lo:[1,0,0] neg_hi:[1,0,0]
v_pk_fma_f32 v[76:77], v[240:241], v[188:189], v[76:77] op_sel_hi:[0,1,1] neg_lo:[1,0,0] neg_hi:[1,0,0]
v_pk_fma_f32 v[92:93], v[240:241], v[204:205], v[92:93] op_sel_hi:[0,1,1] neg_lo:[1,0,0] neg_hi:[1,0,0]
v_pk_fma_f32 v[78:79], v[240:241], v[190:191], v[78:79] op_sel_hi:[0,1,1] neg_lo:[1,0,0] neg_hi:[1,0,0]
v_pk_fma_f32 v[94:95], v[240:241], v[206:207], v[94:95] op_sel_hi:[0,1,1] neg_lo:[1,0,0] neg_hi:[1,0,0]
v_pk_mul_f32 v[156:157], v[64:65], v[140:141] op_sel_hi:[1,0]
v_pk_mul_f32 v[158:159], v[66:67], v[140:141] op_sel_hi:[1,0]
v_pk_mul_f32 v[160:161], v[68:69], v[140:141] op_sel_hi:[1,0]
v_pk_mul_f32 v[162:163], v[70:71], v[140:141] op_sel_hi:[1,0]
v_pk_mul_f32 v[164:165], v[72:73], v[140:141] op_sel_hi:[1,0]
v_pk_mul_f32 v[166:167], v[74:75], v[140:141] op_sel_hi:[1,0]
v_pk_mul_f32 v[168:169], v[76:77], v[140:141] op_sel_hi:[1,0]
v_pk_mul_f32 v[170:171], v[78:79], v[140:141] op_sel_hi:[1,0]
v_exp_f32 v156, v156
v_exp_f32 v157, v157
v_exp_f32 v158, v158
v_exp_f32 v159, v159
v_exp_f32 v160, v160
v_exp_f32 v161, v161
v_exp_f32 v162, v162
v_exp_f32 v163, v163
v_exp_f32 v164, v164
v_exp_f32 v165, v165
v_exp_f32 v166, v166
v_exp_f32 v167, v167
v_exp_f32 v168, v168
v_exp_f32 v169, v169
v_exp_f32 v170, v170
v_exp_f32 v171, v171
v_pk_mul_f32 v[208:209], v[64:65], v[80:81]
v_pk_mul_f32 v[210:211], v[66:67], v[82:83]
v_pk_mul_f32 v[212:213], v[68:69], v[84:85]
v_pk_mul_f32 v[214:215], v[70:71], v[86:87]
v_pk_mul_f32 v[216:217], v[72:73], v[88:89]
v_pk_mul_f32 v[218:219], v[74:75], v[90:91]
v_pk_mul_f32 v[220:221], v[76:77], v[92:93]
v_pk_mul_f32 v[222:223], v[78:79], v[94:95]
v_pk_add_f32 v[156:157], v[156:157], 1.0 op_sel_hi:[1,0]
v_pk_add_f32 v[158:159], v[158:159], 1.0 op_sel_hi:[1,0]
v_pk_add_f32 v[160:161], v[160:161], 1.0 op_sel_hi:[1,0]
v_pk_add_f32 v[162:163], v[162:163], 1.0 op_sel_hi:[1,0]
v_pk_add_f32 v[164:165], v[164:165], 1.0 op_sel_hi:[1,0]
v_pk_add_f32 v[166:167], v[166:167], 1.0 op_sel_hi:[1,0]
v_pk_add_f32 v[168:169], v[168:169], 1.0 op_sel_hi:[1,0]
v_pk_add_f32 v[170:171], v[170:171], 1.0 op_sel_hi:[1,0]
v_rcp_f32 v156, v156
v_rcp_f32 v157, v157
v_rcp_f32 v158, v158
v_rcp_f32 v159, v159
v_rcp_f32 v160, v160
v_rcp_f32 v161, v161
v_rcp_f32 v162, v162
v_rcp_f32 v163, v163
v_rcp_f32 v164, v164
v_rcp_f32 v165, v165
v_rcp_f32 v166, v166
v_rcp_f32 v167, v167
v_rcp_f32 v168, v168
v_rcp_f32 v169, v169
v_rcp_f32 v170, v170
v_rcp_f32 v171, v171
v_pk_mul_f32 v[208:209], v[208:209], v[140:141] op_sel:[0,1] op_sel_hi:[1,1]
v_pk_mul_f32 v[210:211], v[210:211], v[140:141] op_sel:[0,1] op_sel_hi:[1,1]
v_pk_mul_f32 v[212:213], v[212:213], v[140:141] op_sel:[0,1] op_sel_hi:[1,1]
v_pk_mul_f32 v[214:215], v[214:215], v[140:141] op_sel:[0,1] op_sel_hi:[1,1]
v_pk_mul_f32 v[216:217], v[216:217], v[140:141] op_sel:[0,1] op_sel_hi:[1,1]
v_pk_mul_f32 v[218:219], v[218:219], v[140:141] op_sel:[0,1] op_sel_hi:[1,1]
v_pk_mul_f32 v[220:221], v[220:221], v[140:141] op_sel:[0,1] op_sel_hi:[1,1]
v_pk_mul_f32 v[222:223], v[222:223], v[140:141] op_sel:[0,1] op_sel_hi:[1,1]
v_pk_mul_f32 v[208:209], v[208:209], v[156:157]
v_pk_mul_f32 v[210:211], v[210:211], v[158:159]
v_pk_mul_f32 v[212:213], v[212:213], v[160:161]
v_pk_mul_f32 v[214:215], v[214:215], v[162:163]
v_pk_mul_f32 v[216:217], v[216:217], v[164:165]
v_pk_mul_f32 v[218:219], v[218:219], v[166:167]
v_pk_mul_f32 v[220:221], v[220:221], v[168:169]
v_pk_mul_f32 v[222:223], v[222:223], v[170:171]
v_cvt_pk_bf16_f32 v64, v208, v209
v_cvt_pk_bf16_f32 v65, v210, v211
v_cvt_pk_bf16_f32 v68, v212, v213
v_cvt_pk_bf16_f32 v69, v214, v215
v_cvt_pk_bf16_f32 v72, v216, v217
v_cvt_pk_bf16_f32 v73, v218, v219
v_cvt_pk_bf16_f32 v76, v220, v221
v_cvt_pk_bf16_f32 v77, v222, v223
v_pk_fma_f32 v[96:97], v[242:243], v[176:177], v[96:97] op_sel_hi:[0,1,1] neg_lo:[1,0,0] neg_hi:[1,0,0]
v_pk_fma_f32 v[112:113], v[242:243], v[192:193], v[112:113] op_sel_hi:[0,1,1] neg_lo:[1,0,0] neg_hi:[1,0,0]
v_pk_fma_f32 v[98:99], v[242:243], v[178:179], v[98:99] op_sel_hi:[0,1,1] neg_lo:[1,0,0] neg_hi:[1,0,0]
v_pk_fma_f32 v[114:115], v[242:243], v[194:195], v[114:115] op_sel_hi:[0,1,1] neg_lo:[1,0,0] neg_hi:[1,0,0]
v_pk_fma_f32 v[100:101], v[242:243], v[180:181], v[100:101] op_sel_hi:[0,1,1] neg_lo:[1,0,0] neg_hi:[1,0,0]
v_pk_fma_f32 v[116:117], v[242:243], v[196:197], v[116:117] op_sel_hi:[0,1,1] neg_lo:[1,0,0] neg_hi:[1,0,0]
v_pk_fma_f32 v[102:103], v[242:243], v[182:183], v[102:103] op_sel_hi:[0,1,1] neg_lo:[1,0,0] neg_hi:[1,0,0]
v_pk_fma_f32 v[118:119], v[242:243], v[198:199], v[118:119] op_sel_hi:[0,1,1] neg_lo:[1,0,0] neg_hi:[1,0,0]
v_pk_fma_f32 v[104:105], v[242:243], v[184:185], v[104:105] op_sel_hi:[0,1,1] neg_lo:[1,0,0] neg_hi:[1,0,0]
v_pk_fma_f32 v[120:121], v[242:243], v[200:201], v[120:121] op_sel_hi:[0,1,1] neg_lo:[1,0,0] neg_hi:[1,0,0]
v_pk_fma_f32 v[106:107], v[242:243], v[186:187], v[106:107] op_sel_hi:[0,1,1] neg_lo:[1,0,0] neg_hi:[1,0,0]
v_pk_fma_f32 v[122:123], v[242:243], v[202:203], v[122:123] op_sel_hi:[0,1,1] neg_lo:[1,0,0] neg_hi:[1,0,0]
v_pk_fma_f32 v[108:109], v[242:243], v[188:189], v[108:109] op_sel_hi:[0,1,1] neg_lo:[1,0,0] neg_hi:[1,0,0]
v_pk_fma_f32 v[124:125], v[242:243], v[204:205], v[124:125] op_sel_hi:[0,1,1] neg_lo:[1,0,0] neg_hi:[1,0,0]
v_pk_fma_f32 v[110:111], v[242:243], v[190:191], v[110:111] op_sel_hi:[0,1,1] neg_lo:[1,0,0] neg_hi:[1,0,0]
v_pk_fma_f32 v[126:127], v[242:243], v[206:207], v[126:127] op_sel_hi:[0,1,1] neg_lo:[1,0,0] neg_hi:[1,0,0]
v_pk_mul_f32 v[156:157], v[96:97], v[142:143] op_sel_hi:[1,0]
v_pk_mul_f32 v[158:159], v[98:99], v[142:143] op_sel_hi:[1,0]
v_pk_mul_f32 v[160:161], v[100:101], v[142:143] op_sel_hi:[1,0]
v_pk_mul_f32 v[162:163], v[102:103], v[142:143] op_sel_hi:[1,0]
v_pk_mul_f32 v[164:165], v[104:105], v[142:143] op_sel_hi:[1,0]
v_pk_mul_f32 v[166:167], v[106:107], v[142:143] op_sel_hi:[1,0]
v_pk_mul_f32 v[168:169], v[108:109], v[142:143] op_sel_hi:[1,0]
v_pk_mul_f32 v[170:171], v[110:111], v[142:143] op_sel_hi:[1,0]
v_exp_f32 v156, v156
v_exp_f32 v157, v157
v_exp_f32 v158, v158
v_exp_f32 v159, v159
v_exp_f32 v160, v160
v_exp_f32 v161, v161
v_exp_f32 v162, v162
v_exp_f32 v163, v163
v_exp_f32 v164, v164
v_exp_f32 v165, v165
v_exp_f32 v166, v166
v_exp_f32 v167, v167
v_exp_f32 v168, v168
v_exp_f32 v169, v169
v_exp_f32 v170, v170
v_exp_f32 v171, v171
v_pk_mul_f32 v[208:209], v[96:97], v[112:113]
v_pk_mul_f32 v[210:211], v[98:99], v[114:115]
v_pk_mul_f32 v[212:213], v[100:101], v[116:117]
v_pk_mul_f32 v[214:215], v[102:103], v[118:119]
v_pk_mul_f32 v[216:217], v[104:105], v[120:121]
v_pk_mul_f32 v[218:219], v[106:107], v[122:123]
v_pk_mul_f32 v[220:221], v[108:109], v[124:125]
v_pk_mul_f32 v[222:223], v[110:111], v[126:127]
v_pk_add_f32 v[156:157], v[156:157], 1.0 op_sel_hi:[1,0]
v_pk_add_f32 v[158:159], v[158:159], 1.0 op_sel_hi:[1,0]
v_pk_add_f32 v[160:161], v[160:161], 1.0 op_sel_hi:[1,0]
v_pk_add_f32 v[162:163], v[162:163], 1.0 op_sel_hi:[1,0]
v_pk_add_f32 v[164:165], v[164:165], 1.0 op_sel_hi:[1,0]
v_pk_add_f32 v[166:167], v[166:167], 1.0 op_sel_hi:[1,0]
v_pk_add_f32 v[168:169], v[168:169], 1.0 op_sel_hi:[1,0]
v_pk_add_f32 v[170:171], v[170:171], 1.0 op_sel_hi:[1,0]
v_rcp_f32 v156, v156
v_rcp_f32 v157, v157
v_rcp_f32 v158, v158
v_rcp_f32 v159, v159
v_rcp_f32 v160, v160
v_rcp_f32 v161, v161
v_rcp_f32 v162, v162
v_rcp_f32 v163, v163
v_rcp_f32 v164, v164
v_rcp_f32 v165, v165
v_rcp_f32 v166, v166
v_rcp_f32 v167, v167
v_rcp_f32 v168, v168
v_rcp_f32 v169, v169
v_rcp_f32 v170, v170
v_rcp_f32 v171, v171
v_pk_mul_f32 v[208:209], v[208:209], v[142:143] op_sel:[0,1] op_sel_hi:[1,1]
v_pk_mul_f32 v[210:211], v[210:211], v[142:143] op_sel:[0,1] op_sel_hi:[1,1]
v_pk_mul_f32 v[212:213], v[212:213], v[142:143] op_sel:[0,1] op_sel_hi:[1,1]
v_pk_mul_f32 v[214:215], v[214:215], v[142:143] op_sel:[0,1] op_sel_hi:[1,1]
v_pk_mul_f32 v[216:217], v[216:217], v[142:143] op_sel:[0,1] op_sel_hi:[1,1]
v_pk_mul_f32 v[218:219], v[218:219], v[142:143] op_sel:[0,1] op_sel_hi:[1,1]
v_pk_mul_f32 v[220:221], v[220:221], v[142:143] op_sel:[0,1] op_sel_hi:[1,1]
v_pk_mul_f32 v[222:223], v[222:223], v[142:143] op_sel:[0,1] op_sel_hi:[1,1]
v_pk_mul_f32 v[208:209], v[208:209], v[156:157]
v_pk_mul_f32 v[210:211], v[210:211], v[158:159]
v_pk_mul_f32 v[212:213], v[212:213], v[160:161]
v_pk_mul_f32 v[214:215], v[214:215], v[162:163]
v_pk_mul_f32 v[216:217], v[216:217], v[164:165]
v_pk_mul_f32 v[218:219], v[218:219], v[166:167]
v_pk_mul_f32 v[220:221], v[220:221], v[168:169]
v_pk_mul_f32 v[222:223], v[222:223], v[170:171]
v_cvt_pk_bf16_f32 v96, v208, v209
v_cvt_pk_bf16_f32 v97, v210, v211
v_cvt_pk_bf16_f32 v100, v212, v213
v_cvt_pk_bf16_f32 v101, v214, v215
v_cvt_pk_bf16_f32 v104, v216, v217
v_cvt_pk_bf16_f32 v105, v218, v219
v_cvt_pk_bf16_f32 v108, v220, v221
v_cvt_pk_bf16_f32 v109, v222, v223
v_mov_b32 v66, v96
v_mov_b32 v67, v97
s_add_u32 s30, s38, 0
s_lshr_b32 s31, s30, 1
s_lshl_b32 s31, s31, 13
v_permlane16_swap_b32 v64, v66
v_permlane16_swap_b32 v65, v67
s_and_b32 s30, s30, 1
s_lshl_b32 s30, s30, 9
s_add_u32 s30, s30, s31
s_add_u32 s30, s30, s39
buffer_store_dwordx4 v[64:67], v155, s[12:15], s30 offen offset:2048 sc1
v_mov_b32 v70, v100
v_mov_b32 v71, v101
s_add_u32 s30, s38, 1
s_lshr_b32 s31, s30, 1
s_lshl_b32 s31, s31, 13
v_permlane16_swap_b32 v68, v70
v_permlane16_swap_b32 v69, v71
s_and_b32 s30, s30, 1
s_lshl_b32 s30, s30, 9
s_add_u32 s30, s30, s31
s_add_u32 s30, s30, s39
buffer_store_dwordx4 v[68:71], v155, s[12:15], s30 offen offset:2048 sc1
v_mov_b32 v74, v104
v_mov_b32 v75, v105
s_add_u32 s30, s38, 2
s_lshr_b32 s31, s30, 1
s_lshl_b32 s31, s31, 13
v_permlane16_swap_b32 v72, v74
v_permlane16_swap_b32 v73, v75
s_and_b32 s30, s30, 1
s_lshl_b32 s30, s30, 9
s_add_u32 s30, s30, s31
s_add_u32 s30, s30, s39
buffer_store_dwordx4 v[72:75], v155, s[12:15], s30 offen offset:2048 sc1
v_mov_b32 v78, v108
v_mov_b32 v79, v109
s_add_u32 s30, s38, 3
s_lshr_b32 s31, s30, 1
s_lshl_b32 s31, s31, 13
v_permlane16_swap_b32 v76, v78
v_permlane16_swap_b32 v77, v79
s_and_b32 s30, s30, 1
s_lshl_b32 s30, s30, 9
s_add_u32 s30, s30, s31
s_add_u32 s30, s30, s39
buffer_store_dwordx4 v[76:79], v155, s[12:15], s30 offen offset:2048 sc1
s_waitcnt vmcnt(12)
s_branch F_conv
F_grpB:
v_subrev_u32 v223, 114688, v226
ds_read_b64_tr_b16 v[144:145], v231 offset:0
ds_read_b64_tr_b16 v[146:147], v231 offset:1024
ds_read_b64_tr_b16 v[148:149], v232 offset:0
ds_read_b64_tr_b16 v[150:151], v232 offset:1024
ds_read_b64_tr_b16 v[152:153], v233 offset:0
ds_read_b64_tr_b16 v[154:155], v233 offset:1024
ds_read_b64_tr_b16 v[156:157], v231 offset:8192
ds_read_b64_tr_b16 v[158:159], v231 offset:9216
ds_read_b64_tr_b16 v[160:161], v232 offset:8192
ds_read_b64_tr_b16 v[162:163], v232 offset:9216
ds_read_b64_tr_b16 v[164:165], v233 offset:8192
ds_read_b64_tr_b16 v[166:167], v233 offset:9216
ds_read_b128 v[128:131], v229 offset:0
ds_read_b128 v[132:135], v229 offset:2048
ds_read_b128 v[136:139], v229 offset:4096
ds_read_b128 v[140:143], v229 offset:6144
s_mov_b32 s39, 0
s_waitcnt vmcnt(21) lgkmcnt(0)
s_barrier
s_cmp_lg_u32 s71, s39
s_cbranch_scc1 G1cs_1_0
v_dot2c_f32_bf16 v236, v144, v245
v_dot2c_f32_bf16 v237, v148, v245
v_dot2c_f32_bf16 v238, v152, v245
v_dot2c_f32_bf16 v239, v156, v245
v_dot2c_f32_bf16 v240, v160, v245
v_dot2c_f32_bf16 v241, v164, v245
v_dot2c_f32_bf16 v236, v145, v245
v_dot2c_f32_bf16 v237, v149, v245
v_dot2c_f32_bf16 v238, v153, v245
v_dot2c_f32_bf16 v239, v157, v245
v_dot2c_f32_bf16 v240, v161, v245
v_dot2c_f32_bf16 v241, v165, v245
v_dot2c_f32_bf16 v236, v146, v245
v_dot2c_f32_bf16 v237, v150, v245
v_dot2c_f32_bf16 v238, v154, v245
v_dot2c_f32_bf16 v239, v158, v245
v_dot2c_f32_bf16 v240, v162, v245
v_dot2c_f32_bf16 v241, v166, v245
v_dot2c_f32_bf16 v236, v147, v245
v_dot2c_f32_bf16 v237, v151, v245
v_dot2c_f32_bf16 v238, v155, v245
v_dot2c_f32_bf16 v239, v159, v245
v_dot2c_f32_bf16 v240, v163, v245
v_dot2c_f32_bf16 v241, v167, v245
G1cs_1_0:
v_mfma_f32_16x16x32_bf16 v[0:3], v[144:147], v[128:131], 0
s_add_u32 m0, s28, 98304
s_nop 0
buffer_load_dwordx4 v226, s[16:19], s26 offen lds
v_mfma_f32_16x16x32_bf16 v[4:7], v[148:151], v[128:131], 0
v_mfma_f32_16x16x32_bf16 v[8:11], v[152:155], v[128:131], 0
s_add_u32 m0, s28, 106496
s_nop 0
buffer_load_dwordx4 v226, s[20:23], s26 offen lds
s_add_u32 s26, s26, 229376
s_cmp_ge_u32 s26, 7340032
s_cselect_b32 s31, 7340032, 0
s_sub_u32 s26, s26, s31
v_mfma_f32_16x16x32_bf16 v[12:15], v[156:159], v[128:131], 0
v_mfma_f32_16x16x32_bf16 v[16:19], v[160:163], v[128:131], 0
ds_read_b64_tr_b16 v[184:185], v231 offset:16384
v_mfma_f32_16x16x32_bf16 v[20:23], v[164:167], v[128:131], 0
ds_read_b64_tr_b16 v[186:187], v231 offset:17408
v_mfma_f32_16x16x32_bf16 v[24:27], v[144:147], v[132:135], 0
ds_read_b64_tr_b16 v[188:189], v232 offset:16384
v_mfma_f32_16x16x32_bf16 v[28:31], v[148:151], v[132:135], 0
ds_read_b64_tr_b16 v[190:191], v232 offset:17408
v_mfma_f32_16x16x32_bf16 v[32:35], v[152:155], v[132:135], 0
ds_read_b64_tr_b16 v[192:193], v233 offset:16384
v_mfma_f32_16x16x32_bf16 v[36:39], v[156:159], v[132:135], 0
ds_read_b64_tr_b16 v[194:195], v233 offset:17408
v_mfma_f32_16x16x32_bf16 v[40:43], v[160:163], v[132:135], 0
ds_read_b64_tr_b16 v[196:197], v231 offset:24576
v_mfma_f32_16x16x32_bf16 v[44:47], v[164:167], v[132:135], 0
ds_read_b64_tr_b16 v[198:199], v231 offset:25600
v_mfma_f32_16x16x32_bf16 v[48:51], v[144:147], v[136:139], 0
ds_read_b64_tr_b16 v[200:201], v232 offset:24576
v_mfma_f32_16x16x32_bf16 v[52:55], v[148:151], v[136:139], 0
ds_read_b64_tr_b16 v[202:203], v232 offset:25600
v_mfma_f32_16x16x32_bf16 v[56:59], v[152:155], v[136:139], 0
ds_read_b64_tr_b16 v[204:205], v233 offset:24576
v_mfma_f32_16x16x32_bf16 v[60:63], v[156:159], v[136:139], 0
ds_read_b64_tr_b16 v[206:207], v233 offset:25600
v_mfma_f32_16x16x32_bf16 v[64:67], v[160:163], v[136:139], 0
ds_read_b128 v[168:171], v230 offset:0
v_mfma_f32_16x16x32_bf16 v[68:71], v[164:167], v[136:139], 0
ds_read_b128 v[172:175], v230 offset:2048
v_mfma_f32_16x16x32_bf16 v[72:75], v[144:147], v[140:143], 0
ds_read_b128 v[176:179], v230 offset:4096
v_mfma_f32_16x16x32_bf16 v[76:79], v[148:151], v[140:143], 0
ds_read_b128 v[180:183], v230 offset:6144
v_mfma_f32_16x16x32_bf16 v[80:83], v[152:155], v[140:143], 0
v_mfma_f32_16x16x32_bf16 v[84:87], v[156:159], v[140:143], 0
v_mfma_f32_16x16x32_bf16 v[88:91], v[160:163], v[140:143], 0
v_mfma_f32_16x16x32_bf16 v[92:95], v[164:167], v[140:143], 0
s_waitcnt vmcnt(17) lgkmcnt(0)
s_barrier
s_cmp_lg_u32 s71, s39
s_cbranch_scc1 G1cs_1_1
v_dot2c_f32_bf16 v236, v184, v245
v_dot2c_f32_bf16 v237, v188, v245
v_dot2c_f32_bf16 v238, v192, v245
v_dot2c_f32_bf16 v239, v196, v245
v_dot2c_f32_bf16 v240, v200, v245
v_dot2c_f32_bf16 v241, v204, v245
v_dot2c_f32_bf16 v236, v185, v245
v_dot2c_f32_bf16 v237, v189, v245
v_dot2c_f32_bf16 v238, v193, v245
v_dot2c_f32_bf16 v239, v197, v245
v_dot2c_f32_bf16 v240, v201, v245
v_dot2c_f32_bf16 v241, v205, v245
v_dot2c_f32_bf16 v236, v186, v245
v_dot2c_f32_bf16 v237, v190, v245
v_dot2c_f32_bf16 v238, v194, v245
v_dot2c_f32_bf16 v239, v198, v245
v_dot2c_f32_bf16 v240, v202, v245
v_dot2c_f32_bf16 v241, v206, v245
v_dot2c_f32_bf16 v236, v187, v245
v_dot2c_f32_bf16 v237, v191, v245
v_dot2c_f32_bf16 v238, v195, v245
v_dot2c_f32_bf16 v239, v199, v245
v_dot2c_f32_bf16 v240, v203, v245
v_dot2c_f32_bf16 v241, v207, v245
G1cs_1_1:
v_mfma_f32_16x16x32_bf16 v[0:3], v[184:187], v[168:171], v[0:3]
s_add_u32 s37, s37, 32768
s_cmp_ge_u32 s37, 98304
s_cselect_b32 s31, 98304, 0
s_sub_u32 s37, s37, s31
v_add_u32 v229, s37, v227
v_add_u32 v230, s37, v228
s_add_u32 m0, s28, 114688
s_nop 0
buffer_load_dwordx4 v226, s[16:19], s26 offen lds
v_mfma_f32_16x16x32_bf16 v[4:7], v[188:191], v[168:171], v[4:7]
v_mfma_f32_16x16x32_bf16 v[8:11], v[192:195], v[168:171], v[8:11]
s_add_u32 m0, s28, 122880
s_nop 0
buffer_load_dwordx4 v226, s[20:23], s26 offen lds
s_add_u32 s26, s26, 229376
s_cmp_ge_u32 s26, 7340032
s_cselect_b32 s31, 7340032, 0
s_sub_u32 s26, s26, s31
v_mfma_f32_16x16x32_bf16 v[12:15], v[196:199], v[168:171], v[12:15]
v_mfma_f32_16x16x32_bf16 v[16:19], v[200:203], v[168:171], v[16:19]
ds_read_b64_tr_b16 v[144:145], v231 offset:32768
s_mov_b32 m0, s36
s_add_u32 s30, s25, 0
s_add_u32 s30, s30, s27
buffer_load_dwordx4 v224, s[40:43], s30 offen lds
v_mfma_f32_16x16x32_bf16 v[20:23], v[204:207], v[168:171], v[20:23]
ds_read_b64_tr_b16 v[146:147], v231 offset:33792
v_mfma_f32_16x16x32_bf16 v[24:27], v[184:187], v[172:175], v[24:27]
ds_read_b64_tr_b16 v[148:149], v232 offset:32768
buffer_load_dwordx4 v225, s[40:43], s30 offen offset:1024 lds
v_mfma_f32_16x16x32_bf16 v[28:31], v[188:191], v[172:175], v[28:31]
ds_read_b64_tr_b16 v[150:151], v232 offset:33792
v_mfma_f32_16x16x32_bf16 v[32:35], v[192:195], v[172:175], v[32:35]
ds_read_b64_tr_b16 v[152:153], v233 offset:32768
v_mfma_f32_16x16x32_bf16 v[36:39], v[196:199], v[172:175], v[36:39]
ds_read_b64_tr_b16 v[154:155], v233 offset:33792
v_mfma_f32_16x16x32_bf16 v[40:43], v[200:203], v[172:175], v[40:43]
ds_read_b64_tr_b16 v[156:157], v231 offset:40960
v_mfma_f32_16x16x32_bf16 v[44:47], v[204:207], v[172:175], v[44:47]
ds_read_b64_tr_b16 v[158:159], v231 offset:41984
v_mfma_f32_16x16x32_bf16 v[48:51], v[184:187], v[176:179], v[48:51]
ds_read_b64_tr_b16 v[160:161], v232 offset:40960
v_mfma_f32_16x16x32_bf16 v[52:55], v[188:191], v[176:179], v[52:55]
ds_read_b64_tr_b16 v[162:163], v232 offset:41984
v_mfma_f32_16x16x32_bf16 v[56:59], v[192:195], v[176:179], v[56:59]
ds_read_b64_tr_b16 v[164:165], v233 offset:40960
v_mfma_f32_16x16x32_bf16 v[60:63], v[196:199], v[176:179], v[60:63]
ds_read_b64_tr_b16 v[166:167], v233 offset:41984
v_mfma_f32_16x16x32_bf16 v[64:67], v[200:203], v[176:179], v[64:67]
ds_read_b128 v[128:131], v229 offset:0
v_mfma_f32_16x16x32_bf16 v[68:71], v[204:207], v[176:179], v[68:71]
ds_read_b128 v[132:135], v229 offset:2048
v_mfma_f32_16x16x32_bf16 v[72:75], v[184:187], v[180:183], v[72:75]
ds_read_b128 v[136:139], v229 offset:4096
v_mfma_f32_16x16x32_bf16 v[76:79], v[188:191], v[180:183], v[76:79]
ds_read_b128 v[140:143], v229 offset:6144
v_mfma_f32_16x16x32_bf16 v[80:83], v[192:195], v[180:183], v[80:83]
v_mfma_f32_16x16x32_bf16 v[84:87], v[196:199], v[180:183], v[84:87]
v_mfma_f32_16x16x32_bf16 v[88:91], v[200:203], v[180:183], v[88:91]
v_mfma_f32_16x16x32_bf16 v[92:95], v[204:207], v[180:183], v[92:95]
s_waitcnt vmcnt(10) lgkmcnt(0)
s_barrier
s_cmp_lg_u32 s71, s39
s_cbranch_scc1 G1cs_1_2
v_dot2c_f32_bf16 v236, v144, v245
v_dot2c_f32_bf16 v237, v148, v245
v_dot2c_f32_bf16 v238, v152, v245
v_dot2c_f32_bf16 v239, v156, v245
v_dot2c_f32_bf16 v240, v160, v245
v_dot2c_f32_bf16 v241, v164, v245
v_dot2c_f32_bf16 v236, v145, v245
v_dot2c_f32_bf16 v237, v149, v245
v_dot2c_f32_bf16 v238, v153, v245
v_dot2c_f32_bf16 v239, v157, v245
v_dot2c_f32_bf16 v240, v161, v245
v_dot2c_f32_bf16 v241, v165, v245
v_dot2c_f32_bf16 v236, v146, v245
v_dot2c_f32_bf16 v237, v150, v245
v_dot2c_f32_bf16 v238, v154, v245
v_dot2c_f32_bf16 v239, v158, v245
v_dot2c_f32_bf16 v240, v162, v245
v_dot2c_f32_bf16 v241, v166, v245
v_dot2c_f32_bf16 v236, v147, v245
v_dot2c_f32_bf16 v237, v151, v245
v_dot2c_f32_bf16 v238, v155, v245
v_dot2c_f32_bf16 v239, v159, v245
v_dot2c_f32_bf16 v240, v163, v245
v_dot2c_f32_bf16 v241, v167, v245
G1cs_1_2:
v_mfma_f32_16x16x32_bf16 v[0:3], v[144:147], v[128:131], v[0:3]
s_add_u32 m0, s28, 131072
s_nop 0
buffer_load_dwordx4 v226, s[16:19], s26 offen lds
v_mfma_f32_16x16x32_bf16 v[4:7], v[148:151], v[128:131], v[4:7]
v_mfma_f32_16x16x32_bf16 v[8:11], v[152:155], v[128:131], v[8:11]
s_add_u32 m0, s28, 139264
s_nop 0
buffer_load_dwordx4 v226, s[20:23], s26 offen lds
s_add_u32 s26, s26, 229376
s_cmp_ge_u32 s26, 7340032
s_cselect_b32 s31, 7340032, 0
s_sub_u32 s26, s26, s31
v_mfma_f32_16x16x32_bf16 v[12:15], v[156:159], v[128:131], v[12:15]
v_mfma_f32_16x16x32_bf16 v[16:19], v[160:163], v[128:131], v[16:19]
ds_read_b64_tr_b16 v[184:185], v231 offset:49152
s_add_u32 m0, s36, 16384
s_add_u32 s30, s25, 262144
s_add_u32 s30, s30, s27
buffer_load_dwordx4 v224, s[40:43], s30 offen lds
v_mfma_f32_16x16x32_bf16 v[20:23], v[164:167], v[128:131], v[20:23]
ds_read_b64_tr_b16 v[186:187], v231 offset:50176
v_mfma_f32_16x16x32_bf16 v[24:27], v[144:147], v[132:135], v[24:27]
ds_read_b64_tr_b16 v[188:189], v232 offset:49152
buffer_load_dwordx4 v225, s[40:43], s30 offen offset:1024 lds
s_add_u32 s27, s27, 128
s_and_b32 s27, s27, 2047
s_add_u32 s36, s36, 32768
s_cmp_ge_u32 s36, 98304
s_cselect_b32 s31, 98304, 0
s_sub_u32 s36, s36, s31
v_mfma_f32_16x16x32_bf16 v[28:31], v[148:151], v[132:135], v[28:31]
ds_read_b64_tr_b16 v[190:191], v232 offset:50176
v_mfma_f32_16x16x32_bf16 v[32:35], v[152:155], v[132:135], v[32:35]
ds_read_b64_tr_b16 v[192:193], v233 offset:49152
v_mfma_f32_16x16x32_bf16 v[36:39], v[156:159], v[132:135], v[36:39]
ds_read_b64_tr_b16 v[194:195], v233 offset:50176
v_mfma_f32_16x16x32_bf16 v[40:43], v[160:163], v[132:135], v[40:43]
ds_read_b64_tr_b16 v[196:197], v231 offset:57344
v_mfma_f32_16x16x32_bf16 v[44:47], v[164:167], v[132:135], v[44:47]
ds_read_b64_tr_b16 v[198:199], v231 offset:58368
v_mfma_f32_16x16x32_bf16 v[48:51], v[144:147], v[136:139], v[48:51]
ds_read_b64_tr_b16 v[200:201], v232 offset:57344
v_mfma_f32_16x16x32_bf16 v[52:55], v[148:151], v[136:139], v[52:55]
ds_read_b64_tr_b16 v[202:203], v232 offset:58368
v_mfma_f32_16x16x32_bf16 v[56:59], v[152:155], v[136:139], v[56:59]
ds_read_b64_tr_b16 v[204:205], v233 offset:57344
v_mfma_f32_16x16x32_bf16 v[60:63], v[156:159], v[136:139], v[60:63]
ds_read_b64_tr_b16 v[206:207], v233 offset:58368
v_mfma_f32_16x16x32_bf16 v[64:67], v[160:163], v[136:139], v[64:67]
ds_read_b128 v[168:171], v230 offset:0
v_mfma_f32_16x16x32_bf16 v[68:71], v[164:167], v[136:139], v[68:71]
ds_read_b128 v[172:175], v230 offset:2048
v_mfma_f32_16x16x32_bf16 v[72:75], v[144:147], v[140:143], v[72:75]
ds_read_b128 v[176:179], v230 offset:4096
v_mfma_f32_16x16x32_bf16 v[76:79], v[148:151], v[140:143], v[76:79]
ds_read_b128 v[180:183], v230 offset:6144
v_mfma_f32_16x16x32_bf16 v[80:83], v[152:155], v[140:143], v[80:83]
v_mfma_f32_16x16x32_bf16 v[84:87], v[156:159], v[140:143], v[84:87]
v_mfma_f32_16x16x32_bf16 v[88:91], v[160:163], v[140:143], v[88:91]
v_mfma_f32_16x16x32_bf16 v[92:95], v[164:167], v[140:143], v[92:95]
s_waitcnt vmcnt(8) lgkmcnt(0)
s_barrier
s_cmp_lg_u32 s71, s39
s_cbranch_scc1 G1cs_1_3
v_dot2c_f32_bf16 v236, v184, v245
v_dot2c_f32_bf16 v237, v188, v245
v_dot2c_f32_bf16 v238, v192, v245
v_dot2c_f32_bf16 v239, v196, v245
v_dot2c_f32_bf16 v240, v200, v245
v_dot2c_f32_bf16 v241, v204, v245
v_dot2c_f32_bf16 v236, v185, v245
v_dot2c_f32_bf16 v237, v189, v245
v_dot2c_f32_bf16 v238, v193, v245
v_dot2c_f32_bf16 v239, v197, v245
v_dot2c_f32_bf16 v240, v201, v245
v_dot2c_f32_bf16 v241, v205, v245
v_dot2c_f32_bf16 v236, v186, v245
v_dot2c_f32_bf16 v237, v190, v245
v_dot2c_f32_bf16 v238, v194, v245
v_dot2c_f32_bf16 v239, v198, v245
v_dot2c_f32_bf16 v240, v202, v245
v_dot2c_f32_bf16 v241, v206, v245
v_dot2c_f32_bf16 v236, v187, v245
v_dot2c_f32_bf16 v237, v191, v245
v_dot2c_f32_bf16 v238, v195, v245
v_dot2c_f32_bf16 v239, v199, v245
v_dot2c_f32_bf16 v240, v203, v245
v_dot2c_f32_bf16 v241, v207, v245
G1cs_1_3:
v_mfma_f32_16x16x32_bf16 v[0:3], v[184:187], v[168:171], v[0:3]
s_add_u32 s37, s37, 32768
s_cmp_ge_u32 s37, 98304
s_cselect_b32 s31, 98304, 0
s_sub_u32 s37, s37, s31
v_add_u32 v229, s37, v227
v_add_u32 v230, s37, v228
s_add_u32 m0, s28, 147456
s_nop 0
buffer_load_dwordx4 v226, s[16:19], s26 offen lds
v_mfma_f32_16x16x32_bf16 v[4:7], v[188:191], v[168:171], v[4:7]
v_mfma_f32_16x16x32_bf16 v[8:11], v[192:195], v[168:171], v[8:11]
s_add_u32 m0, s28, 155648
s_nop 0
buffer_load_dwordx4 v226, s[20:23], s26 offen lds
s_add_u32 s26, s26, 229376
s_cmp_ge_u32 s26, 7340032
s_cselect_b32 s31, 7340032, 0
s_sub_u32 s26, s26, s31
v_mfma_f32_16x16x32_bf16 v[12:15], v[196:199], v[168:171], v[12:15]
v_mfma_f32_16x16x32_bf16 v[16:19], v[200:203], v[168:171], v[16:19]
ds_read_b64_tr_b16 v[144:145], v231 offset:0
s_mov_b32 m0, s36
s_add_u32 s30, s25, 0
s_add_u32 s30, s30, s27
buffer_load_dwordx4 v224, s[40:43], s30 offen lds
v_mfma_f32_16x16x32_bf16 v[20:23], v[204:207], v[168:171], v[20:23]
ds_read_b64_tr_b16 v[146:147], v231 offset:1024
v_mfma_f32_16x16x32_bf16 v[24:27], v[184:187], v[172:175], v[24:27]
ds_read_b64_tr_b16 v[148:149], v232 offset:0
buffer_load_dwordx4 v225, s[40:43], s30 offen offset:1024 lds
v_mfma_f32_16x16x32_bf16 v[28:31], v[188:191], v[172:175], v[28:31]
ds_read_b64_tr_b16 v[150:151], v232 offset:1024
v_mfma_f32_16x16x32_bf16 v[32:35], v[192:195], v[172:175], v[32:35]
ds_read_b64_tr_b16 v[152:153], v233 offset:0
v_mfma_f32_16x16x32_bf16 v[36:39], v[196:199], v[172:175], v[36:39]
ds_read_b64_tr_b16 v[154:155], v233 offset:1024
v_mfma_f32_16x16x32_bf16 v[40:43], v[200:203], v[172:175], v[40:43]
ds_read_b64_tr_b16 v[156:157], v231 offset:8192
v_mfma_f32_16x16x32_bf16 v[44:47], v[204:207], v[172:175], v[44:47]
ds_read_b64_tr_b16 v[158:159], v231 offset:9216
v_mfma_f32_16x16x32_bf16 v[48:51], v[184:187], v[176:179], v[48:51]
ds_read_b64_tr_b16 v[160:161], v232 offset:8192
v_mfma_f32_16x16x32_bf16 v[52:55], v[188:191], v[176:179], v[52:55]
ds_read_b64_tr_b16 v[162:163], v232 offset:9216
v_mfma_f32_16x16x32_bf16 v[56:59], v[192:195], v[176:179], v[56:59]
ds_read_b64_tr_b16 v[164:165], v233 offset:8192
v_mfma_f32_16x16x32_bf16 v[60:63], v[196:199], v[176:179], v[60:63]
ds_read_b64_tr_b16 v[166:167], v233 offset:9216
v_mfma_f32_16x16x32_bf16 v[64:67], v[200:203], v[176:179], v[64:67]
ds_read_b128 v[128:131], v229 offset:0
v_mfma_f32_16x16x32_bf16 v[68:71], v[204:207], v[176:179], v[68:71]
ds_read_b128 v[132:135], v229 offset:2048
v_mfma_f32_16x16x32_bf16 v[72:75], v[184:187], v[180:183], v[72:75]
ds_read_b128 v[136:139], v229 offset:4096
v_mfma_f32_16x16x32_bf16 v[76:79], v[188:191], v[180:183], v[76:79]
ds_read_b128 v[140:143], v229 offset:6144
v_mfma_f32_16x16x32_bf16 v[80:83], v[192:195], v[180:183], v[80:83]
v_mfma_f32_16x16x32_bf16 v[84:87], v[196:199], v[180:183], v[84:87]
v_mfma_f32_16x16x32_bf16 v[88:91], v[200:203], v[180:183], v[88:91]
v_mfma_f32_16x16x32_bf16 v[92:95], v[204:207], v[180:183], v[92:95]
s_mov_b32 s39, 1
G1L1_loop:
s_waitcnt vmcnt(10) lgkmcnt(0)
s_barrier
s_cmp_lg_u32 s39, 4
s_cbranch_scc1 EVcs_1_4
s_cmp_eq_u32 s71, 0xff
s_cbranch_scc1 EVcs_1_4
v_mov_b32 v244, v236
s_nop 1
v_permlane16_swap_b32 v244, v236
s_nop 1
v_add_f32 v236, v236, v244
v_mov_b32 v244, v236
s_nop 1
v_permlane32_swap_b32 v244, v236
s_nop 1
v_add_f32 v236, v236, v244
v_mov_b32 v244, v237
s_nop 1
v_permlane16_swap_b32 v244, v237
s_nop 1
v_add_f32 v237, v237, v244
v_mov_b32 v244, v237
s_nop 1
v_permlane32_swap_b32 v244, v237
s_nop 1
v_add_f32 v237, v237, v244
v_mov_b32 v244, v238
s_nop 1
v_permlane16_swap_b32 v244, v238
s_nop 1
v_add_f32 v238, v238, v244
v_mov_b32 v244, v238
s_nop 1
v_permlane32_swap_b32 v244, v238
s_nop 1
v_add_f32 v238, v238, v244
v_mov_b32 v244, v239
s_nop 1
v_permlane16_swap_b32 v244, v239
s_nop 1
v_add_f32 v239, v239, v244
v_mov_b32 v244, v239
s_nop 1
v_permlane32_swap_b32 v244, v239
s_nop 1
v_add_f32 v239, v239, v244
v_mov_b32 v244, v240
s_nop 1
v_permlane16_swap_b32 v244, v240
s_nop 1
v_add_f32 v240, v240, v244
v_mov_b32 v244, v240
s_nop 1
v_permlane32_swap_b32 v244, v240
s_nop 1
v_add_f32 v240, v240, v244
v_mov_b32 v244, v241
s_nop 1
v_permlane16_swap_b32 v244, v241
s_nop 1
v_add_f32 v241, v241, v244
v_mov_b32 v244, v241
s_nop 1
v_permlane32_swap_b32 v244, v241
s_nop 1
v_add_f32 v241, v241, v244
v_lshlrev_b32 v244, 2, v235
s_mul_i32 s82, s33, 112
s_add_u32 s82, s82, 64
s_lshl_b32 s82, s82, 2
s_add_u32 s82, s82, 2097152
s_mov_b64 s[46:47], exec
s_mov_b64 exec, 0xffff
s_add_u32 s83, s82, 0
buffer_atomic_add_f32 v236, v244, s[12:15], s83 offen sc1
s_add_u32 s83, s82, 64
buffer_atomic_add_f32 v237, v244, s[12:15], s83 offen sc1
s_add_u32 s83, s82, 128
buffer_atomic_add_f32 v238, v244, s[12:15], s83 offen sc1
s_add_u32 s83, s82, 14336
buffer_atomic_add_f32 v239, v244, s[12:15], s83 offen sc1
s_add_u32 s83, s82, 14400
buffer_atomic_add_f32 v240, v244, s[12:15], s83 offen sc1
s_add_u32 s83, s82, 14464
buffer_atomic_add_f32 v241, v244, s[12:15], s83 offen sc1
s_mov_b64 exec, s[46:47]
EVcs_1_4:
s_cmp_lg_u32 s71, s39
s_cbranch_scc1 G1cs_1_4
v_dot2c_f32_bf16 v236, v144, v245
v_dot2c_f32_bf16 v237, v148, v245
v_dot2c_f32_bf16 v238, v152, v245
v_dot2c_f32_bf16 v239, v156, v245
v_dot2c_f32_bf16 v240, v160, v245
v_dot2c_f32_bf16 v241, v164, v245
v_dot2c_f32_bf16 v236, v145, v245
v_dot2c_f32_bf16 v237, v149, v245
v_dot2c_f32_bf16 v238, v153, v245
v_dot2c_f32_bf16 v239, v157, v245
v_dot2c_f32_bf16 v240, v161, v245
v_dot2c_f32_bf16 v241, v165, v245
v_dot2c_f32_bf16 v236, v146, v245
v_dot2c_f32_bf16 v237, v150, v245
v_dot2c_f32_bf16 v238, v154, v245
v_dot2c_f32_bf16 v239, v158, v245
v_dot2c_f32_bf16 v240, v162, v245
v_dot2c_f32_bf16 v241, v166, v245
v_dot2c_f32_bf16 v236, v147, v245
v_dot2c_f32_bf16 v237, v151, v245
v_dot2c_f32_bf16 v238, v155, v245
v_dot2c_f32_bf16 v239, v159, v245
v_dot2c_f32_bf16 v240, v163, v245
v_dot2c_f32_bf16 v241, v167, v245
G1cs_1_4:
v_mfma_f32_16x16x32_bf16 v[0:3], v[144:147], v[128:131], v[0:3]
s_add_u32 m0, s28, 98304
s_nop 0
buffer_load_dwordx4 v226, s[16:19], s26 offen lds
v_mfma_f32_16x16x32_bf16 v[4:7], v[148:151], v[128:131], v[4:7]
v_mfma_f32_16x16x32_bf16 v[8:11], v[152:155], v[128:131], v[8:11]
s_add_u32 m0, s28, 106496
s_nop 0
buffer_load_dwordx4 v226, s[20:23], s26 offen lds
s_add_u32 s26, s26, 229376
s_cmp_ge_u32 s26, 7340032
s_cselect_b32 s31, 7340032, 0
s_sub_u32 s26, s26, s31
v_mfma_f32_16x16x32_bf16 v[12:15], v[156:159], v[128:131], v[12:15]
v_mfma_f32_16x16x32_bf16 v[16:19], v[160:163], v[128:131], v[16:19]
ds_read_b64_tr_b16 v[184:185], v231 offset:16384
s_add_u32 m0, s36, 16384
s_add_u32 s30, s25, 262144
s_add_u32 s30, s30, s27
buffer_load_dwordx4 v224, s[40:43], s30 offen lds
v_mfma_f32_16x16x32_bf16 v[20:23], v[164:167], v[128:131], v[20:23]
ds_read_b64_tr_b16 v[186:187], v231 offset:17408
v_mfma_f32_16x16x32_bf16 v[24:27], v[144:147], v[132:135], v[24:27]
ds_read_b64_tr_b16 v[188:189], v232 offset:16384
buffer_load_dwordx4 v225, s[40:43], s30 offen offset:1024 lds
s_add_u32 s27, s27, 128
s_and_b32 s27, s27, 2047
s_add_u32 s36, s36, 32768
s_cmp_ge_u32 s36, 98304
s_cselect_b32 s31, 98304, 0
s_sub_u32 s36, s36, s31
v_mfma_f32_16x16x32_bf16 v[28:31], v[148:151], v[132:135], v[28:31]
ds_read_b64_tr_b16 v[190:191], v232 offset:17408
v_mfma_f32_16x16x32_bf16 v[32:35], v[152:155], v[132:135], v[32:35]
ds_read_b64_tr_b16 v[192:193], v233 offset:16384
v_mfma_f32_16x16x32_bf16 v[36:39], v[156:159], v[132:135], v[36:39]
ds_read_b64_tr_b16 v[194:195], v233 offset:17408
v_mfma_f32_16x16x32_bf16 v[40:43], v[160:163], v[132:135], v[40:43]
ds_read_b64_tr_b16 v[196:197], v231 offset:24576
v_mfma_f32_16x16x32_bf16 v[44:47], v[164:167], v[132:135], v[44:47]
ds_read_b64_tr_b16 v[198:199], v231 offset:25600
v_mfma_f32_16x16x32_bf16 v[48:51], v[144:147], v[136:139], v[48:51]
ds_read_b64_tr_b16 v[200:201], v232 offset:24576
v_mfma_f32_16x16x32_bf16 v[52:55], v[148:151], v[136:139], v[52:55]
ds_read_b64_tr_b16 v[202:203], v232 offset:25600
v_mfma_f32_16x16x32_bf16 v[56:59], v[152:155], v[136:139], v[56:59]
ds_read_b64_tr_b16 v[204:205], v233 offset:24576
v_mfma_f32_16x16x32_bf16 v[60:63], v[156:159], v[136:139], v[60:63]
ds_read_b64_tr_b16 v[206:207], v233 offset:25600
v_mfma_f32_16x16x32_bf16 v[64:67], v[160:163], v[136:139], v[64:67]
ds_read_b128 v[168:171], v230 offset:0
v_mfma_f32_16x16x32_bf16 v[68:71], v[164:167], v[136:139], v[68:71]
ds_read_b128 v[172:175], v230 offset:2048
v_mfma_f32_16x16x32_bf16 v[72:75], v[144:147], v[140:143], v[72:75]
ds_read_b128 v[176:179], v230 offset:4096
v_mfma_f32_16x16x32_bf16 v[76:79], v[148:151], v[140:143], v[76:79]
ds_read_b128 v[180:183], v230 offset:6144
v_mfma_f32_16x16x32_bf16 v[80:83], v[152:155], v[140:143], v[80:83]
v_mfma_f32_16x16x32_bf16 v[84:87], v[156:159], v[140:143], v[84:87]
v_mfma_f32_16x16x32_bf16 v[88:91], v[160:163], v[140:143], v[88:91]
v_mfma_f32_16x16x32_bf16 v[92:95], v[164:167], v[140:143], v[92:95]
s_waitcnt vmcnt(8) lgkmcnt(0)
s_barrier
s_cmp_lg_u32 s71, s39
s_cbranch_scc1 G1cs_1_5
v_dot2c_f32_bf16 v236, v184, v245
v_dot2c_f32_bf16 v237, v188, v245
v_dot2c_f32_bf16 v238, v192, v245
v_dot2c_f32_bf16 v239, v196, v245
v_dot2c_f32_bf16 v240, v200, v245
v_dot2c_f32_bf16 v241, v204, v245
v_dot2c_f32_bf16 v236, v185, v245
v_dot2c_f32_bf16 v237, v189, v245
v_dot2c_f32_bf16 v238, v193, v245
v_dot2c_f32_bf16 v239, v197, v245
v_dot2c_f32_bf16 v240, v201, v245
v_dot2c_f32_bf16 v241, v205, v245
v_dot2c_f32_bf16 v236, v186, v245
v_dot2c_f32_bf16 v237, v190, v245
v_dot2c_f32_bf16 v238, v194, v245
v_dot2c_f32_bf16 v239, v198, v245
v_dot2c_f32_bf16 v240, v202, v245
v_dot2c_f32_bf16 v241, v206, v245
v_dot2c_f32_bf16 v236, v187, v245
v_dot2c_f32_bf16 v237, v191, v245
v_dot2c_f32_bf16 v238, v195, v245
v_dot2c_f32_bf16 v239, v199, v245
v_dot2c_f32_bf16 v240, v203, v245
v_dot2c_f32_bf16 v241, v207, v245
G1cs_1_5:
v_mfma_f32_16x16x32_bf16 v[0:3], v[184:187], v[168:171], v[0:3]
s_add_u32 s37, s37, 32768
s_cmp_ge_u32 s37, 98304
s_cselect_b32 s31, 98304, 0
s_sub_u32 s37, s37, s31
v_add_u32 v229, s37, v227
v_add_u32 v230, s37, v228
s_add_u32 m0, s28, 114688
s_nop 0
buffer_load_dwordx4 v226, s[16:19], s26 offen lds
v_mfma_f32_16x16x32_bf16 v[4:7], v[188:191], v[168:171], v[4:7]
v_mfma_f32_16x16x32_bf16 v[8:11], v[192:195], v[168:171], v[8:11]
s_add_u32 m0, s28, 122880
s_nop 0
buffer_load_dwordx4 v226, s[20:23], s26 offen lds
s_add_u32 s26, s26, 229376
s_cmp_ge_u32 s26, 7340032
s_cselect_b32 s31, 7340032, 0
s_sub_u32 s26, s26, s31
v_mfma_f32_16x16x32_bf16 v[12:15], v[196:199], v[168:171], v[12:15]
v_mfma_f32_16x16x32_bf16 v[16:19], v[200:203], v[168:171], v[16:19]
ds_read_b64_tr_b16 v[144:145], v231 offset:32768
s_mov_b32 m0, s36
s_add_u32 s30, s25, 0
s_add_u32 s30, s30, s27
buffer_load_dwordx4 v224, s[40:43], s30 offen lds
v_mfma_f32_16x16x32_bf16 v[20:23], v[204:207], v[168:171], v[20:23]
ds_read_b64_tr_b16 v[146:147], v231 offset:33792
v_mfma_f32_16x16x32_bf16 v[24:27], v[184:187], v[172:175], v[24:27]
ds_read_b64_tr_b16 v[148:149], v232 offset:32768
buffer_load_dwordx4 v225, s[40:43], s30 offen offset:1024 lds
v_mfma_f32_16x16x32_bf16 v[28:31], v[188:191], v[172:175], v[28:31]
ds_read_b64_tr_b16 v[150:151], v232 offset:33792
v_mfma_f32_16x16x32_bf16 v[32:35], v[192:195], v[172:175], v[32:35]
ds_read_b64_tr_b16 v[152:153], v233 offset:32768
v_mfma_f32_16x16x32_bf16 v[36:39], v[196:199], v[172:175], v[36:39]
ds_read_b64_tr_b16 v[154:155], v233 offset:33792
v_mfma_f32_16x16x32_bf16 v[40:43], v[200:203], v[172:175], v[40:43]
ds_read_b64_tr_b16 v[156:157], v231 offset:40960
v_mfma_f32_16x16x32_bf16 v[44:47], v[204:207], v[172:175], v[44:47]
ds_read_b64_tr_b16 v[158:159], v231 offset:41984
v_mfma_f32_16x16x32_bf16 v[48:51], v[184:187], v[176:179], v[48:51]
ds_read_b64_tr_b16 v[160:161], v232 offset:40960
v_mfma_f32_16x16x32_bf16 v[52:55], v[188:191], v[176:179], v[52:55]
ds_read_b64_tr_b16 v[162:163], v232 offset:41984
v_mfma_f32_16x16x32_bf16 v[56:59], v[192:195], v[176:179], v[56:59]
ds_read_b64_tr_b16 v[164:165], v233 offset:40960
v_mfma_f32_16x16x32_bf16 v[60:63], v[196:199], v[176:179], v[60:63]
ds_read_b64_tr_b16 v[166:167], v233 offset:41984
v_mfma_f32_16x16x32_bf16 v[64:67], v[200:203], v[176:179], v[64:67]
ds_read_b128 v[128:131], v229 offset:0
v_mfma_f32_16x16x32_bf16 v[68:71], v[204:207], v[176:179], v[68:71]
ds_read_b128 v[132:135], v229 offset:2048
v_mfma_f32_16x16x32_bf16 v[72:75], v[184:187], v[180:183], v[72:75]
ds_read_b128 v[136:139], v229 offset:4096
v_mfma_f32_16x16x32_bf16 v[76:79], v[188:191], v[180:183], v[76:79]
ds_read_b128 v[140:143], v229 offset:6144
v_mfma_f32_16x16x32_bf16 v[80:83], v[192:195], v[180:183], v[80:83]
v_mfma_f32_16x16x32_bf16 v[84:87], v[196:199], v[180:183], v[84:87]
v_mfma_f32_16x16x32_bf16 v[88:91], v[200:203], v[180:183], v[88:91]
v_mfma_f32_16x16x32_bf16 v[92:95], v[204:207], v[180:183], v[92:95]
s_waitcnt vmcnt(10) lgkmcnt(0)
s_barrier
s_cmp_lg_u32 s71, s39
s_cbranch_scc1 G1cs_1_6
v_dot2c_f32_bf16 v236, v144, v245
v_dot2c_f32_bf16 v237, v148, v245
v_dot2c_f32_bf16 v238, v152, v245
v_dot2c_f32_bf16 v239, v156, v245
v_dot2c_f32_bf16 v240, v160, v245
v_dot2c_f32_bf16 v241, v164, v245
v_dot2c_f32_bf16 v236, v145, v245
v_dot2c_f32_bf16 v237, v149, v245
v_dot2c_f32_bf16 v238, v153, v245
v_dot2c_f32_bf16 v239, v157, v245
v_dot2c_f32_bf16 v240, v161, v245
v_dot2c_f32_bf16 v241, v165, v245
v_dot2c_f32_bf16 v236, v146, v245
v_dot2c_f32_bf16 v237, v150, v245
v_dot2c_f32_bf16 v238, v154, v245
v_dot2c_f32_bf16 v239, v158, v245
v_dot2c_f32_bf16 v240, v162, v245
v_dot2c_f32_bf16 v241, v166, v245
v_dot2c_f32_bf16 v236, v147, v245
v_dot2c_f32_bf16 v237, v151, v245
v_dot2c_f32_bf16 v238, v155, v245
v_dot2c_f32_bf16 v239, v159, v245
v_dot2c_f32_bf16 v240, v163, v245
v_dot2c_f32_bf16 v241, v167, v245
G1cs_1_6:
v_mfma_f32_16x16x32_bf16 v[0:3], v[144:147], v[128:131], v[0:3]
s_add_u32 m0, s28, 131072
s_nop 0
buffer_load_dwordx4 v226, s[16:19], s26 offen lds
v_mfma_f32_16x16x32_bf16 v[4:7], v[148:151], v[128:131], v[4:7]
v_mfma_f32_16x16x32_bf16 v[8:11], v[152:155], v[128:131], v[8:11]
s_add_u32 m0, s28, 139264
s_nop 0
buffer_load_dwordx4 v226, s[20:23], s26 offen lds
s_add_u32 s26, s26, 229376
s_cmp_ge_u32 s26, 7340032
s_cselect_b32 s31, 7340032, 0
s_sub_u32 s26, s26, s31
v_mfma_f32_16x16x32_bf16 v[12:15], v[156:159], v[128:131], v[12:15]
v_mfma_f32_16x16x32_bf16 v[16:19], v[160:163], v[128:131], v[16:19]
ds_read_b64_tr_b16 v[184:185], v231 offset:49152
s_add_u32 m0, s36, 16384
s_add_u32 s30, s25, 262144
s_add_u32 s30, s30, s27
buffer_load_dwordx4 v224, s[40:43], s30 offen lds
v_mfma_f32_16x16x32_bf16 v[20:23], v[164:167], v[128:131], v[20:23]
ds_read_b64_tr_b16 v[186:187], v231 offset:50176
v_mfma_f32_16x16x32_bf16 v[24:27], v[144:147], v[132:135], v[24:27]
ds_read_b64_tr_b16 v[188:189], v232 offset:49152
buffer_load_dwordx4 v225, s[40:43], s30 offen offset:1024 lds
s_add_u32 s27, s27, 128
s_and_b32 s27, s27, 2047
s_add_u32 s36, s36, 32768
s_cmp_ge_u32 s36, 98304
s_cselect_b32 s31, 98304, 0
s_sub_u32 s36, s36, s31
v_mfma_f32_16x16x32_bf16 v[28:31], v[148:151], v[132:135], v[28:31]
ds_read_b64_tr_b16 v[190:191], v232 offset:50176
v_mfma_f32_16x16x32_bf16 v[32:35], v[152:155], v[132:135], v[32:35]
ds_read_b64_tr_b16 v[192:193], v233 offset:49152
v_mfma_f32_16x16x32_bf16 v[36:39], v[156:159], v[132:135], v[36:39]
ds_read_b64_tr_b16 v[194:195], v233 offset:50176
v_mfma_f32_16x16x32_bf16 v[40:43], v[160:163], v[132:135], v[40:43]
ds_read_b64_tr_b16 v[196:197], v231 offset:57344
v_mfma_f32_16x16x32_bf16 v[44:47], v[164:167], v[132:135], v[44:47]
ds_read_b64_tr_b16 v[198:199], v231 offset:58368
v_mfma_f32_16x16x32_bf16 v[48:51], v[144:147], v[136:139], v[48:51]
ds_read_b64_tr_b16 v[200:201], v232 offset:57344
v_mfma_f32_16x16x32_bf16 v[52:55], v[148:151], v[136:139], v[52:55]
ds_read_b64_tr_b16 v[202:203], v232 offset:58368
v_mfma_f32_16x16x32_bf16 v[56:59], v[152:155], v[136:139], v[56:59]
ds_read_b64_tr_b16 v[204:205], v233 offset:57344
v_mfma_f32_16x16x32_bf16 v[60:63], v[156:159], v[136:139], v[60:63]
ds_read_b64_tr_b16 v[206:207], v233 offset:58368
v_mfma_f32_16x16x32_bf16 v[64:67], v[160:163], v[136:139], v[64:67]
ds_read_b128 v[168:171], v230 offset:0
v_mfma_f32_16x16x32_bf16 v[68:71], v[164:167], v[136:139], v[68:71]
ds_read_b128 v[172:175], v230 offset:2048
v_mfma_f32_16x16x32_bf16 v[72:75], v[144:147], v[140:143], v[72:75]
ds_read_b128 v[176:179], v230 offset:4096
v_mfma_f32_16x16x32_bf16 v[76:79], v[148:151], v[140:143], v[76:79]
ds_read_b128 v[180:183], v230 offset:6144
v_mfma_f32_16x16x32_bf16 v[80:83], v[152:155], v[140:143], v[80:83]
v_mfma_f32_16x16x32_bf16 v[84:87], v[156:159], v[140:143], v[84:87]
v_mfma_f32_16x16x32_bf16 v[88:91], v[160:163], v[140:143], v[88:91]
v_mfma_f32_16x16x32_bf16 v[92:95], v[164:167], v[140:143], v[92:95]
s_waitcnt vmcnt(8) lgkmcnt(0)
s_barrier
s_cmp_lg_u32 s71, s39
s_cbranch_scc1 G1cs_1_7
v_dot2c_f32_bf16 v236, v184, v245
v_dot2c_f32_bf16 v237, v188, v245
v_dot2c_f32_bf16 v238, v192, v245
v_dot2c_f32_bf16 v239, v196, v245
v_dot2c_f32_bf16 v240, v200, v245
v_dot2c_f32_bf16 v241, v204, v245
v_dot2c_f32_bf16 v236, v185, v245
v_dot2c_f32_bf16 v237, v189, v245
v_dot2c_f32_bf16 v238, v193, v245
v_dot2c_f32_bf16 v239, v197, v245
v_dot2c_f32_bf16 v240, v201, v245
v_dot2c_f32_bf16 v241, v205, v245
v_dot2c_f32_bf16 v236, v186, v245
v_dot2c_f32_bf16 v237, v190, v245
v_dot2c_f32_bf16 v238, v194, v245
v_dot2c_f32_bf16 v239, v198, v245
v_dot2c_f32_bf16 v240, v202, v245
v_dot2c_f32_bf16 v241, v206, v245
v_dot2c_f32_bf16 v236, v187, v245
v_dot2c_f32_bf16 v237, v191, v245
v_dot2c_f32_bf16 v238, v195, v245
v_dot2c_f32_bf16 v239, v199, v245
v_dot2c_f32_bf16 v240, v203, v245
v_dot2c_f32_bf16 v241, v207, v245
G1cs_1_7:
v_mfma_f32_16x16x32_bf16 v[0:3], v[184:187], v[168:171], v[0:3]
s_add_u32 s37, s37, 32768
s_cmp_ge_u32 s37, 98304
s_cselect_b32 s31, 98304, 0
s_sub_u32 s37, s37, s31
v_add_u32 v229, s37, v227
v_add_u32 v230, s37, v228
s_add_u32 m0, s28, 147456
s_nop 0
buffer_load_dwordx4 v226, s[16:19], s26 offen lds
v_mfma_f32_16x16x32_bf16 v[4:7], v[188:191], v[168:171], v[4:7]
v_mfma_f32_16x16x32_bf16 v[8:11], v[192:195], v[168:171], v[8:11]
s_add_u32 m0, s28, 155648
s_nop 0
buffer_load_dwordx4 v226, s[20:23], s26 offen lds
s_add_u32 s26, s26, 229376
s_cmp_ge_u32 s26, 7340032
s_cselect_b32 s31, 7340032, 0
s_sub_u32 s26, s26, s31
v_mfma_f32_16x16x32_bf16 v[12:15], v[196:199], v[168:171], v[12:15]
v_mfma_f32_16x16x32_bf16 v[16:19], v[200:203], v[168:171], v[16:19]
ds_read_b64_tr_b16 v[144:145], v231 offset:0
s_mov_b32 m0, s36
s_add_u32 s30, s25, 0
s_add_u32 s30, s30, s27
buffer_load_dwordx4 v224, s[40:43], s30 offen lds
v_mfma_f32_16x16x32_bf16 v[20:23], v[204:207], v[168:171], v[20:23]
ds_read_b64_tr_b16 v[146:147], v231 offset:1024
v_mfma_f32_16x16x32_bf16 v[24:27], v[184:187], v[172:175], v[24:27]
ds_read_b64_tr_b16 v[148:149], v232 offset:0
buffer_load_dwordx4 v225, s[40:43], s30 offen offset:1024 lds
v_mfma_f32_16x16x32_bf16 v[28:31], v[188:191], v[172:175], v[28:31]
ds_read_b64_tr_b16 v[150:151], v232 offset:1024
v_mfma_f32_16x16x32_bf16 v[32:35], v[192:195], v[172:175], v[32:35]
ds_read_b64_tr_b16 v[152:153], v233 offset:0
v_mfma_f32_16x16x32_bf16 v[36:39], v[196:199], v[172:175], v[36:39]
ds_read_b64_tr_b16 v[154:155], v233 offset:1024
v_mfma_f32_16x16x32_bf16 v[40:43], v[200:203], v[172:175], v[40:43]
ds_read_b64_tr_b16 v[156:157], v231 offset:8192
v_mfma_f32_16x16x32_bf16 v[44:47], v[204:207], v[172:175], v[44:47]
ds_read_b64_tr_b16 v[158:159], v231 offset:9216
v_mfma_f32_16x16x32_bf16 v[48:51], v[184:187], v[176:179], v[48:51]
ds_read_b64_tr_b16 v[160:161], v232 offset:8192
v_mfma_f32_16x16x32_bf16 v[52:55], v[188:191], v[176:179], v[52:55]
ds_read_b64_tr_b16 v[162:163], v232 offset:9216
v_mfma_f32_16x16x32_bf16 v[56:59], v[192:195], v[176:179], v[56:59]
ds_read_b64_tr_b16 v[164:165], v233 offset:8192
v_mfma_f32_16x16x32_bf16 v[60:63], v[196:199], v[176:179], v[60:63]
ds_read_b64_tr_b16 v[166:167], v233 offset:9216
v_mfma_f32_16x16x32_bf16 v[64:67], v[200:203], v[176:179], v[64:67]
ds_read_b128 v[128:131], v229 offset:0
v_mfma_f32_16x16x32_bf16 v[68:71], v[204:207], v[176:179], v[68:71]
ds_read_b128 v[132:135], v229 offset:2048
v_mfma_f32_16x16x32_bf16 v[72:75], v[184:187], v[180:183], v[72:75]
ds_read_b128 v[136:139], v229 offset:4096
v_mfma_f32_16x16x32_bf16 v[76:79], v[188:191], v[180:183], v[76:79]
ds_read_b128 v[140:143], v229 offset:6144
v_mfma_f32_16x16x32_bf16 v[80:83], v[192:195], v[180:183], v[80:83]
v_mfma_f32_16x16x32_bf16 v[84:87], v[196:199], v[180:183], v[84:87]
v_mfma_f32_16x16x32_bf16 v[88:91], v[200:203], v[180:183], v[88:91]
v_mfma_f32_16x16x32_bf16 v[92:95], v[204:207], v[180:183], v[92:95]
s_add_u32 s39, s39, 1
s_cmp_lt_u32 s39, 6
s_cbranch_scc1 G1L1_loop
s_waitcnt vmcnt(10) lgkmcnt(0)
s_barrier
v_mfma_f32_16x16x32_bf16 v[0:3], v[144:147], v[128:131], v[0:3]
s_add_u32 m0, s28, 98304
s_nop 0
buffer_load_dwordx4 v226, s[16:19], s26 offen lds
v_mfma_f32_16x16x32_bf16 v[4:7], v[148:151], v[128:131], v[4:7]
v_mfma_f32_16x16x32_bf16 v[8:11], v[152:155], v[128:131], v[8:11]
s_add_u32 m0, s28, 106496
s_nop 0
buffer_load_dwordx4 v226, s[20:23], s26 offen lds
s_add_u32 s26, s26, 229376
s_cmp_ge_u32 s26, 7340032
s_cselect_b32 s31, 7340032, 0
s_sub_u32 s26, s26, s31
v_mfma_f32_16x16x32_bf16 v[12:15], v[156:159], v[128:131], v[12:15]
v_mfma_f32_16x16x32_bf16 v[16:19], v[160:163], v[128:131], v[16:19]
ds_read_b64_tr_b16 v[184:185], v231 offset:16384
s_add_u32 m0, s36, 16384
s_add_u32 s30, s25, 262144
s_add_u32 s30, s30, s27
buffer_load_dwordx4 v224, s[40:43], s30 offen lds
v_mfma_f32_16x16x32_bf16 v[20:23], v[164:167], v[128:131], v[20:23]
ds_read_b64_tr_b16 v[186:187], v231 offset:17408
v_mfma_f32_16x16x32_bf16 v[24:27], v[144:147], v[132:135], v[24:27]
ds_read_b64_tr_b16 v[188:189], v232 offset:16384
buffer_load_dwordx4 v225, s[40:43], s30 offen offset:1024 lds
s_add_u32 s27, s27, 128
s_and_b32 s27, s27, 2047
s_add_u32 s36, s36, 32768
s_cmp_ge_u32 s36, 98304
s_cselect_b32 s31, 98304, 0
s_sub_u32 s36, s36, s31
v_mfma_f32_16x16x32_bf16 v[28:31], v[148:151], v[132:135], v[28:31]
ds_read_b64_tr_b16 v[190:191], v232 offset:17408
v_mfma_f32_16x16x32_bf16 v[32:35], v[152:155], v[132:135], v[32:35]
ds_read_b64_tr_b16 v[192:193], v233 offset:16384
v_mfma_f32_16x16x32_bf16 v[36:39], v[156:159], v[132:135], v[36:39]
ds_read_b64_tr_b16 v[194:195], v233 offset:17408
v_mfma_f32_16x16x32_bf16 v[40:43], v[160:163], v[132:135], v[40:43]
ds_read_b64_tr_b16 v[196:197], v231 offset:24576
v_mfma_f32_16x16x32_bf16 v[44:47], v[164:167], v[132:135], v[44:47]
ds_read_b64_tr_b16 v[198:199], v231 offset:25600
v_mfma_f32_16x16x32_bf16 v[48:51], v[144:147], v[136:139], v[48:51]
ds_read_b64_tr_b16 v[200:201], v232 offset:24576
v_mfma_f32_16x16x32_bf16 v[52:55], v[148:151], v[136:139], v[52:55]
ds_read_b64_tr_b16 v[202:203], v232 offset:25600
v_mfma_f32_16x16x32_bf16 v[56:59], v[152:155], v[136:139], v[56:59]
ds_read_b64_tr_b16 v[204:205], v233 offset:24576
v_mfma_f32_16x16x32_bf16 v[60:63], v[156:159], v[136:139], v[60:63]
ds_read_b64_tr_b16 v[206:207], v233 offset:25600
v_mfma_f32_16x16x32_bf16 v[64:67], v[160:163], v[136:139], v[64:67]
ds_read_b128 v[168:171], v230 offset:0
v_mfma_f32_16x16x32_bf16 v[68:71], v[164:167], v[136:139], v[68:71]
ds_read_b128 v[172:175], v230 offset:2048
v_mfma_f32_16x16x32_bf16 v[72:75], v[144:147], v[140:143], v[72:75]
ds_read_b128 v[176:179], v230 offset:4096
v_mfma_f32_16x16x32_bf16 v[76:79], v[148:151], v[140:143], v[76:79]
ds_read_b128 v[180:183], v230 offset:6144
v_mfma_f32_16x16x32_bf16 v[80:83], v[152:155], v[140:143], v[80:83]
v_mfma_f32_16x16x32_bf16 v[84:87], v[156:159], v[140:143], v[84:87]
v_mfma_f32_16x16x32_bf16 v[88:91], v[160:163], v[140:143], v[88:91]
v_mfma_f32_16x16x32_bf16 v[92:95], v[164:167], v[140:143], v[92:95]
s_waitcnt vmcnt(8) lgkmcnt(0)
s_barrier
v_mfma_f32_16x16x32_bf16 v[0:3], v[184:187], v[168:171], v[0:3]
s_add_u32 s37, s37, 32768
s_cmp_ge_u32 s37, 98304
s_cselect_b32 s31, 98304, 0
s_sub_u32 s37, s37, s31
v_add_u32 v229, s37, v227
v_add_u32 v230, s37, v228
s_add_u32 m0, s28, 114688
s_nop 0
buffer_load_dwordx4 v226, s[16:19], s26 offen lds
v_mfma_f32_16x16x32_bf16 v[4:7], v[188:191], v[168:171], v[4:7]
v_mfma_f32_16x16x32_bf16 v[8:11], v[192:195], v[168:171], v[8:11]
s_add_u32 m0, s28, 122880
s_nop 0
buffer_load_dwordx4 v226, s[20:23], s26 offen lds
s_add_u32 s26, s26, 229376
s_cmp_ge_u32 s26, 7340032
s_cselect_b32 s31, 7340032, 0
s_sub_u32 s26, s26, s31
v_mfma_f32_16x16x32_bf16 v[12:15], v[196:199], v[168:171], v[12:15]
v_mfma_f32_16x16x32_bf16 v[16:19], v[200:203], v[168:171], v[16:19]
ds_read_b64_tr_b16 v[144:145], v231 offset:32768
s_mov_b32 m0, s36
s_add_u32 s30, s25, 0
s_add_u32 s30, s30, s27
buffer_load_dwordx4 v224, s[40:43], s30 offen lds
v_mfma_f32_16x16x32_bf16 v[20:23], v[204:207], v[168:171], v[20:23]
ds_read_b64_tr_b16 v[146:147], v231 offset:33792
v_mfma_f32_16x16x32_bf16 v[24:27], v[184:187], v[172:175], v[24:27]
ds_read_b64_tr_b16 v[148:149], v232 offset:32768
buffer_load_dwordx4 v225, s[40:43], s30 offen offset:1024 lds
v_mfma_f32_16x16x32_bf16 v[28:31], v[188:191], v[172:175], v[28:31]
ds_read_b64_tr_b16 v[150:151], v232 offset:33792
v_mfma_f32_16x16x32_bf16 v[32:35], v[192:195], v[172:175], v[32:35]
ds_read_b64_tr_b16 v[152:153], v233 offset:32768
v_mfma_f32_16x16x32_bf16 v[36:39], v[196:199], v[172:175], v[36:39]
ds_read_b64_tr_b16 v[154:155], v233 offset:33792
v_mfma_f32_16x16x32_bf16 v[40:43], v[200:203], v[172:175], v[40:43]
ds_read_b64_tr_b16 v[156:157], v231 offset:40960
v_mfma_f32_16x16x32_bf16 v[44:47], v[204:207], v[172:175], v[44:47]
ds_read_b64_tr_b16 v[158:159], v231 offset:41984
v_mfma_f32_16x16x32_bf16 v[48:51], v[184:187], v[176:179], v[48:51]
ds_read_b64_tr_b16 v[160:161], v232 offset:40960
v_mfma_f32_16x16x32_bf16 v[52:55], v[188:191], v[176:179], v[52:55]
ds_read_b64_tr_b16 v[162:163], v232 offset:41984
v_mfma_f32_16x16x32_bf16 v[56:59], v[192:195], v[176:179], v[56:59]
ds_read_b64_tr_b16 v[164:165], v233 offset:40960
v_mfma_f32_16x16x32_bf16 v[60:63], v[196:199], v[176:179], v[60:63]
ds_read_b64_tr_b16 v[166:167], v233 offset:41984
v_mfma_f32_16x16x32_bf16 v[64:67], v[200:203], v[176:179], v[64:67]
ds_read_b128 v[128:131], v229 offset:0
v_mfma_f32_16x16x32_bf16 v[68:71], v[204:207], v[176:179], v[68:71]
ds_read_b128 v[132:135], v229 offset:2048
v_mfma_f32_16x16x32_bf16 v[72:75], v[184:187], v[180:183], v[72:75]
ds_read_b128 v[136:139], v229 offset:4096
v_mfma_f32_16x16x32_bf16 v[76:79], v[188:191], v[180:183], v[76:79]
ds_read_b128 v[140:143], v229 offset:6144
v_mfma_f32_16x16x32_bf16 v[80:83], v[192:195], v[180:183], v[80:83]
v_mfma_f32_16x16x32_bf16 v[84:87], v[196:199], v[180:183], v[84:87]
v_mfma_f32_16x16x32_bf16 v[88:91], v[200:203], v[180:183], v[88:91]
v_mfma_f32_16x16x32_bf16 v[92:95], v[204:207], v[180:183], v[92:95]
s_waitcnt vmcnt(10) lgkmcnt(0)
s_barrier
v_mfma_f32_16x16x32_bf16 v[0:3], v[144:147], v[128:131], v[0:3]
s_add_u32 m0, s28, 131072
s_nop 0
buffer_load_dwordx4 v226, s[16:19], s26 offen lds
v_mfma_f32_16x16x32_bf16 v[4:7], v[148:151], v[128:131], v[4:7]
v_mfma_f32_16x16x32_bf16 v[8:11], v[152:155], v[128:131], v[8:11]
s_add_u32 m0, s28, 139264
s_nop 0
buffer_load_dwordx4 v226, s[20:23], s26 offen lds
s_add_u32 s26, s26, 229376
s_cmp_ge_u32 s26, 7340032
s_cselect_b32 s31, 7340032, 0
s_sub_u32 s26, s26, s31
v_mfma_f32_16x16x32_bf16 v[12:15], v[156:159], v[128:131], v[12:15]
v_mfma_f32_16x16x32_bf16 v[16:19], v[160:163], v[128:131], v[16:19]
ds_read_b64_tr_b16 v[184:185], v231 offset:49152
s_add_u32 m0, s36, 16384
s_add_u32 s30, s25, 262144
s_add_u32 s30, s30, s27
buffer_load_dwordx4 v224, s[40:43], s30 offen lds
v_mfma_f32_16x16x32_bf16 v[20:23], v[164:167], v[128:131], v[20:23]
ds_read_b64_tr_b16 v[186:187], v231 offset:50176
v_mfma_f32_16x16x32_bf16 v[24:27], v[144:147], v[132:135], v[24:27]
ds_read_b64_tr_b16 v[188:189], v232 offset:49152
buffer_load_dwordx4 v225, s[40:43], s30 offen offset:1024 lds
s_add_u32 s27, s27, 128
s_and_b32 s27, s27, 2047
s_add_u32 s36, s36, 32768
s_cmp_ge_u32 s36, 98304
s_cselect_b32 s31, 98304, 0
s_sub_u32 s36, s36, s31
v_mfma_f32_16x16x32_bf16 v[28:31], v[148:151], v[132:135], v[28:31]
ds_read_b64_tr_b16 v[190:191], v232 offset:50176
v_mfma_f32_16x16x32_bf16 v[32:35], v[152:155], v[132:135], v[32:35]
ds_read_b64_tr_b16 v[192:193], v233 offset:49152
v_mfma_f32_16x16x32_bf16 v[36:39], v[156:159], v[132:135], v[36:39]
ds_read_b64_tr_b16 v[194:195], v233 offset:50176
v_mfma_f32_16x16x32_bf16 v[40:43], v[160:163], v[132:135], v[40:43]
ds_read_b64_tr_b16 v[196:197], v231 offset:57344
v_mfma_f32_16x16x32_bf16 v[44:47], v[164:167], v[132:135], v[44:47]
ds_read_b64_tr_b16 v[198:199], v231 offset:58368
v_mfma_f32_16x16x32_bf16 v[48:51], v[144:147], v[136:139], v[48:51]
ds_read_b64_tr_b16 v[200:201], v232 offset:57344
v_mfma_f32_16x16x32_bf16 v[52:55], v[148:151], v[136:139], v[52:55]
ds_read_b64_tr_b16 v[202:203], v232 offset:58368
v_mfma_f32_16x16x32_bf16 v[56:59], v[152:155], v[136:139], v[56:59]
ds_read_b64_tr_b16 v[204:205], v233 offset:57344
v_mfma_f32_16x16x32_bf16 v[60:63], v[156:159], v[136:139], v[60:63]
ds_read_b64_tr_b16 v[206:207], v233 offset:58368
v_mfma_f32_16x16x32_bf16 v[64:67], v[160:163], v[136:139], v[64:67]
ds_read_b128 v[168:171], v230 offset:0
v_mfma_f32_16x16x32_bf16 v[68:71], v[164:167], v[136:139], v[68:71]
ds_read_b128 v[172:175], v230 offset:2048
v_mfma_f32_16x16x32_bf16 v[72:75], v[144:147], v[140:143], v[72:75]
ds_read_b128 v[176:179], v230 offset:4096
v_mfma_f32_16x16x32_bf16 v[76:79], v[148:151], v[140:143], v[76:79]
ds_read_b128 v[180:183], v230 offset:6144
v_mfma_f32_16x16x32_bf16 v[80:83], v[152:155], v[140:143], v[80:83]
v_mfma_f32_16x16x32_bf16 v[84:87], v[156:159], v[140:143], v[84:87]
v_mfma_f32_16x16x32_bf16 v[88:91], v[160:163], v[140:143], v[88:91]
v_mfma_f32_16x16x32_bf16 v[92:95], v[164:167], v[140:143], v[92:95]
s_waitcnt vmcnt(8) lgkmcnt(0)
s_barrier
v_mfma_f32_16x16x32_bf16 v[0:3], v[184:187], v[168:171], v[0:3]
s_add_u32 s37, s37, 32768
s_cmp_ge_u32 s37, 98304
s_cselect_b32 s31, 98304, 0
s_sub_u32 s37, s37, s31
v_add_u32 v229, s37, v227
v_add_u32 v230, s37, v228
s_add_u32 m0, s28, 147456
s_nop 0
buffer_load_dwordx4 v226, s[16:19], s26 offen lds
v_mfma_f32_16x16x32_bf16 v[4:7], v[188:191], v[168:171], v[4:7]
v_mfma_f32_16x16x32_bf16 v[8:11], v[192:195], v[168:171], v[8:11]
s_add_u32 m0, s28, 155648
s_nop 0
buffer_load_dwordx4 v226, s[20:23], s26 offen lds
s_add_u32 s26, s26, 229376
s_cmp_ge_u32 s26, 7340032
s_cselect_b32 s31, 7340032, 0
s_sub_u32 s26, s26, s31
v_mfma_f32_16x16x32_bf16 v[12:15], v[196:199], v[168:171], v[12:15]
v_mfma_f32_16x16x32_bf16 v[16:19], v[200:203], v[168:171], v[16:19]
ds_read_b64_tr_b16 v[144:145], v231 offset:0
v_mfma_f32_16x16x32_bf16 v[20:23], v[204:207], v[168:171], v[20:23]
ds_read_b64_tr_b16 v[146:147], v231 offset:1024
v_mfma_f32_16x16x32_bf16 v[24:27], v[184:187], v[172:175], v[24:27]
ds_read_b64_tr_b16 v[148:149], v232 offset:0
v_mfma_f32_16x16x32_bf16 v[28:31], v[188:191], v[172:175], v[28:31]
ds_read_b64_tr_b16 v[150:151], v232 offset:1024
v_mfma_f32_16x16x32_bf16 v[32:35], v[192:195], v[172:175], v[32:35]
ds_read_b64_tr_b16 v[152:153], v233 offset:0
v_mfma_f32_16x16x32_bf16 v[36:39], v[196:199], v[172:175], v[36:39]
ds_read_b64_tr_b16 v[154:155], v233 offset:1024
v_mfma_f32_16x16x32_bf16 v[40:43], v[200:203], v[172:175], v[40:43]
ds_read_b64_tr_b16 v[156:157], v231 offset:8192
v_mfma_f32_16x16x32_bf16 v[44:47], v[204:207], v[172:175], v[44:47]
ds_read_b64_tr_b16 v[158:159], v231 offset:9216
v_mfma_f32_16x16x32_bf16 v[48:51], v[184:187], v[176:179], v[48:51]
ds_read_b64_tr_b16 v[160:161], v232 offset:8192
v_mfma_f32_16x16x32_bf16 v[52:55], v[188:191], v[176:179], v[52:55]
ds_read_b64_tr_b16 v[162:163], v232 offset:9216
v_mfma_f32_16x16x32_bf16 v[56:59], v[192:195], v[176:179], v[56:59]
ds_read_b64_tr_b16 v[164:165], v233 offset:8192
v_mfma_f32_16x16x32_bf16 v[60:63], v[196:199], v[176:179], v[60:63]
ds_read_b64_tr_b16 v[166:167], v233 offset:9216
v_mfma_f32_16x16x32_bf16 v[64:67], v[200:203], v[176:179], v[64:67]
ds_read_b128 v[128:131], v229 offset:0
v_mfma_f32_16x16x32_bf16 v[68:71], v[204:207], v[176:179], v[68:71]
ds_read_b128 v[132:135], v229 offset:2048
v_mfma_f32_16x16x32_bf16 v[72:75], v[184:187], v[180:183], v[72:75]
ds_read_b128 v[136:139], v229 offset:4096
v_mfma_f32_16x16x32_bf16 v[76:79], v[188:191], v[180:183], v[76:79]
ds_read_b128 v[140:143], v229 offset:6144
v_mfma_f32_16x16x32_bf16 v[80:83], v[192:195], v[180:183], v[80:83]
v_mfma_f32_16x16x32_bf16 v[84:87], v[196:199], v[180:183], v[84:87]
v_mfma_f32_16x16x32_bf16 v[88:91], v[200:203], v[180:183], v[88:91]
v_mfma_f32_16x16x32_bf16 v[92:95], v[204:207], v[180:183], v[92:95]
s_waitcnt vmcnt(8) lgkmcnt(0)
s_barrier
v_and_b32 v253, 15, v235
v_lshlrev_b32 v253, 3, v253
s_lshl_b32 s82, s32, 11
s_lshl_b32 s83, s35, 9
s_add_u32 s82, s82, s83
buffer_load_dwordx2 v[236:237], v253, s[12:15], s82 offen offset:0 sc1
buffer_load_dwordx2 v[238:239], v253, s[12:15], s82 offen offset:128 sc1
buffer_load_dwordx2 v[240:241], v253, s[12:15], s82 offen offset:256 sc1
buffer_load_dwordx2 v[242:243], v253, s[12:15], s82 offen offset:384 sc1
v_lshlrev_b32 v253, 2, v235
s_mul_i32 s82, s33, 112
s_add_u32 s82, s82, 64
s_lshl_b32 s82, s82, 2
s_add_u32 s82, s82, 2097152
s_add_u32 s83, s82, 0
buffer_load_dword v244, v253, s[12:15], s83 offen sc1
s_add_u32 s83, s82, 14336
buffer_load_dword v245, v253, s[12:15], s83 offen sc1
v_mfma_f32_16x16x32_bf16 v[0:3], v[144:147], v[128:131], v[0:3]
v_mfma_f32_16x16x32_bf16 v[4:7], v[148:151], v[128:131], v[4:7]
v_mfma_f32_16x16x32_bf16 v[8:11], v[152:155], v[128:131], v[8:11]
v_mfma_f32_16x16x32_bf16 v[12:15], v[156:159], v[128:131], v[12:15]
v_mfma_f32_16x16x32_bf16 v[16:19], v[160:163], v[128:131], v[16:19]
ds_read_b64_tr_b16 v[184:185], v231 offset:16384
v_mfma_f32_16x16x32_bf16 v[20:23], v[164:167], v[128:131], v[20:23]
ds_read_b64_tr_b16 v[186:187], v231 offset:17408
v_mfma_f32_16x16x32_bf16 v[24:27], v[144:147], v[132:135], v[24:27]
ds_read_b64_tr_b16 v[188:189], v232 offset:16384
v_mfma_f32_16x16x32_bf16 v[28:31], v[148:151], v[132:135], v[28:31]
ds_read_b64_tr_b16 v[190:191], v232 offset:17408
v_mfma_f32_16x16x32_bf16 v[32:35], v[152:155], v[132:135], v[32:35]
ds_read_b64_tr_b16 v[192:193], v233 offset:16384
v_mfma_f32_16x16x32_bf16 v[36:39], v[156:159], v[132:135], v[36:39]
ds_read_b64_tr_b16 v[194:195], v233 offset:17408
v_mfma_f32_16x16x32_bf16 v[40:43], v[160:163], v[132:135], v[40:43]
ds_read_b64_tr_b16 v[196:197], v231 offset:24576
v_mfma_f32_16x16x32_bf16 v[44:47], v[164:167], v[132:135], v[44:47]
ds_read_b64_tr_b16 v[198:199], v231 offset:25600
v_mfma_f32_16x16x32_bf16 v[48:51], v[144:147], v[136:139], v[48:51]
ds_read_b64_tr_b16 v[200:201], v232 offset:24576
v_mfma_f32_16x16x32_bf16 v[52:55], v[148:151], v[136:139], v[52:55]
ds_read_b64_tr_b16 v[202:203], v232 offset:25600
v_mfma_f32_16x16x32_bf16 v[56:59], v[152:155], v[136:139], v[56:59]
ds_read_b64_tr_b16 v[204:205], v233 offset:24576
v_mfma_f32_16x16x32_bf16 v[60:63], v[156:159], v[136:139], v[60:63]
ds_read_b64_tr_b16 v[206:207], v233 offset:25600
v_mfma_f32_16x16x32_bf16 v[64:67], v[160:163], v[136:139], v[64:67]
ds_read_b128 v[168:171], v230 offset:0
v_mfma_f32_16x16x32_bf16 v[68:71], v[164:167], v[136:139], v[68:71]
ds_read_b128 v[172:175], v230 offset:2048
v_mfma_f32_16x16x32_bf16 v[72:75], v[144:147], v[140:143], v[72:75]
ds_read_b128 v[176:179], v230 offset:4096
v_mfma_f32_16x16x32_bf16 v[76:79], v[148:151], v[140:143], v[76:79]
ds_read_b128 v[180:183], v230 offset:6144
v_mfma_f32_16x16x32_bf16 v[80:83], v[152:155], v[140:143], v[80:83]
v_mfma_f32_16x16x32_bf16 v[84:87], v[156:159], v[140:143], v[84:87]
v_mfma_f32_16x16x32_bf16 v[88:91], v[160:163], v[140:143], v[88:91]
v_mfma_f32_16x16x32_bf16 v[92:95], v[164:167], v[140:143], v[92:95]
s_waitcnt vmcnt(8) lgkmcnt(0)
s_barrier
s_load_dwordx4 s[4:7], s[0:1], 32
v_mfma_f32_16x16x32_bf16 v[0:3], v[184:187], v[168:171], v[0:3]
s_add_u32 s37, s37, 32768
s_cmp_ge_u32 s37, 98304
s_cselect_b32 s31, 98304, 0
s_sub_u32 s37, s37, s31
v_add_u32 v229, s37, v227
v_add_u32 v230, s37, v228
v_mfma_f32_16x16x32_bf16 v[4:7], v[188:191], v[168:171], v[4:7]
v_mfma_f32_16x16x32_bf16 v[8:11], v[192:195], v[168:171], v[8:11]
v_mfma_f32_16x16x32_bf16 v[12:15], v[196:199], v[168:171], v[12:15]
v_mfma_f32_16x16x32_bf16 v[16:19], v[200:203], v[168:171], v[16:19]
ds_read_b64_tr_b16 v[144:145], v231 offset:32768
v_mfma_f32_16x16x32_bf16 v[20:23], v[204:207], v[168:171], v[20:23]
ds_read_b64_tr_b16 v[146:147], v231 offset:33792
v_mfma_f32_16x16x32_bf16 v[24:27], v[184:187], v[172:175], v[24:27]
ds_read_b64_tr_b16 v[148:149], v232 offset:32768
v_mfma_f32_16x16x32_bf16 v[28:31], v[188:191], v[172:175], v[28:31]
ds_read_b64_tr_b16 v[150:151], v232 offset:33792
v_mfma_f32_16x16x32_bf16 v[32:35], v[192:195], v[172:175], v[32:35]
ds_read_b64_tr_b16 v[152:153], v233 offset:32768
v_mfma_f32_16x16x32_bf16 v[36:39], v[196:199], v[172:175], v[36:39]
ds_read_b64_tr_b16 v[154:155], v233 offset:33792
v_mfma_f32_16x16x32_bf16 v[40:43], v[200:203], v[172:175], v[40:43]
ds_read_b64_tr_b16 v[156:157], v231 offset:40960
v_mfma_f32_16x16x32_bf16 v[44:47], v[204:207], v[172:175], v[44:47]
ds_read_b64_tr_b16 v[158:159], v231 offset:41984
v_mfma_f32_16x16x32_bf16 v[48:51], v[184:187], v[176:179], v[48:51]
ds_read_b64_tr_b16 v[160:161], v232 offset:40960
v_mfma_f32_16x16x32_bf16 v[52:55], v[188:191], v[176:179], v[52:55]
ds_read_b64_tr_b16 v[162:163], v232 offset:41984
v_mfma_f32_16x16x32_bf16 v[56:59], v[192:195], v[176:179], v[56:59]
ds_read_b64_tr_b16 v[164:165], v233 offset:40960
v_mfma_f32_16x16x32_bf16 v[60:63], v[196:199], v[176:179], v[60:63]
ds_read_b64_tr_b16 v[166:167], v233 offset:41984
v_mfma_f32_16x16x32_bf16 v[64:67], v[200:203], v[176:179], v[64:67]
ds_read_b128 v[128:131], v229 offset:0
v_mfma_f32_16x16x32_bf16 v[68:71], v[204:207], v[176:179], v[68:71]
ds_read_b128 v[132:135], v229 offset:2048
v_mfma_f32_16x16x32_bf16 v[72:75], v[184:187], v[180:183], v[72:75]
ds_read_b128 v[136:139], v229 offset:4096
v_mfma_f32_16x16x32_bf16 v[76:79], v[188:191], v[180:183], v[76:79]
ds_read_b128 v[140:143], v229 offset:6144
v_mfma_f32_16x16x32_bf16 v[80:83], v[192:195], v[180:183], v[80:83]
v_mfma_f32_16x16x32_bf16 v[84:87], v[196:199], v[180:183], v[84:87]
v_mfma_f32_16x16x32_bf16 v[88:91], v[200:203], v[180:183], v[88:91]
v_mfma_f32_16x16x32_bf16 v[92:95], v[204:207], v[180:183], v[92:95]
s_waitcnt vmcnt(6) lgkmcnt(0)
s_barrier
s_mov_b32 s72, s4
s_and_b32 s73, s5, 0xffff
s_mov_b32 s74, 4194304
s_mov_b32 s75, 0x20000
s_mov_b32 s76, s6
s_and_b32 s77, s7, 0xffff
s_mov_b32 s78, 2048
s_mov_b32 s79, 0x20000
s_and_b32 s50, s24, 3
s_lshr_b32 s51, s24, 2
s_lshl_b32 s52, s2, 2
s_add_u32 s52, s52, s50
s_mul_i32 s53, s50, 20736
s_add_u32 s53, s53, 32768
s_lshl_b32 s54, s52, 12
v_lshlrev_b32 v255, 4, v235
s_lshl_b32 s55, s51, 2
v_add_u32 v253, s55, v255
s_mul_i32 s55, s51, 8320
s_add_u32 s55, s55, s53
s_add_u32 m0, s55, 0
s_add_u32 s56, s54, 4194304
buffer_load_dwordx4 v253, s[12:15], s56 offen offset:0 sc1 lds
buffer_load_dwordx4 v253, s[12:15], s56 offen offset:1024 sc1 lds
buffer_load_dwordx4 v253, s[12:15], s56 offen offset:2048 sc1 lds
buffer_load_dwordx4 v253, s[12:15], s56 offen offset:3072 sc1 lds
s_mul_i32 s55, s51, 8320
s_add_u32 s55, s55, s53
s_add_u32 m0, s55, 4160
s_add_u32 s56, s54, 8388608
buffer_load_dwordx4 v253, s[12:15], s56 offen offset:0 sc1 lds
buffer_load_dwordx4 v253, s[12:15], s56 offen offset:1024 sc1 lds
buffer_load_dwordx4 v253, s[12:15], s56 offen offset:2048 sc1 lds
buffer_load_dwordx4 v253, s[12:15], s56 offen offset:3072 sc1 lds
s_lshl_b32 s55, s51, 11
s_add_u32 s56, s54, s55
s_add_u32 s55, s55, s53
s_add_u32 m0, s55, 16640
s_nop 0
buffer_load_dwordx4 v255, s[72:75], s56 offen offset:0 lds
buffer_load_dwordx4 v255, s[72:75], s56 offen offset:1024 lds
s_lshl_b32 s55, s52, 1
v_mov_b32 v254, s55
buffer_load_ushort v254, v254, s[76:79], 0 offen
v_mfma_f32_16x16x32_bf16 v[0:3], v[144:147], v[128:131], v[0:3]
v_mfma_f32_16x16x32_bf16 v[4:7], v[148:151], v[128:131], v[4:7]
v_mfma_f32_16x16x32_bf16 v[8:11], v[152:155], v[128:131], v[8:11]
v_mfma_f32_16x16x32_bf16 v[12:15], v[156:159], v[128:131], v[12:15]
v_mfma_f32_16x16x32_bf16 v[16:19], v[160:163], v[128:131], v[16:19]
ds_read_b64_tr_b16 v[184:185], v231 offset:49152
v_mfma_f32_16x16x32_bf16 v[20:23], v[164:167], v[128:131], v[20:23]
ds_read_b64_tr_b16 v[186:187], v231 offset:50176
v_mfma_f32_16x16x32_bf16 v[24:27], v[144:147], v[132:135], v[24:27]
ds_read_b64_tr_b16 v[188:189], v232 offset:49152
v_mfma_f32_16x16x32_bf16 v[28:31], v[148:151], v[132:135], v[28:31]
ds_read_b64_tr_b16 v[190:191], v232 offset:50176
v_mfma_f32_16x16x32_bf16 v[32:35], v[152:155], v[132:135], v[32:35]
ds_read_b64_tr_b16 v[192:193], v233 offset:49152
v_mfma_f32_16x16x32_bf16 v[36:39], v[156:159], v[132:135], v[36:39]
ds_read_b64_tr_b16 v[194:195], v233 offset:50176
v_mfma_f32_16x16x32_bf16 v[40:43], v[160:163], v[132:135], v[40:43]
ds_read_b64_tr_b16 v[196:197], v231 offset:57344
v_mfma_f32_16x16x32_bf16 v[44:47], v[164:167], v[132:135], v[44:47]
ds_read_b64_tr_b16 v[198:199], v231 offset:58368
v_mfma_f32_16x16x32_bf16 v[48:51], v[144:147], v[136:139], v[48:51]
ds_read_b64_tr_b16 v[200:201], v232 offset:57344
v_mfma_f32_16x16x32_bf16 v[52:55], v[148:151], v[136:139], v[52:55]
ds_read_b64_tr_b16 v[202:203], v232 offset:58368
v_mfma_f32_16x16x32_bf16 v[56:59], v[152:155], v[136:139], v[56:59]
ds_read_b64_tr_b16 v[204:205], v233 offset:57344
v_mfma_f32_16x16x32_bf16 v[60:63], v[156:159], v[136:139], v[60:63]
ds_read_b64_tr_b16 v[206:207], v233 offset:58368
v_mfma_f32_16x16x32_bf16 v[64:67], v[160:163], v[136:139], v[64:67]
ds_read_b128 v[168:171], v230 offset:0
v_mfma_f32_16x16x32_bf16 v[68:71], v[164:167], v[136:139], v[68:71]
ds_read_b128 v[172:175], v230 offset:2048
v_mfma_f32_16x16x32_bf16 v[72:75], v[144:147], v[140:143], v[72:75]
ds_read_b128 v[176:179], v230 offset:4096
v_mfma_f32_16x16x32_bf16 v[76:79], v[148:151], v[140:143], v[76:79]
ds_read_b128 v[180:183], v230 offset:6144
v_mfma_f32_16x16x32_bf16 v[80:83], v[152:155], v[140:143], v[80:83]
v_mfma_f32_16x16x32_bf16 v[84:87], v[156:159], v[140:143], v[84:87]
v_mfma_f32_16x16x32_bf16 v[88:91], v[160:163], v[140:143], v[88:91]
v_mfma_f32_16x16x32_bf16 v[92:95], v[164:167], v[140:143], v[92:95]
s_waitcnt lgkmcnt(0)
v_mfma_f32_16x16x32_bf16 v[0:3], v[184:187], v[168:171], v[0:3]
v_mfma_f32_16x16x32_bf16 v[4:7], v[188:191], v[168:171], v[4:7]
v_mfma_f32_16x16x32_bf16 v[8:11], v[192:195], v[168:171], v[8:11]
v_mfma_f32_16x16x32_bf16 v[12:15], v[196:199], v[168:171], v[12:15]
v_mfma_f32_16x16x32_bf16 v[16:19], v[200:203], v[168:171], v[16:19]
v_mfma_f32_16x16x32_bf16 v[20:23], v[204:207], v[168:171], v[20:23]
v_mfma_f32_16x16x32_bf16 v[24:27], v[184:187], v[172:175], v[24:27]
v_mfma_f32_16x16x32_bf16 v[28:31], v[188:191], v[172:175], v[28:31]
v_mfma_f32_16x16x32_bf16 v[32:35], v[192:195], v[172:175], v[32:35]
v_mfma_f32_16x16x32_bf16 v[36:39], v[196:199], v[172:175], v[36:39]
v_mfma_f32_16x16x32_bf16 v[40:43], v[200:203], v[172:175], v[40:43]
v_mfma_f32_16x16x32_bf16 v[44:47], v[204:207], v[172:175], v[44:47]
v_mfma_f32_16x16x32_bf16 v[48:51], v[184:187], v[176:179], v[48:51]
v_mfma_f32_16x16x32_bf16 v[52:55], v[188:191], v[176:179], v[52:55]
v_mfma_f32_16x16x32_bf16 v[56:59], v[192:195], v[176:179], v[56:59]
v_mfma_f32_16x16x32_bf16 v[60:63], v[196:199], v[176:179], v[60:63]
v_mfma_f32_16x16x32_bf16 v[64:67], v[200:203], v[176:179], v[64:67]
v_mfma_f32_16x16x32_bf16 v[68:71], v[204:207], v[176:179], v[68:71]
v_mfma_f32_16x16x32_bf16 v[72:75], v[184:187], v[180:183], v[72:75]
v_mfma_f32_16x16x32_bf16 v[76:79], v[188:191], v[180:183], v[76:79]
v_mfma_f32_16x16x32_bf16 v[80:83], v[192:195], v[180:183], v[80:83]
v_mfma_f32_16x16x32_bf16 v[84:87], v[196:199], v[180:183], v[84:87]
v_mfma_f32_16x16x32_bf16 v[88:91], v[200:203], v[180:183], v[88:91]
v_mfma_f32_16x16x32_bf16 v[92:95], v[204:207], v[180:183], v[92:95]
s_waitcnt vmcnt(11)
s_load_dwordx2 s[64:65], s[0:1], 72
v_lshlrev_b32 v224, 4, v235
s_lshl_b32 s82, s2, 15
s_lshl_b32 s83, s24, 12
s_add_u32 s82, s82, s83
s_waitcnt lgkmcnt(0)
s_mov_b32 s60, s64
s_and_b32 s61, s65, 0xffff
s_mov_b32 s62, 7340032
s_mov_b32 s63, 0x20000
buffer_load_dwordx4 v[228:231], v224, s[60:63], s82 offen offset:0
buffer_load_dwordx4 v[228:231], v224, s[60:63], s82 offen offset:1024
buffer_load_dwordx4 v[228:231], v224, s[60:63], s82 offen offset:2048
buffer_load_dwordx4 v[228:231], v224, s[60:63], s82 offen offset:3072
v_lshlrev_b32 v152, 2, v235
s_lshl_b32 s30, s24, 9
s_add_u32 s30, s30, 115712
v_add_u32 v152, s30, v152
ds_write_b32 v152, v244
ds_write_b32 v152, v245 offset:256
v_lshrrev_b32 v153, 4, v235
v_lshlrev_b32 v153, 4, v153
v_add_u32 v153, s30, v153
s_waitcnt lgkmcnt(0)
ds_read_b128 v[168:171], v153 offset:0
ds_read_b128 v[172:175], v153 offset:64
ds_read_b128 v[176:179], v153 offset:128
ds_read_b128 v[180:183], v153 offset:256
ds_read_b128 v[184:187], v153 offset:320
ds_read_b128 v[188:191], v153 offset:384
v_lshrrev_b32 v154, 4, v235
v_and_b32 v155, 1, v154
v_lshlrev_b32 v155, 10, v155
v_lshrrev_b32 v154, 1, v154
v_lshlrev_b32 v154, 8, v154
v_add_u32 v155, v155, v154
v_and_b32 v154, 15, v235
v_lshlrev_b32 v154, 4, v154
v_add_u32 v155, v155, v154
s_mul_i32 s38, s33, 7
s_lshl_b32 s39, s32, 1
s_lshr_b32 s30, s35, 1
s_add_u32 s39, s39, s30
s_mul_i32 s39, s39, 917504
s_and_b32 s30, s35, 1
s_lshl_b32 s30, s30, 12
s_add_u32 s39, s39, s30
s_add_u32 s39, s39, 16777216
s_mov_b32 s83, 0xbfb8aa3b
v_mul_f32 v136, s83, v237
v_mul_f32 v137, v237, v237
v_mul_f32 v138, s83, v239
v_mul_f32 v139, v239, v239
v_mul_f32 v140, s83, v241
v_mul_f32 v141, v241, v241
v_mul_f32 v142, s83, v243
v_mul_f32 v143, v243, v243
s_waitcnt lgkmcnt(0)
v_pk_fma_f32 v[0:1], v[236:237], v[168:169], v[0:1] op_sel_hi:[0,1,1] neg_lo:[1,0,0] neg_hi:[1,0,0]
v_pk_fma_f32 v[12:13], v[236:237], v[180:181], v[12:13] op_sel_hi:[0,1,1] neg_lo:[1,0,0] neg_hi:[1,0,0]
v_pk_fma_f32 v[2:3], v[236:237], v[170:171], v[2:3] op_sel_hi:[0,1,1] neg_lo:[1,0,0] neg_hi:[1,0,0]
v_pk_fma_f32 v[14:15], v[236:237], v[182:183], v[14:15] op_sel_hi:[0,1,1] neg_lo:[1,0,0] neg_hi:[1,0,0]
v_pk_fma_f32 v[4:5], v[236:237], v[172:173], v[4:5] op_sel_hi:[0,1,1] neg_lo:[1,0,0] neg_hi:[1,0,0]
v_pk_fma_f32 v[16:17], v[236:237], v[184:185], v[16:17] op_sel_hi:[0,1,1] neg_lo:[1,0,0] neg_hi:[1,0,0]
v_pk_fma_f32 v[6:7], v[236:237], v[174:175], v[6:7] op_sel_hi:[0,1,1] neg_lo:[1,0,0] neg_hi:[1,0,0]
v_pk_fma_f32 v[18:19], v[236:237], v[186:187], v[18:19] op_sel_hi:[0,1,1] neg_lo:[1,0,0] neg_hi:[1,0,0]
v_pk_fma_f32 v[8:9], v[236:237], v[176:177], v[8:9] op_sel_hi:[0,1,1] neg_lo:[1,0,0] neg_hi:[1,0,0]
v_pk_fma_f32 v[20:21], v[236:237], v[188:189], v[20:21] op_sel_hi:[0,1,1] neg_lo:[1,0,0] neg_hi:[1,0,0]
v_pk_fma_f32 v[10:11], v[236:237], v[178:179], v[10:11] op_sel_hi:[0,1,1] neg_lo:[1,0,0] neg_hi:[1,0,0]
v_pk_fma_f32 v[22:23], v[236:237], v[190:191], v[22:23] op_sel_hi:[0,1,1] neg_lo:[1,0,0] neg_hi:[1,0,0]
v_pk_mul_f32 v[156:157], v[0:1], v[136:137] op_sel_hi:[1,0]
v_pk_mul_f32 v[158:159], v[2:3], v[136:137] op_sel_hi:[1,0]
v_pk_mul_f32 v[160:161], v[4:5], v[136:137] op_sel_hi:[1,0]
v_pk_mul_f32 v[162:163], v[6:7], v[136:137] op_sel_hi:[1,0]
v_pk_mul_f32 v[164:165], v[8:9], v[136:137] op_sel_hi:[1,0]
v_pk_mul_f32 v[166:167], v[10:11], v[136:137] op_sel_hi:[1,0]
v_exp_f32 v156, v156
v_exp_f32 v157, v157
v_exp_f32 v158, v158
v_exp_f32 v159, v159
v_exp_f32 v160, v160
v_exp_f32 v161, v161
v_exp_f32 v162, v162
v_exp_f32 v163, v163
v_exp_f32 v164, v164
v_exp_f32 v165, v165
v_exp_f32 v166, v166
v_exp_f32 v167, v167
v_pk_mul_f32 v[192:193], v[0:1], v[12:13]
v_pk_mul_f32 v[194:195], v[2:3], v[14:15]
v_pk_mul_f32 v[196:197], v[4:5], v[16:17]
v_pk_mul_f32 v[198:199], v[6:7], v[18:19]
v_pk_mul_f32 v[200:201], v[8:9], v[20:21]
v_pk_mul_f32 v[202:203], v[10:11], v[22:23]
v_pk_add_f32 v[156:157], v[156:157], 1.0 op_sel_hi:[1,0]
v_pk_add_f32 v[158:159], v[158:159], 1.0 op_sel_hi:[1,0]
v_pk_add_f32 v[160:161], v[160:161], 1.0 op_sel_hi:[1,0]
v_pk_add_f32 v[162:163], v[162:163], 1.0 op_sel_hi:[1,0]
v_pk_add_f32 v[164:165], v[164:165], 1.0 op_sel_hi:[1,0]
v_pk_add_f32 v[166:167], v[166:167], 1.0 op_sel_hi:[1,0]
v_rcp_f32 v156, v156
v_rcp_f32 v157, v157
v_rcp_f32 v158, v158
v_rcp_f32 v159, v159
v_rcp_f32 v160, v160
v_rcp_f32 v161, v161
v_rcp_f32 v162, v162
v_rcp_f32 v163, v163
v_rcp_f32 v164, v164
v_rcp_f32 v165, v165
v_rcp_f32 v166, v166
v_rcp_f32 v167, v167
v_pk_mul_f32 v[192:193], v[192:193], v[136:137] op_sel:[0,1] op_sel_hi:[1,1]
v_pk_mul_f32 v[194:195], v[194:195], v[136:137] op_sel:[0,1] op_sel_hi:[1,1]
v_pk_mul_f32 v[196:197], v[196:197], v[136:137] op_sel:[0,1] op_sel_hi:[1,1]
v_pk_mul_f32 v[198:199], v[198:199], v[136:137] op_sel:[0,1] op_sel_hi:[1,1]
v_pk_mul_f32 v[200:201], v[200:201], v[136:137] op_sel:[0,1] op_sel_hi:[1,1]
v_pk_mul_f32 v[202:203], v[202:203], v[136:137] op_sel:[0,1] op_sel_hi:[1,1]
v_pk_mul_f32 v[192:193], v[192:193], v[156:157]
v_pk_mul_f32 v[194:195], v[194:195], v[158:159]
v_pk_mul_f32 v[196:197], v[196:197], v[160:161]
v_pk_mul_f32 v[198:199], v[198:199], v[162:163]
v_pk_mul_f32 v[200:201], v[200:201], v[164:165]
v_pk_mul_f32 v[202:203], v[202:203], v[166:167]
v_cvt_pk_bf16_f32 v0, v192, v193
v_cvt_pk_bf16_f32 v1, v194, v195
v_cvt_pk_bf16_f32 v4, v196, v197
v_cvt_pk_bf16_f32 v5, v198, v199
v_cvt_pk_bf16_f32 v8, v200, v201
v_cvt_pk_bf16_f32 v9, v202, v203
v_pk_fma_f32 v[24:25], v[238:239], v[168:169], v[24:25] op_sel_hi:[0,1,1] neg_lo:[1,0,0] neg_hi:[1,0,0]
v_pk_fma_f32 v[36:37], v[238:239], v[180:181], v[36:37] op_sel_hi:[0,1,1] neg_lo:[1,0,0] neg_hi:[1,0,0]
v_pk_fma_f32 v[26:27], v[238:239], v[170:171], v[26:27] op_sel_hi:[0,1,1] neg_lo:[1,0,0] neg_hi:[1,0,0]
v_pk_fma_f32 v[38:39], v[238:239], v[182:183], v[38:39] op_sel_hi:[0,1,1] neg_lo:[1,0,0] neg_hi:[1,0,0]
v_pk_fma_f32 v[28:29], v[238:239], v[172:173], v[28:29] op_sel_hi:[0,1,1] neg_lo:[1,0,0] neg_hi:[1,0,0]
v_pk_fma_f32 v[40:41], v[238:239], v[184:185], v[40:41] op_sel_hi:[0,1,1] neg_lo:[1,0,0] neg_hi:[1,0,0]
v_pk_fma_f32 v[30:31], v[238:239], v[174:175], v[30:31] op_sel_hi:[0,1,1] neg_lo:[1,0,0] neg_hi:[1,0,0]
v_pk_fma_f32 v[42:43], v[238:239], v[186:187], v[42:43] op_sel_hi:[0,1,1] neg_lo:[1,0,0] neg_hi:[1,0,0]
v_pk_fma_f32 v[32:33], v[238:239], v[176:177], v[32:33] op_sel_hi:[0,1,1] neg_lo:[1,0,0] neg_hi:[1,0,0]
v_pk_fma_f32 v[44:45], v[238:239], v[188:189], v[44:45] op_sel_hi:[0,1,1] neg_lo:[1,0,0] neg_hi:[1,0,0]
v_pk_fma_f32 v[34:35], v[238:239], v[178:179], v[34:35] op_sel_hi:[0,1,1] neg_lo:[1,0,0] neg_hi:[1,0,0]
v_pk_fma_f32 v[46:47], v[238:239], v[190:191], v[46:47] op_sel_hi:[0,1,1] neg_lo:[1,0,0] neg_hi:[1,0,0]
v_pk_mul_f32 v[156:157], v[24:25], v[138:139] op_sel_hi:[1,0]
v_pk_mul_f32 v[158:159], v[26:27], v[138:139] op_sel_hi:[1,0]
v_pk_mul_f32 v[160:161], v[28:29], v[138:139] op_sel_hi:[1,0]
v_pk_mul_f32 v[162:163], v[30:31], v[138:139] op_sel_hi:[1,0]
v_pk_mul_f32 v[164:165], v[32:33], v[138:139] op_sel_hi:[1,0]
v_pk_mul_f32 v[166:167], v[34:35], v[138:139] op_sel_hi:[1,0]
v_exp_f32 v156, v156
v_exp_f32 v157, v157
v_exp_f32 v158, v158
v_exp_f32 v159, v159
v_exp_f32 v160, v160
v_exp_f32 v161, v161
v_exp_f32 v162, v162
v_exp_f32 v163, v163
v_exp_f32 v164, v164
v_exp_f32 v165, v165
v_exp_f32 v166, v166
v_exp_f32 v167, v167
v_pk_mul_f32 v[192:193], v[24:25], v[36:37]
v_pk_mul_f32 v[194:195], v[26:27], v[38:39]
v_pk_mul_f32 v[196:197], v[28:29], v[40:41]
v_pk_mul_f32 v[198:199], v[30:31], v[42:43]
v_pk_mul_f32 v[200:201], v[32:33], v[44:45]
v_pk_mul_f32 v[202:203], v[34:35], v[46:47]
v_pk_add_f32 v[156:157], v[156:157], 1.0 op_sel_hi:[1,0]
v_pk_add_f32 v[158:159], v[158:159], 1.0 op_sel_hi:[1,0]
v_pk_add_f32 v[160:161], v[160:161], 1.0 op_sel_hi:[1,0]
v_pk_add_f32 v[162:163], v[162:163], 1.0 op_sel_hi:[1,0]
v_pk_add_f32 v[164:165], v[164:165], 1.0 op_sel_hi:[1,0]
v_pk_add_f32 v[166:167], v[166:167], 1.0 op_sel_hi:[1,0]
v_rcp_f32 v156, v156
v_rcp_f32 v157, v157
v_rcp_f32 v158, v158
v_rcp_f32 v159, v159
v_rcp_f32 v160, v160
v_rcp_f32 v161, v161
v_rcp_f32 v162, v162
v_rcp_f32 v163, v163
v_rcp_f32 v164, v164
v_rcp_f32 v165, v165
v_rcp_f32 v166, v166
v_rcp_f32 v167, v167
v_pk_mul_f32 v[192:193], v[192:193], v[138:139] op_sel:[0,1] op_sel_hi:[1,1]
v_pk_mul_f32 v[194:195], v[194:195], v[138:139] op_sel:[0,1] op_sel_hi:[1,1]
v_pk_mul_f32 v[196:197], v[196:197], v[138:139] op_sel:[0,1] op_sel_hi:[1,1]
v_pk_mul_f32 v[198:199], v[198:199], v[138:139] op_sel:[0,1] op_sel_hi:[1,1]
v_pk_mul_f32 v[200:201], v[200:201], v[138:139] op_sel:[0,1] op_sel_hi:[1,1]
v_pk_mul_f32 v[202:203], v[202:203], v[138:139] op_sel:[0,1] op_sel_hi:[1,1]
v_pk_mul_f32 v[192:193], v[192:193], v[156:157]
v_pk_mul_f32 v[194:195], v[194:195], v[158:159]
v_pk_mul_f32 v[196:197], v[196:197], v[160:161]
v_pk_mul_f32 v[198:199], v[198:199], v[162:163]
v_pk_mul_f32 v[200:201], v[200:201], v[164:165]
v_pk_mul_f32 v[202:203], v[202:203], v[166:167]
v_cvt_pk_bf16_f32 v24, v192, v193
v_cvt_pk_bf16_f32 v25, v194, v195
v_cvt_pk_bf16_f32 v28, v196, v197
v_cvt_pk_bf16_f32 v29, v198, v199
v_cvt_pk_bf16_f32 v32, v200, v201
v_cvt_pk_bf16_f32 v33, v202, v203
v_mov_b32 v2, v24
v_mov_b32 v3, v25
s_add_u32 s30, s38, 4
s_lshr_b32 s31, s30, 1
s_lshl_b32 s31, s31, 13
v_permlane16_swap_b32 v0, v2
v_permlane16_swap_b32 v1, v3
s_and_b32 s30, s30, 1
s_lshl_b32 s30, s30, 9
s_add_u32 s30, s30, s31
s_add_u32 s30, s30, s39
buffer_store_dwordx4 v[0:3], v155, s[12:15], s30 offen offset:0 sc1
v_mov_b32 v6, v28
v_mov_b32 v7, v29
s_add_u32 s30, s38, 5
s_lshr_b32 s31, s30, 1
s_lshl_b32 s31, s31, 13
v_permlane16_swap_b32 v4, v6
v_permlane16_swap_b32 v5, v7
s_and_b32 s30, s30, 1
s_lshl_b32 s30, s30, 9
s_add_u32 s30, s30, s31
s_add_u32 s30, s30, s39
buffer_store_dwordx4 v[4:7], v155, s[12:15], s30 offen offset:0 sc1
v_mov_b32 v10, v32
v_mov_b32 v11, v33
s_add_u32 s30, s38, 6
s_lshr_b32 s31, s30, 1
s_lshl_b32 s31, s31, 13
v_permlane16_swap_b32 v8, v10
v_permlane16_swap_b32 v9, v11
s_and_b32 s30, s30, 1
s_lshl_b32 s30, s30, 9
s_add_u32 s30, s30, s31
s_add_u32 s30, s30, s39
buffer_store_dwordx4 v[8:11], v155, s[12:15], s30 offen offset:0 sc1
v_pk_fma_f32 v[48:49], v[240:241], v[168:169], v[48:49] op_sel_hi:[0,1,1] neg_lo:[1,0,0] neg_hi:[1,0,0]
v_pk_fma_f32 v[60:61], v[240:241], v[180:181], v[60:61] op_sel_hi:[0,1,1] neg_lo:[1,0,0] neg_hi:[1,0,0]
v_pk_fma_f32 v[50:51], v[240:241], v[170:171], v[50:51] op_sel_hi:[0,1,1] neg_lo:[1,0,0] neg_hi:[1,0,0]
v_pk_fma_f32 v[62:63], v[240:241], v[182:183], v[62:63] op_sel_hi:[0,1,1] neg_lo:[1,0,0] neg_hi:[1,0,0]
v_pk_fma_f32 v[52:53], v[240:241], v[172:173], v[52:53] op_sel_hi:[0,1,1] neg_lo:[1,0,0] neg_hi:[1,0,0]
v_pk_fma_f32 v[64:65], v[240:241], v[184:185], v[64:65] op_sel_hi:[0,1,1] neg_lo:[1,0,0] neg_hi:[1,0,0]
v_pk_fma_f32 v[54:55], v[240:241], v[174:175], v[54:55] op_sel_hi:[0,1,1] neg_lo:[1,0,0] neg_hi:[1,0,0]
v_pk_fma_f32 v[66:67], v[240:241], v[186:187], v[66:67] op_sel_hi:[0,1,1] neg_lo:[1,0,0] neg_hi:[1,0,0]
v_pk_fma_f32 v[56:57], v[240:241], v[176:177], v[56:57] op_sel_hi:[0,1,1] neg_lo:[1,0,0] neg_hi:[1,0,0]
v_pk_fma_f32 v[68:69], v[240:241], v[188:189], v[68:69] op_sel_hi:[0,1,1] neg_lo:[1,0,0] neg_hi:[1,0,0]
v_pk_fma_f32 v[58:59], v[240:241], v[178:179], v[58:59] op_sel_hi:[0,1,1] neg_lo:[1,0,0] neg_hi:[1,0,0]
v_pk_fma_f32 v[70:71], v[240:241], v[190:191], v[70:71] op_sel_hi:[0,1,1] neg_lo:[1,0,0] neg_hi:[1,0,0]
v_pk_mul_f32 v[156:157], v[48:49], v[140:141] op_sel_hi:[1,0]
v_pk_mul_f32 v[158:159], v[50:51], v[140:141] op_sel_hi:[1,0]
v_pk_mul_f32 v[160:161], v[52:53], v[140:141] op_sel_hi:[1,0]
v_pk_mul_f32 v[162:163], v[54:55], v[140:141] op_sel_hi:[1,0]
v_pk_mul_f32 v[164:165], v[56:57], v[140:141] op_sel_hi:[1,0]
v_pk_mul_f32 v[166:167], v[58:59], v[140:141] op_sel_hi:[1,0]
v_exp_f32 v156, v156
v_exp_f32 v157, v157
v_exp_f32 v158, v158
v_exp_f32 v159, v159
v_exp_f32 v160, v160
v_exp_f32 v161, v161
v_exp_f32 v162, v162
v_exp_f32 v163, v163
v_exp_f32 v164, v164
v_exp_f32 v165, v165
v_exp_f32 v166, v166
v_exp_f32 v167, v167
v_pk_mul_f32 v[192:193], v[48:49], v[60:61]
v_pk_mul_f32 v[194:195], v[50:51], v[62:63]
v_pk_mul_f32 v[196:197], v[52:53], v[64:65]
v_pk_mul_f32 v[198:199], v[54:55], v[66:67]
v_pk_mul_f32 v[200:201], v[56:57], v[68:69]
v_pk_mul_f32 v[202:203], v[58:59], v[70:71]
v_pk_add_f32 v[156:157], v[156:157], 1.0 op_sel_hi:[1,0]
v_pk_add_f32 v[158:159], v[158:159], 1.0 op_sel_hi:[1,0]
v_pk_add_f32 v[160:161], v[160:161], 1.0 op_sel_hi:[1,0]
v_pk_add_f32 v[162:163], v[162:163], 1.0 op_sel_hi:[1,0]
v_pk_add_f32 v[164:165], v[164:165], 1.0 op_sel_hi:[1,0]
v_pk_add_f32 v[166:167], v[166:167], 1.0 op_sel_hi:[1,0]
v_rcp_f32 v156, v156
v_rcp_f32 v157, v157
v_rcp_f32 v158, v158
v_rcp_f32 v159, v159
v_rcp_f32 v160, v160
v_rcp_f32 v161, v161
v_rcp_f32 v162, v162
v_rcp_f32 v163, v163
v_rcp_f32 v164, v164
v_rcp_f32 v165, v165
v_rcp_f32 v166, v166
v_rcp_f32 v167, v167
v_pk_mul_f32 v[192:193], v[192:193], v[140:141] op_sel:[0,1] op_sel_hi:[1,1]
v_pk_mul_f32 v[194:195], v[194:195], v[140:141] op_sel:[0,1] op_sel_hi:[1,1]
v_pk_mul_f32 v[196:197], v[196:197], v[140:141] op_sel:[0,1] op_sel_hi:[1,1]
v_pk_mul_f32 v[198:199], v[198:199], v[140:141] op_sel:[0,1] op_sel_hi:[1,1]
v_pk_mul_f32 v[200:201], v[200:201], v[140:141] op_sel:[0,1] op_sel_hi:[1,1]
v_pk_mul_f32 v[202:203], v[202:203], v[140:141] op_sel:[0,1] op_sel_hi:[1,1]
v_pk_mul_f32 v[192:193], v[192:193], v[156:157]
v_pk_mul_f32 v[194:195], v[194:195], v[158:159]
v_pk_mul_f32 v[196:197], v[196:197], v[160:161]
v_pk_mul_f32 v[198:199], v[198:199], v[162:163]
v_pk_mul_f32 v[200:201], v[200:201], v[164:165]
v_pk_mul_f32 v[202:203], v[202:203], v[166:167]
v_cvt_pk_bf16_f32 v48, v192, v193
v_cvt_pk_bf16_f32 v49, v194, v195
v_cvt_pk_bf16_f32 v52, v196, v197
v_cvt_pk_bf16_f32 v53, v198, v199
v_cvt_pk_bf16_f32 v56, v200, v201
v_cvt_pk_bf16_f32 v57, v202, v203
v_pk_fma_f32 v[72:73], v[242:243], v[168:169], v[72:73] op_sel_hi:[0,1,1] neg_lo:[1,0,0] neg_hi:[1,0,0]
v_pk_fma_f32 v[84:85], v[242:243], v[180:181], v[84:85] op_sel_hi:[0,1,1] neg_lo:[1,0,0] neg_hi:[1,0,0]
v_pk_fma_f32 v[74:75], v[242:243], v[170:171], v[74:75] op_sel_hi:[0,1,1] neg_lo:[1,0,0] neg_hi:[1,0,0]
v_pk_fma_f32 v[86:87], v[242:243], v[182:183], v[86:87] op_sel_hi:[0,1,1] neg_lo:[1,0,0] neg_hi:[1,0,0]
v_pk_fma_f32 v[76:77], v[242:243], v[172:173], v[76:77] op_sel_hi:[0,1,1] neg_lo:[1,0,0] neg_hi:[1,0,0]
v_pk_fma_f32 v[88:89], v[242:243], v[184:185], v[88:89] op_sel_hi:[0,1,1] neg_lo:[1,0,0] neg_hi:[1,0,0]
v_pk_fma_f32 v[78:79], v[242:243], v[174:175], v[78:79] op_sel_hi:[0,1,1] neg_lo:[1,0,0] neg_hi:[1,0,0]
v_pk_fma_f32 v[90:91], v[242:243], v[186:187], v[90:91] op_sel_hi:[0,1,1] neg_lo:[1,0,0] neg_hi:[1,0,0]
v_pk_fma_f32 v[80:81], v[242:243], v[176:177], v[80:81] op_sel_hi:[0,1,1] neg_lo:[1,0,0] neg_hi:[1,0,0]
v_pk_fma_f32 v[92:93], v[242:243], v[188:189], v[92:93] op_sel_hi:[0,1,1] neg_lo:[1,0,0] neg_hi:[1,0,0]
v_pk_fma_f32 v[82:83], v[242:243], v[178:179], v[82:83] op_sel_hi:[0,1,1] neg_lo:[1,0,0] neg_hi:[1,0,0]
v_pk_fma_f32 v[94:95], v[242:243], v[190:191], v[94:95] op_sel_hi:[0,1,1] neg_lo:[1,0,0] neg_hi:[1,0,0]
v_pk_mul_f32 v[156:157], v[72:73], v[142:143] op_sel_hi:[1,0]
v_pk_mul_f32 v[158:159], v[74:75], v[142:143] op_sel_hi:[1,0]
v_pk_mul_f32 v[160:161], v[76:77], v[142:143] op_sel_hi:[1,0]
v_pk_mul_f32 v[162:163], v[78:79], v[142:143] op_sel_hi:[1,0]
v_pk_mul_f32 v[164:165], v[80:81], v[142:143] op_sel_hi:[1,0]
v_pk_mul_f32 v[166:167], v[82:83], v[142:143] op_sel_hi:[1,0]
v_exp_f32 v156, v156
v_exp_f32 v157, v157
v_exp_f32 v158, v158
v_exp_f32 v159, v159
v_exp_f32 v160, v160
v_exp_f32 v161, v161
v_exp_f32 v162, v162
v_exp_f32 v163, v163
v_exp_f32 v164, v164
v_exp_f32 v165, v165
v_exp_f32 v166, v166
v_exp_f32 v167, v167
v_pk_mul_f32 v[192:193], v[72:73], v[84:85]
v_pk_mul_f32 v[194:195], v[74:75], v[86:87]
v_pk_mul_f32 v[196:197], v[76:77], v[88:89]
v_pk_mul_f32 v[198:199], v[78:79], v[90:91]
v_pk_mul_f32 v[200:201], v[80:81], v[92:93]
v_pk_mul_f32 v[202:203], v[82:83], v[94:95]
v_pk_add_f32 v[156:157], v[156:157], 1.0 op_sel_hi:[1,0]
v_pk_add_f32 v[158:159], v[158:159], 1.0 op_sel_hi:[1,0]
v_pk_add_f32 v[160:161], v[160:161], 1.0 op_sel_hi:[1,0]
v_pk_add_f32 v[162:163], v[162:163], 1.0 op_sel_hi:[1,0]
v_pk_add_f32 v[164:165], v[164:165], 1.0 op_sel_hi:[1,0]
v_pk_add_f32 v[166:167], v[166:167], 1.0 op_sel_hi:[1,0]
v_rcp_f32 v156, v156
v_rcp_f32 v157, v157
v_rcp_f32 v158, v158
v_rcp_f32 v159, v159
v_rcp_f32 v160, v160
v_rcp_f32 v161, v161
v_rcp_f32 v162, v162
v_rcp_f32 v163, v163
v_rcp_f32 v164, v164
v_rcp_f32 v165, v165
v_rcp_f32 v166, v166
v_rcp_f32 v167, v167
v_pk_mul_f32 v[192:193], v[192:193], v[142:143] op_sel:[0,1] op_sel_hi:[1,1]
v_pk_mul_f32 v[194:195], v[194:195], v[142:143] op_sel:[0,1] op_sel_hi:[1,1]
v_pk_mul_f32 v[196:197], v[196:197], v[142:143] op_sel:[0,1] op_sel_hi:[1,1]
v_pk_mul_f32 v[198:199], v[198:199], v[142:143] op_sel:[0,1] op_sel_hi:[1,1]
v_pk_mul_f32 v[200:201], v[200:201], v[142:143] op_sel:[0,1] op_sel_hi:[1,1]
v_pk_mul_f32 v[202:203], v[202:203], v[142:143] op_sel:[0,1] op_sel_hi:[1,1]
v_pk_mul_f32 v[192:193], v[192:193], v[156:157]
v_pk_mul_f32 v[194:195], v[194:195], v[158:159]
v_pk_mul_f32 v[196:197], v[196:197], v[160:161]
v_pk_mul_f32 v[198:199], v[198:199], v[162:163]
v_pk_mul_f32 v[200:201], v[200:201], v[164:165]
v_pk_mul_f32 v[202:203], v[202:203], v[166:167]
v_cvt_pk_bf16_f32 v72, v192, v193
v_cvt_pk_bf16_f32 v73, v194, v195
v_cvt_pk_bf16_f32 v76, v196, v197
v_cvt_pk_bf16_f32 v77, v198, v199
v_cvt_pk_bf16_f32 v80, v200, v201
v_cvt_pk_bf16_f32 v81, v202, v203
v_mov_b32 v50, v72
v_mov_b32 v51, v73
s_add_u32 s30, s38, 4
s_lshr_b32 s31, s30, 1
s_lshl_b32 s31, s31, 13
v_permlane16_swap_b32 v48, v50
v_permlane16_swap_b32 v49, v51
s_and_b32 s30, s30, 1
s_lshl_b32 s30, s30, 9
s_add_u32 s30, s30, s31
s_add_u32 s30, s30, s39
buffer_store_dwordx4 v[48:51], v155, s[12:15], s30 offen offset:2048 sc1
v_mov_b32 v54, v76
v_mov_b32 v55, v77
s_add_u32 s30, s38, 5
s_lshr_b32 s31, s30, 1
s_lshl_b32 s31, s31, 13
v_permlane16_swap_b32 v52, v54
v_permlane16_swap_b32 v53, v55
s_and_b32 s30, s30, 1
s_lshl_b32 s30, s30, 9
s_add_u32 s30, s30, s31
s_add_u32 s30, s30, s39
buffer_store_dwordx4 v[52:55], v155, s[12:15], s30 offen offset:2048 sc1
v_mov_b32 v58, v80
v_mov_b32 v59, v81
s_add_u32 s30, s38, 6
s_lshr_b32 s31, s30, 1
s_lshl_b32 s31, s31, 13
v_permlane16_swap_b32 v56, v58
v_permlane16_swap_b32 v57, v59
s_and_b32 s30, s30, 1
s_lshl_b32 s30, s30, 9
s_add_u32 s30, s30, s31
s_add_u32 s30, s30, s39
buffer_store_dwordx4 v[56:59], v155, s[12:15], s30 offen offset:2048 sc1
s_waitcnt vmcnt(10)
F_conv:
v_mov_b32 v163, v254
v_and_b32 v3, 15, v235
v_lshrrev_b32 v4, 4, v235
v_and_b32 v5, 1, v4
v_lshrrev_b32 v6, 1, v4
v_not_b32 v7, v3
v_and_b32 v7, 3, v7
v_mul_u32_u24 v8, 4158, v7
v_lshlrev_b32 v9, 5, v6
v_sub_u32 v8, v8, v9
v_lshlrev_b32 v9, 1, v3
v_sub_u32 v8, v8, v9
v_lshlrev_b32 v9, 4, v5
v_add_u32 v8, v8, v9
s_lshl_b32 s55, s51, 8
s_sub_u32 s56, s53, s55
s_add_u32 s57, s56, 318
v_add_u32 v160, s57, v8
v_lshlrev_b32 v8, 5, v3
v_lshlrev_b32 v9, 5, v6
v_sub_u32 v8, v8, v9
v_lshlrev_b32 v9, 4, v5
v_add_u32 v8, v8, v9
s_add_u32 s57, s56, 16448
v_add_u32 v161, s57, v8
v_lshlrev_b32 v8, 3, v5
v_sub_u32 v8, v3, v8
v_lshlrev_b32 v9, 6, v6
v_add_u32 v8, v8, v9
s_lshl_b32 s55, s51, 6
v_add_u32 v8, s55, v8
v_cmp_le_i32 vcc, 0, v8
v_cmp_le_i32 s[46:47], 1, v8
s_nop 1
v_cndmask_b32_e64 v9, 0, -1, vcc
v_cndmask_b32_e64 v10, 0, -1, s[46:47]
v_and_b32 v9, 0xffff, v9
v_and_b32 v10, 0xffff0000, v10
v_or_b32 v168, v9, v10
v_cmp_le_i32 vcc, 2, v8
v_cmp_le_i32 s[46:47], 3, v8
s_nop 1
v_cndmask_b32_e64 v9, 0, -1, vcc
v_cndmask_b32_e64 v10, 0, -1, s[46:47]
v_and_b32 v9, 0xffff, v9
v_and_b32 v10, 0xffff0000, v10
v_or_b32 v169, v9, v10
v_cmp_le_i32 vcc, 4, v8
v_cmp_le_i32 s[46:47], 5, v8
s_nop 1
v_cndmask_b32_e64 v9, 0, -1, vcc
v_cndmask_b32_e64 v10, 0, -1, s[46:47]
v_and_b32 v9, 0xffff, v9
v_and_b32 v10, 0xffff0000, v10
v_or_b32 v170, v9, v10
v_cmp_le_i32 vcc, 6, v8
v_cmp_le_i32 s[46:47], 7, v8
s_nop 1
v_cndmask_b32_e64 v9, 0, -1, vcc
v_cndmask_b32_e64 v10, 0, -1, s[46:47]
v_and_b32 v9, 0xffff, v9
v_and_b32 v10, 0xffff0000, v10
v_or_b32 v171, v9, v10
v_sub_u32 v8, v3, v6
s_lshl_b32 s55, s51, 3
s_add_u32 s56, s55, 0
v_cmp_le_i32 s[88:89], s56, v8
s_add_u32 s56, s55, 2
v_cmp_le_i32 s[90:91], s56, v8
s_add_u32 s56, s55, 4
v_cmp_le_i32 s[92:93], s56, v8
s_add_u32 s56, s55, 6
v_cmp_le_i32 s[94:95], s56, v8
s_barrier
ds_read_b128 v[64:67], v161 offset:192
ds_read_b128 v[68:71], v161 offset:704
ds_read_b128 v[72:75], v161 offset:1216
ds_read_b128 v[76:79], v161 offset:1728
ds_read_b128 v[80:83], v161 offset:2240
ds_read_b128 v[84:87], v161 offset:2752
ds_read_b128 v[88:91], v161 offset:3264
ds_read_b128 v[92:95], v161 offset:3776
ds_read_b64 v[32:33], v160 offset:3776
ds_read_b64 v[34:35], v160 offset:3784
ds_read_b64 v[36:37], v160 offset:3264
ds_read_b64 v[38:39], v160 offset:3272
ds_read_b64 v[40:41], v160 offset:2752
ds_read_b64 v[42:43], v160 offset:2760
ds_read_b64 v[44:45], v160 offset:2240
ds_read_b64 v[46:47], v160 offset:2248
ds_read_b64 v[48:49], v160 offset:1728
ds_read_b64 v[50:51], v160 offset:1736
ds_read_b64 v[52:53], v160 offset:1216
ds_read_b64 v[54:55], v160 offset:1224
ds_read_b64 v[56:57], v160 offset:704
ds_read_b64 v[58:59], v160 offset:712
ds_read_b64 v[60:61], v160 offset:192
ds_read_b64 v[62:63], v160 offset:200
s_waitcnt lgkmcnt(0)
v_cndmask_b32 v64, 0, v64, s[88:89]
v_cndmask_b32 v65, 0, v65, s[88:89]
v_cndmask_b32 v66, 0, v66, s[88:89]
v_cndmask_b32 v67, 0, v67, s[88:89]
v_and_b32 v32, v32, v168
v_and_b32 v33, v33, v169
v_and_b32 v34, v34, v170
v_and_b32 v35, v35, v171
v_mfma_f32_16x16x32_bf16 v[184:187], v[36:39], v[68:71], 0
ds_read_b128 v[128:131], v161 offset:128
v_mfma_f32_16x16x32_bf16 v[188:191], v[36:39], v[72:75], 0
ds_read_b128 v[132:135], v161 offset:640
v_mfma_f32_16x16x32_bf16 v[192:195], v[36:39], v[76:79], 0
ds_read_b128 v[136:139], v161 offset:1152
v_mfma_f32_16x16x32_bf16 v[196:199], v[36:39], v[80:83], 0
ds_read_b128 v[140:143], v161 offset:1664
v_mfma_f32_16x16x32_bf16 v[200:203], v[36:39], v[84:87], 0
ds_read_b128 v[144:147], v161 offset:2176
v_mfma_f32_16x16x32_bf16 v[204:207], v[36:39], v[88:91], 0
ds_read_b128 v[148:151], v161 offset:2688
v_mfma_f32_16x16x32_bf16 v[188:191], v[40:43], v[68:71], v[188:191]
ds_read_b128 v[152:155], v161 offset:3200
v_mfma_f32_16x16x32_bf16 v[192:195], v[40:43], v[72:75], v[192:195]
ds_read_b128 v[156:159], v161 offset:3712
v_mfma_f32_16x16x32_bf16 v[196:199], v[40:43], v[76:79], v[196:199]
ds_read_b64 v[96:97], v160 offset:3712
v_mfma_f32_16x16x32_bf16 v[200:203], v[40:43], v[80:83], v[200:203]
ds_read_b64 v[98:99], v160 offset:3720
v_mfma_f32_16x16x32_bf16 v[204:207], v[40:43], v[84:87], v[204:207]
ds_read_b64 v[100:101], v160 offset:3200
v_mfma_f32_16x16x32_bf16 v[192:195], v[44:47], v[68:71], v[192:195]
ds_read_b64 v[102:103], v160 offset:3208
v_mfma_f32_16x16x32_bf16 v[196:199], v[44:47], v[72:75], v[196:199]
ds_read_b64 v[104:105], v160 offset:2688
v_mfma_f32_16x16x32_bf16 v[200:203], v[44:47], v[76:79], v[200:203]
ds_read_b64 v[106:107], v160 offset:2696
v_mfma_f32_16x16x32_bf16 v[204:207], v[44:47], v[80:83], v[204:207]
ds_read_b64 v[108:109], v160 offset:2176
v_mfma_f32_16x16x32_bf16 v[196:199], v[48:51], v[68:71], v[196:199]
ds_read_b64 v[110:111], v160 offset:2184
v_mfma_f32_16x16x32_bf16 v[200:203], v[48:51], v[72:75], v[200:203]
ds_read_b64 v[112:113], v160 offset:1664
v_mfma_f32_16x16x32_bf16 v[204:207], v[48:51], v[76:79], v[204:207]
ds_read_b64 v[114:115], v160 offset:1672
v_mfma_f32_16x16x32_bf16 v[200:203], v[52:55], v[68:71], v[200:203]
ds_read_b64 v[116:117], v160 offset:1152
v_mfma_f32_16x16x32_bf16 v[204:207], v[52:55], v[72:75], v[204:207]
ds_read_b64 v[118:119], v160 offset:1160
v_mfma_f32_16x16x32_bf16 v[204:207], v[56:59], v[68:71], v[204:207]
ds_read_b64 v[120:121], v160 offset:640
v_mfma_f32_16x16x32_bf16 v[176:179], v[32:35], v[64:67], 0
ds_read_b64 v[122:123], v160 offset:648
v_mfma_f32_16x16x32_bf16 v[180:183], v[32:35], v[68:71], 0
ds_read_b64 v[124:125], v160 offset:128
v_mfma_f32_16x16x32_bf16 v[184:187], v[32:35], v[72:75], v[184:187]
ds_read_b64 v[126:127], v160 offset:136
v_mfma_f32_16x16x32_bf16 v[188:191], v[32:35], v[76:79], v[188:191]
v_mfma_f32_16x16x32_bf16 v[192:195], v[32:35], v[80:83], v[192:195]
v_mfma_f32_16x16x32_bf16 v[196:199], v[32:35], v[84:87], v[196:199]
v_mfma_f32_16x16x32_bf16 v[200:203], v[32:35], v[88:91], v[200:203]
v_mfma_f32_16x16x32_bf16 v[204:207], v[32:35], v[92:95], v[204:207]
v_mfma_f32_16x16x32_bf16 v[180:183], v[36:39], v[64:67], v[180:183]
v_mfma_f32_16x16x32_bf16 v[184:187], v[40:43], v[64:67], v[184:187]
v_mfma_f32_16x16x32_bf16 v[188:191], v[44:47], v[64:67], v[188:191]
v_mfma_f32_16x16x32_bf16 v[192:195], v[48:51], v[64:67], v[192:195]
v_mfma_f32_16x16x32_bf16 v[196:199], v[52:55], v[64:67], v[196:199]
v_mfma_f32_16x16x32_bf16 v[200:203], v[56:59], v[64:67], v[200:203]
v_mfma_f32_16x16x32_bf16 v[204:207], v[60:63], v[64:67], v[204:207]
s_waitcnt vmcnt(0)
s_barrier
s_cmp_lg_u32 s24, 0
s_cbranch_scc1 CV_nosig
s_lshl_b32 s55, s32, 12
s_add_u32 s55, s55, 1048576
v_lshlrev_b32 v166, 7, v235
v_mov_b32 v167, 1
s_mov_b64 s[46:47], exec
s_mov_b64 exec, 0xffffffff
buffer_atomic_add v167, v166, s[12:15], s55 offen sc1
s_mov_b64 exec, s[46:47]
CV_nosig:
s_waitcnt lgkmcnt(0)
v_cndmask_b32 v128, 0, v128, s[90:91]
v_cndmask_b32 v129, 0, v129, s[90:91]
v_cndmask_b32 v130, 0, v130, s[90:91]
v_cndmask_b32 v131, 0, v131, s[90:91]
v_mfma_f32_16x16x32_bf16 v[184:187], v[100:103], v[132:135], v[184:187]
ds_read_b128 v[64:67], v161 offset:64
v_mfma_f32_16x16x32_bf16 v[188:191], v[100:103], v[136:139], v[188:191]
ds_read_b128 v[68:71], v161 offset:576
v_mfma_f32_16x16x32_bf16 v[192:195], v[100:103], v[140:143], v[192:195]
ds_read_b128 v[72:75], v161 offset:1088
v_mfma_f32_16x16x32_bf16 v[196:199], v[100:103], v[144:147], v[196:199]
ds_read_b128 v[76:79], v161 offset:1600
v_mfma_f32_16x16x32_bf16 v[200:203], v[100:103], v[148:151], v[200:203]
ds_read_b128 v[80:83], v161 offset:2112
v_mfma_f32_16x16x32_bf16 v[204:207], v[100:103], v[152:155], v[204:207]
ds_read_b128 v[84:87], v161 offset:2624
v_mfma_f32_16x16x32_bf16 v[188:191], v[104:107], v[132:135], v[188:191]
ds_read_b128 v[88:91], v161 offset:3136
v_mfma_f32_16x16x32_bf16 v[192:195], v[104:107], v[136:139], v[192:195]
ds_read_b128 v[92:95], v161 offset:3648
v_mfma_f32_16x16x32_bf16 v[196:199], v[104:107], v[140:143], v[196:199]
ds_read_b64 v[32:33], v160 offset:3648
v_mfma_f32_16x16x32_bf16 v[200:203], v[104:107], v[144:147], v[200:203]
ds_read_b64 v[34:35], v160 offset:3656
v_mfma_f32_16x16x32_bf16 v[204:207], v[104:107], v[148:151], v[204:207]
ds_read_b64 v[36:37], v160 offset:3136
v_mfma_f32_16x16x32_bf16 v[192:195], v[108:111], v[132:135], v[192:195]
ds_read_b64 v[38:39], v160 offset:3144
v_mfma_f32_16x16x32_bf16 v[196:199], v[108:111], v[136:139], v[196:199]
ds_read_b64 v[40:41], v160 offset:2624
v_mfma_f32_16x16x32_bf16 v[200:203], v[108:111], v[140:143], v[200:203]
ds_read_b64 v[42:43], v160 offset:2632
v_mfma_f32_16x16x32_bf16 v[204:207], v[108:111], v[144:147], v[204:207]
ds_read_b64 v[44:45], v160 offset:2112
v_mfma_f32_16x16x32_bf16 v[196:199], v[112:115], v[132:135], v[196:199]
ds_read_b64 v[46:47], v160 offset:2120
v_mfma_f32_16x16x32_bf16 v[200:203], v[112:115], v[136:139], v[200:203]
ds_read_b64 v[48:49], v160 offset:1600
v_mfma_f32_16x16x32_bf16 v[204:207], v[112:115], v[140:143], v[204:207]
ds_read_b64 v[50:51], v160 offset:1608
v_mfma_f32_16x16x32_bf16 v[200:203], v[116:119], v[132:135], v[200:203]
ds_read_b64 v[52:53], v160 offset:1088
v_mfma_f32_16x16x32_bf16 v[204:207], v[116:119], v[136:139], v[204:207]
ds_read_b64 v[54:55], v160 offset:1096
v_mfma_f32_16x16x32_bf16 v[204:207], v[120:123], v[132:135], v[204:207]
ds_read_b64 v[56:57], v160 offset:576
v_mfma_f32_16x16x32_bf16 v[176:179], v[96:99], v[128:131], v[176:179]
ds_read_b64 v[58:59], v160 offset:584
v_mfma_f32_16x16x32_bf16 v[180:183], v[96:99], v[132:135], v[180:183]
ds_read_b64 v[60:61], v160 offset:64
v_mfma_f32_16x16x32_bf16 v[184:187], v[96:99], v[136:139], v[184:187]
ds_read_b64 v[62:63], v160 offset:72
v_mfma_f32_16x16x32_bf16 v[188:191], v[96:99], v[140:143], v[188:191]
v_mfma_f32_16x16x32_bf16 v[192:195], v[96:99], v[144:147], v[192:195]
v_mfma_f32_16x16x32_bf16 v[196:199], v[96:99], v[148:151], v[196:199]
v_mfma_f32_16x16x32_bf16 v[200:203], v[96:99], v[152:155], v[200:203]
v_mfma_f32_16x16x32_bf16 v[204:207], v[96:99], v[156:159], v[204:207]
v_mfma_f32_16x16x32_bf16 v[180:183], v[100:103], v[128:131], v[180:183]
v_mfma_f32_16x16x32_bf16 v[184:187], v[104:107], v[128:131], v[184:187]
v_mfma_f32_16x16x32_bf16 v[188:191], v[108:111], v[128:131], v[188:191]
v_mfma_f32_16x16x32_bf16 v[192:195], v[112:115], v[128:131], v[192:195]
v_mfma_f32_16x16x32_bf16 v[196:199], v[116:119], v[128:131], v[196:199]
v_mfma_f32_16x16x32_bf16 v[200:203], v[120:123], v[128:131], v[200:203]
v_mfma_f32_16x16x32_bf16 v[204:207], v[124:127], v[128:131], v[204:207]
s_waitcnt lgkmcnt(0)
v_cndmask_b32 v64, 0, v64, s[92:93]
v_cndmask_b32 v65, 0, v65, s[92:93]
v_cndmask_b32 v66, 0, v66, s[92:93]
v_cndmask_b32 v67, 0, v67, s[92:93]
v_mfma_f32_16x16x32_bf16 v[184:187], v[36:39], v[68:71], v[184:187]
ds_read_b128 v[128:131], v161 offset:0
v_mfma_f32_16x16x32_bf16 v[188:191], v[36:39], v[72:75], v[188:191]
ds_read_b128 v[132:135], v161 offset:512
v_mfma_f32_16x16x32_bf16 v[192:195], v[36:39], v[76:79], v[192:195]
ds_read_b128 v[136:139], v161 offset:1024
v_mfma_f32_16x16x32_bf16 v[196:199], v[36:39], v[80:83], v[196:199]
ds_read_b128 v[140:143], v161 offset:1536
v_mfma_f32_16x16x32_bf16 v[200:203], v[36:39], v[84:87], v[200:203]
ds_read_b128 v[144:147], v161 offset:2048
v_mfma_f32_16x16x32_bf16 v[204:207], v[36:39], v[88:91], v[204:207]
ds_read_b128 v[148:151], v161 offset:2560
v_mfma_f32_16x16x32_bf16 v[188:191], v[40:43], v[68:71], v[188:191]
ds_read_b128 v[152:155], v161 offset:3072
v_mfma_f32_16x16x32_bf16 v[192:195], v[40:43], v[72:75], v[192:195]
ds_read_b128 v[156:159], v161 offset:3584
v_mfma_f32_16x16x32_bf16 v[196:199], v[40:43], v[76:79], v[196:199]
ds_read_b64 v[96:97], v160 offset:3584
v_mfma_f32_16x16x32_bf16 v[200:203], v[40:43], v[80:83], v[200:203]
ds_read_b64 v[98:99], v160 offset:3592
v_mfma_f32_16x16x32_bf16 v[204:207], v[40:43], v[84:87], v[204:207]
ds_read_b64 v[100:101], v160 offset:3072
v_mfma_f32_16x16x32_bf16 v[192:195], v[44:47], v[68:71], v[192:195]
ds_read_b64 v[102:103], v160 offset:3080
v_mfma_f32_16x16x32_bf16 v[196:199], v[44:47], v[72:75], v[196:199]
ds_read_b64 v[104:105], v160 offset:2560
v_mfma_f32_16x16x32_bf16 v[200:203], v[44:47], v[76:79], v[200:203]
ds_read_b64 v[106:107], v160 offset:2568
v_mfma_f32_16x16x32_bf16 v[204:207], v[44:47], v[80:83], v[204:207]
ds_read_b64 v[108:109], v160 offset:2048
v_mfma_f32_16x16x32_bf16 v[196:199], v[48:51], v[68:71], v[196:199]
ds_read_b64 v[110:111], v160 offset:2056
v_mfma_f32_16x16x32_bf16 v[200:203], v[48:51], v[72:75], v[200:203]
ds_read_b64 v[112:113], v160 offset:1536
v_mfma_f32_16x16x32_bf16 v[204:207], v[48:51], v[76:79], v[204:207]
ds_read_b64 v[114:115], v160 offset:1544
v_mfma_f32_16x16x32_bf16 v[200:203], v[52:55], v[68:71], v[200:203]
ds_read_b64 v[116:117], v160 offset:1024
v_mfma_f32_16x16x32_bf16 v[204:207], v[52:55], v[72:75], v[204:207]
ds_read_b64 v[118:119], v160 offset:1032
v_mfma_f32_16x16x32_bf16 v[204:207], v[56:59], v[68:71], v[204:207]
ds_read_b64 v[120:121], v160 offset:512
v_mfma_f32_16x16x32_bf16 v[176:179], v[32:35], v[64:67], v[176:179]
ds_read_b64 v[122:123], v160 offset:520
v_mfma_f32_16x16x32_bf16 v[180:183], v[32:35], v[68:71], v[180:183]
ds_read_b64 v[124:125], v160 offset:0
v_mfma_f32_16x16x32_bf16 v[184:187], v[32:35], v[72:75], v[184:187]
ds_read_b64 v[126:127], v160 offset:8
v_mfma_f32_16x16x32_bf16 v[188:191], v[32:35], v[76:79], v[188:191]
v_mfma_f32_16x16x32_bf16 v[192:195], v[32:35], v[80:83], v[192:195]
v_mfma_f32_16x16x32_bf16 v[196:199], v[32:35], v[84:87], v[196:199]
v_mfma_f32_16x16x32_bf16 v[200:203], v[32:35], v[88:91], v[200:203]
v_mfma_f32_16x16x32_bf16 v[204:207], v[32:35], v[92:95], v[204:207]
v_mfma_f32_16x16x32_bf16 v[180:183], v[36:39], v[64:67], v[180:183]
v_mfma_f32_16x16x32_bf16 v[184:187], v[40:43], v[64:67], v[184:187]
v_mfma_f32_16x16x32_bf16 v[188:191], v[44:47], v[64:67], v[188:191]
v_mfma_f32_16x16x32_bf16 v[192:195], v[48:51], v[64:67], v[192:195]
v_mfma_f32_16x16x32_bf16 v[196:199], v[52:55], v[64:67], v[196:199]
v_mfma_f32_16x16x32_bf16 v[200:203], v[56:59], v[64:67], v[200:203]
v_mfma_f32_16x16x32_bf16 v[204:207], v[60:63], v[64:67], v[204:207]
s_waitcnt lgkmcnt(0)
v_cndmask_b32 v128, 0, v128, s[94:95]
v_cndmask_b32 v129, 0, v129, s[94:95]
v_cndmask_b32 v130, 0, v130, s[94:95]
v_cndmask_b32 v131, 0, v131, s[94:95]
v_mfma_f32_16x16x32_bf16 v[184:187], v[100:103], v[132:135], v[184:187]
v_mfma_f32_16x16x32_bf16 v[188:191], v[100:103], v[136:139], v[188:191]
v_mfma_f32_16x16x32_bf16 v[192:195], v[100:103], v[140:143], v[192:195]
v_mfma_f32_16x16x32_bf16 v[196:199], v[100:103], v[144:147], v[196:199]
v_mfma_f32_16x16x32_bf16 v[200:203], v[100:103], v[148:151], v[200:203]
v_mfma_f32_16x16x32_bf16 v[204:207], v[100:103], v[152:155], v[204:207]
v_mfma_f32_16x16x32_bf16 v[188:191], v[104:107], v[132:135], v[188:191]
v_mfma_f32_16x16x32_bf16 v[192:195], v[104:107], v[136:139], v[192:195]
v_mfma_f32_16x16x32_bf16 v[196:199], v[104:107], v[140:143], v[196:199]
v_mfma_f32_16x16x32_bf16 v[200:203], v[104:107], v[144:147], v[200:203]
v_mfma_f32_16x16x32_bf16 v[204:207], v[104:107], v[148:151], v[204:207]
v_mfma_f32_16x16x32_bf16 v[192:195], v[108:111], v[132:135], v[192:195]
v_mfma_f32_16x16x32_bf16 v[196:199], v[108:111], v[136:139], v[196:199]
v_mfma_f32_16x16x32_bf16 v[200:203], v[108:111], v[140:143], v[200:203]
v_mfma_f32_16x16x32_bf16 v[204:207], v[108:111], v[144:147], v[204:207]
v_mfma_f32_16x16x32_bf16 v[196:199], v[112:115], v[132:135], v[196:199]
v_mfma_f32_16x16x32_bf16 v[200:203], v[112:115], v[136:139], v[200:203]
v_mfma_f32_16x16x32_bf16 v[204:207], v[112:115], v[140:143], v[204:207]
v_mfma_f32_16x16x32_bf16 v[200:203], v[116:119], v[132:135], v[200:203]
v_mfma_f32_16x16x32_bf16 v[204:207], v[116:119], v[136:139], v[204:207]
v_mfma_f32_16x16x32_bf16 v[204:207], v[120:123], v[132:135], v[204:207]
v_mfma_f32_16x16x32_bf16 v[176:179], v[96:99], v[128:131], v[176:179]
v_mfma_f32_16x16x32_bf16 v[180:183], v[96:99], v[132:135], v[180:183]
v_mfma_f32_16x16x32_bf16 v[184:187], v[96:99], v[136:139], v[184:187]
v_mfma_f32_16x16x32_bf16 v[188:191], v[96:99], v[140:143], v[188:191]
v_mfma_f32_16x16x32_bf16 v[192:195], v[96:99], v[144:147], v[192:195]
v_mfma_f32_16x16x32_bf16 v[196:199], v[96:99], v[148:151], v[196:199]
v_mfma_f32_16x16x32_bf16 v[200:203], v[96:99], v[152:155], v[200:203]
v_mfma_f32_16x16x32_bf16 v[204:207], v[96:99], v[156:159], v[204:207]
v_mfma_f32_16x16x32_bf16 v[180:183], v[100:103], v[128:131], v[180:183]
v_mfma_f32_16x16x32_bf16 v[184:187], v[104:107], v[128:131], v[184:187]
v_mfma_f32_16x16x32_bf16 v[188:191], v[108:111], v[128:131], v[188:191]
v_mfma_f32_16x16x32_bf16 v[192:195], v[112:115], v[128:131], v[192:195]
v_mfma_f32_16x16x32_bf16 v[196:199], v[116:119], v[128:131], v[196:199]
v_mfma_f32_16x16x32_bf16 v[200:203], v[120:123], v[128:131], v[200:203]
v_mfma_f32_16x16x32_bf16 v[204:207], v[124:127], v[128:131], v[204:207]
s_lshl_b32 s55, s24, 12
s_add_u32 s55, s55, 115712
v_add_u32 v164, s55, v255
s_xor_b32 s56, s24, 4
s_lshl_b32 s56, s56, 12
s_add_u32 s56, s56, 115712
v_add_u32 v165, s56, v255
s_nop 4
s_cmp_eq_u32 s51, 0
s_cbranch_scc1 CV_h0
ds_write_b128 v164, v[176:179] offset:0
ds_write_b128 v164, v[180:183] offset:1024
ds_write_b128 v164, v[184:187] offset:2048
ds_write_b128 v164, v[188:191] offset:3072
s_nop 1
v_mov_b32 v176, v192
v_mov_b32 v177, v193
v_mov_b32 v178, v194
v_mov_b32 v179, v195
v_mov_b32 v180, v196
v_mov_b32 v181, v197
v_mov_b32 v182, v198
v_mov_b32 v183, v199
v_mov_b32 v184, v200
v_mov_b32 v185, v201
v_mov_b32 v186, v202
v_mov_b32 v187, v203
v_mov_b32 v188, v204
v_mov_b32 v189, v205
v_mov_b32 v190, v206
v_mov_b32 v191, v207
s_branch CV_h1
CV_h0:
ds_write_b128 v164, v[192:195] offset:0
ds_write_b128 v164, v[196:199] offset:1024
ds_write_b128 v164, v[200:203] offset:2048
ds_write_b128 v164, v[204:207] offset:3072
CV_h1:
s_waitcnt lgkmcnt(0)
s_barrier
ds_read_b128 v[32:35], v165 offset:0
ds_read_b128 v[36:39], v165 offset:1024
ds_read_b128 v[40:43], v165 offset:2048
ds_read_b128 v[44:47], v165 offset:3072
v_lshlrev_b32 v8, 5, v3
v_lshlrev_b32 v9, 3, v4
v_add_u32 v8, v8, v9
s_lshl_b32 s55, s51, 11
s_add_u32 s56, s53, 2552
s_sub_u32 s56, s56, s55
v_sub_u32 v9, s56, v8
ds_read_b64 v[48:49], v9 offset:1536
ds_read_b64 v[50:51], v9 offset:1024
ds_read_b64 v[52:53], v9 offset:512
ds_read_b64 v[54:55], v9 offset:0
s_add_u32 s56, s54, s55
s_add_u32 s56, s56, 33554432
v_lshlrev_b32 v163, 16, v163
v_and_b32 v10, 1, v4
v_lshlrev_b32 v10, 9, v10
v_lshrrev_b32 v9, 1, v4
v_lshlrev_b32 v9, 4, v9
v_add_u32 v10, v10, v9
v_lshlrev_b32 v9, 5, v3
v_add_u32 v10, v10, v9
s_waitcnt lgkmcnt(0)
v_add_f32 v176, v176, v32
v_add_f32 v177, v177, v33
v_add_f32 v178, v178, v34
v_add_f32 v179, v179, v35
v_cvt_pk_bf16_f32 v56, v176, v177
v_cvt_pk_bf16_f32 v57, v178, v179
v_lshlrev_b32 v176, 16, v56
v_and_b32 v177, 0xffff0000, v56
v_lshlrev_b32 v178, 16, v57
v_and_b32 v179, 0xffff0000, v57
v_and_b32 v58, 0xffff0000, v49
v_lshlrev_b32 v59, 16, v49
v_and_b32 v60, 0xffff0000, v48
v_lshlrev_b32 v61, 16, v48
v_mul_f32 v58, v58, v163
v_mul_f32 v59, v59, v163
v_mul_f32 v60, v60, v163
v_mul_f32 v61, v61, v163
v_cvt_pk_bf16_f32 v56, v58, v59
v_cvt_pk_bf16_f32 v57, v60, v61
v_lshlrev_b32 v58, 16, v56
v_and_b32 v59, 0xffff0000, v56
v_lshlrev_b32 v60, 16, v57
v_and_b32 v61, 0xffff0000, v57
v_add_f32 v176, v176, v58
v_add_f32 v177, v177, v59
v_add_f32 v178, v178, v60
v_add_f32 v179, v179, v61
v_cvt_pk_bf16_f32 v64, v176, v177
v_cvt_pk_bf16_f32 v65, v178, v179
v_add_f32 v180, v180, v36
v_add_f32 v181, v181, v37
v_add_f32 v182, v182, v38
v_add_f32 v183, v183, v39
v_cvt_pk_bf16_f32 v56, v180, v181
v_cvt_pk_bf16_f32 v57, v182, v183
v_lshlrev_b32 v180, 16, v56
v_and_b32 v181, 0xffff0000, v56
v_lshlrev_b32 v182, 16, v57
v_and_b32 v183, 0xffff0000, v57
v_and_b32 v58, 0xffff0000, v51
v_lshlrev_b32 v59, 16, v51
v_and_b32 v60, 0xffff0000, v50
v_lshlrev_b32 v61, 16, v50
v_mul_f32 v58, v58, v163
v_mul_f32 v59, v59, v163
v_mul_f32 v60, v60, v163
v_mul_f32 v61, v61, v163
v_cvt_pk_bf16_f32 v56, v58, v59
v_cvt_pk_bf16_f32 v57, v60, v61
v_lshlrev_b32 v58, 16, v56
v_and_b32 v59, 0xffff0000, v56
v_lshlrev_b32 v60, 16, v57
v_and_b32 v61, 0xffff0000, v57
v_add_f32 v180, v180, v58
v_add_f32 v181, v181, v59
v_add_f32 v182, v182, v60
v_add_f32 v183, v183, v61
v_cvt_pk_bf16_f32 v66, v180, v181
v_cvt_pk_bf16_f32 v67, v182, v183
s_nop 1
v_permlane16_swap_b32 v64, v66
v_permlane16_swap_b32 v65, v67
buffer_store_dwordx4 v[64:67], v10, s[12:15], s56 offen offset:0 sc1
v_add_f32 v184, v184, v40
v_add_f32 v185, v185, v41
v_add_f32 v186, v186, v42
v_add_f32 v187, v187, v43
v_cvt_pk_bf16_f32 v56, v184, v185
v_cvt_pk_bf16_f32 v57, v186, v187
v_lshlrev_b32 v184, 16, v56
v_and_b32 v185, 0xffff0000, v56
v_lshlrev_b32 v186, 16, v57
v_and_b32 v187, 0xffff0000, v57
v_and_b32 v58, 0xffff0000, v53
v_lshlrev_b32 v59, 16, v53
v_and_b32 v60, 0xffff0000, v52
v_lshlrev_b32 v61, 16, v52
v_mul_f32 v58, v58, v163
v_mul_f32 v59, v59, v163
v_mul_f32 v60, v60, v163
v_mul_f32 v61, v61, v163
v_cvt_pk_bf16_f32 v56, v58, v59
v_cvt_pk_bf16_f32 v57, v60, v61
v_lshlrev_b32 v58, 16, v56
v_and_b32 v59, 0xffff0000, v56
v_lshlrev_b32 v60, 16, v57
v_and_b32 v61, 0xffff0000, v57
v_add_f32 v184, v184, v58
v_add_f32 v185, v185, v59
v_add_f32 v186, v186, v60
v_add_f32 v187, v187, v61
v_cvt_pk_bf16_f32 v68, v184, v185
v_cvt_pk_bf16_f32 v69, v186, v187
v_add_f32 v188, v188, v44
v_add_f32 v189, v189, v45
v_add_f32 v190, v190, v46
v_add_f32 v191, v191, v47
v_cvt_pk_bf16_f32 v56, v188, v189
v_cvt_pk_bf16_f32 v57, v190, v191
v_lshlrev_b32 v188, 16, v56
v_and_b32 v189, 0xffff0000, v56
v_lshlrev_b32 v190, 16, v57
v_and_b32 v191, 0xffff0000, v57
v_and_b32 v58, 0xffff0000, v55
v_lshlrev_b32 v59, 16, v55
v_and_b32 v60, 0xffff0000, v54
v_lshlrev_b32 v61, 16, v54
v_mul_f32 v58, v58, v163
v_mul_f32 v59, v59, v163
v_mul_f32 v60, v60, v163
v_mul_f32 v61, v61, v163
v_cvt_pk_bf16_f32 v56, v58, v59
v_cvt_pk_bf16_f32 v57, v60, v61
v_lshlrev_b32 v58, 16, v56
v_and_b32 v59, 0xffff0000, v56
v_lshlrev_b32 v60, 16, v57
v_and_b32 v61, 0xffff0000, v57
v_add_f32 v188, v188, v58
v_add_f32 v189, v189, v59
v_add_f32 v190, v190, v60
v_add_f32 v191, v191, v61
v_cvt_pk_bf16_f32 v70, v188, v189
v_cvt_pk_bf16_f32 v71, v190, v191
s_nop 1
v_permlane16_swap_b32 v68, v70
v_permlane16_swap_b32 v69, v71
buffer_store_dwordx4 v[68:71], v10, s[12:15], s56 offen offset:1024 sc1
s_load_dwordx4 s[4:7], s[0:1], 72
s_load_dwordx2 s[8:9], s[0:1], 0
v_mov_b32 v2, v235
s_mov_b32 s32, s59
s_and_b32 s33, s3, 1
s_lshl_b32 s33, s33, 3
s_and_b32 s34, s29, 7
s_add_u32 s33, s33, s34
s_lshr_b32 s35, s24, 2
s_bfe_u32 s36, s24, 0x10001
s_and_b32 s37, s24, 1
s_mul_i32 s25, s32, 917504
s_lshl_b32 s34, s24, 11
s_add_u32 s25, s25, s34
s_add_u32 s25, s25, 16777216
s_mov_b32 s26, 0
s_lshl_b32 s27, s24, 11
s_lshl_b32 s28, s24, 10
s_add_u32 s28, s28, 16384
v_lshlrev_b32 v110, 4, v2
v_lshrrev_b32 v3, 3, v2
v_bfe_u32 v4, v2, 4, 1
s_and_b32 s34, s24, 1
s_lshl_b32 s34, s34, 1
v_or_b32 v4, s34, v4
v_lshlrev_b32 v4, 1, v4
v_and_b32 v5, 7, v2
v_xor_b32 v5, v5, v4
v_lshlrev_b32 v5, 4, v5
s_lshl_b32 s34, s24, 3
v_add_u32 v6, s34, v3
v_lshlrev_b32 v6, 11, v6
v_add_u32 v6, v6, v5
s_lshl_b32 s34, s33, 7
v_add_u32 v111, s34, v6
s_waitcnt lgkmcnt(0)
s_mov_b32 s16, s4
s_and_b32 s17, s5, 0xffff
s_mov_b32 s18, 7340032
s_mov_b32 s19, 0x20000
s_mov_b32 s20, s6
s_and_b32 s21, s7, 0xffff
s_mov_b32 s22, 4194304
s_mov_b32 s23, 0x20000
s_mov_b32 s40, s8
s_and_b32 s41, s9, 0xffff
s_mov_b32 s42, 4194304
s_mov_b32 s43, 0x20000
s_cmp_lg_u32 s24, 0
s_cbranch_scc1 PI_14
v_mov_b32 v12, s70
buffer_load_dword v13, v12, s[12:15], 0 offen sc1
PI_14:
s_barrier
s_add_u32 m0, s28, 0
s_nop 0
buffer_load_dwordx4 v111, s[16:19], s26 offen lds
s_add_u32 s26, s26, 131072
s_add_u32 m0, s28, 24576
s_nop 0
buffer_load_dwordx4 v111, s[16:19], s26 offen lds
s_add_u32 s26, s26, 131072
s_add_u32 m0, s28, 49152
s_nop 0
buffer_load_dwordx4 v111, s[16:19], s26 offen lds
s_add_u32 s26, s26, 131072
s_add_u32 m0, s28, 73728
s_nop 0
buffer_load_dwordx4 v111, s[16:19], s26 offen lds
s_add_u32 s26, s26, 131072
s_add_u32 m0, s28, 98304
s_nop 0
buffer_load_dwordx4 v111, s[16:19], s26 offen lds
s_add_u32 s26, s26, 131072
s_add_u32 m0, s28, 122880
s_nop 0
buffer_load_dwordx4 v111, s[16:19], s26 offen lds
s_add_u32 s26, s26, 131072
v_lshrrev_b32 v3, 4, v2
v_lshlrev_b32 v3, 12, v3
v_and_b32 v4, 15, v2
v_lshlrev_b32 v4, 4, v4
v_add_u32 v115, v3, v4
s_lshl_b32 s34, s33, 6
s_lshl_b32 s38, s24, 3
s_add_u32 s34, s34, s38
s_lshl_b32 s34, s34, 12
s_lshl_b32 s38, s32, 8
s_add_u32 s34, s34, s38
s_add_u32 s58, s34, 33554432
v_lshrrev_b32 v3, 4, v2
v_and_b32 v4, 1, v3
v_lshlrev_b32 v4, 1, v4
v_lshrrev_b32 v5, 1, v3
v_or_b32 v4, v4, v5
v_and_b32 v5, 15, v2
s_lshl_b32 s34, s32, 7
s_lshl_b32 s38, s36, 6
s_add_u32 s34, s34, s38
s_lshl_b32 s38, s35, 5
s_add_u32 s34, s34, s38
v_add_u32 v6, s34, v5
v_lshlrev_b32 v7, 3, v6
v_lshlrev_b32 v6, 11, v6
v_lshlrev_b32 v9, 4, v4
v_add_u32 v6, v6, v9
s_lshl_b32 s38, s33, 7
s_lshl_b32 s39, s37, 6
s_add_u32 s38, s38, s39
v_add_u32 v112, s38, v6
v_add_u32 v113, 32768, v112
buffer_load_dwordx4 v[116:119], v112, s[40:43], 0 offen
buffer_load_dwordx4 v[120:123], v113, s[40:43], 0 offen
s_mov_b32 s38, 0
buffer_load_dwordx2 v[124:125], v7, s[12:15], s38 offen sc1
buffer_load_dwordx2 v[126:127], v7, s[12:15], s38 offen offset:128 sc1
s_lshl_b32 s34, s35, 13
s_lshl_b32 s38, s36, 12
s_add_u32 s34, s34, s38
v_add_u32 v96, s34, v110
v_add_u32 v97, 49152, v96
v_add_u32 v98, 98304, v96
v_lshrrev_b32 v3, 4, v2
v_bfe_u32 v6, v2, 2, 2
v_and_b32 v7, 3, v2
v_and_b32 v9, 1, v3
v_lshlrev_b32 v9, 1, v9
v_lshrrev_b32 v10, 1, v6
v_or_b32 v10, v9, v10
v_lshlrev_b32 v9, 3, v3
v_add_u32 v9, v9, v6
v_lshlrev_b32 v9, 7, v9
v_lshlrev_b32 v7, 3, v7
v_add_u32 v9, v9, v7
s_lshl_b32 s34, s35, 12
s_add_u32 s34, s34, 16384
v_add_u32 v9, s34, v9
s_lshl_b32 s34, s37, 1
s_add_u32 s38, s34, 0
v_xor_b32 v11, s38, v10
v_lshlrev_b32 v11, 5, v11
v_add_u32 v100, v9, v11
v_add_u32 v101, 49152, v100
v_add_u32 v102, 98304, v100
s_add_u32 s38, s34, 1
v_xor_b32 v11, s38, v10
v_lshlrev_b32 v11, 5, v11
v_add_u32 v103, v9, v11
v_add_u32 v104, 49152, v103
v_add_u32 v105, 98304, v103
v_lshlrev_b32 v9, 3, v4
v_add_u32 v9, v9, v6
v_lshlrev_b32 v9, 8, v9
v_add_u32 v9, v9, v7
s_lshl_b32 s34, s37, 13
s_lshl_b32 s38, s36, 7
s_add_u32 s34, s34, s38
s_lshl_b32 s38, s35, 6
s_add_u32 s34, s34, s38
s_add_u32 s34, s34, 147456
v_add_u32 v114, s34, v9
s_cmp_lg_u32 s24, 0
s_cbranch_scc1 PC_15_done
s_waitcnt vmcnt(0)
s_mov_b32 s48, 0
PC_15_chk:
v_readfirstlane_b32 s49, v13
s_add_u32 s48, s48, 1
s_cmp_ge_u32 s49, 32
s_cbranch_scc1 PC_15_done
s_cmp_ge_u32 s48, 0x40000
s_cbranch_scc1 PC_15_done
s_sleep 4
buffer_load_dword v13, v12, s[12:15], 0 offen sc1
s_waitcnt vmcnt(0)
s_branch PC_15_chk
PC_15_done:
s_barrier
s_add_u32 m0, s27, 0
s_nop 0
buffer_load_dwordx4 v110, s[12:15], s25 offen sc1 lds
buffer_load_dwordx4 v110, s[12:15], s25 offen offset:1024 sc1 lds
s_add_u32 s25, s25, 16384
s_add_u32 m0, s27, 24576
s_nop 0
buffer_load_dwordx4 v110, s[12:15], s25 offen sc1 lds
buffer_load_dwordx4 v110, s[12:15], s25 offen offset:1024 sc1 lds
s_add_u32 s25, s25, 16384
s_add_u32 m0, s27, 49152
s_nop 0
buffer_load_dwordx4 v110, s[12:15], s25 offen sc1 lds
buffer_load_dwordx4 v110, s[12:15], s25 offen offset:1024 sc1 lds
s_add_u32 s25, s25, 16384
s_add_u32 m0, s27, 73728
s_nop 0
buffer_load_dwordx4 v110, s[12:15], s25 offen sc1 lds
buffer_load_dwordx4 v110, s[12:15], s25 offen offset:1024 sc1 lds
s_add_u32 s25, s25, 16384
s_add_u32 m0, s27, 98304
s_nop 0
buffer_load_dwordx4 v110, s[12:15], s25 offen sc1 lds
buffer_load_dwordx4 v110, s[12:15], s25 offen offset:1024 sc1 lds
s_add_u32 s25, s25, 16384
s_add_u32 m0, s27, 122880
s_nop 0
buffer_load_dwordx4 v110, s[12:15], s25 offen sc1 lds
buffer_load_dwordx4 v110, s[12:15], s25 offen offset:1024 sc1 lds
s_add_u32 s25, s25, 16384
s_waitcnt vmcnt(10)
s_barrier
ds_read_b64_tr_b16 v[48:49], v100 offset:0
ds_read_b64_tr_b16 v[50:51], v100 offset:512
ds_read_b64_tr_b16 v[52:53], v103 offset:0
ds_read_b64_tr_b16 v[54:55], v103 offset:512
ds_read_b128 v[32:35], v96 offset:0
ds_read_b128 v[36:39], v96 offset:1024
ds_read_b128 v[40:43], v96 offset:2048
ds_read_b128 v[44:47], v96 offset:3072
s_waitcnt vmcnt(8) lgkmcnt(0)
s_barrier
v_mfma_f32_16x16x32_bf16 v[136:139], v[48:51], v[32:35], 0
s_add_u32 m0, s27, 0
s_nop 0
buffer_load_dwordx4 v110, s[12:15], s25 offen sc1 lds
ds_read_b64_tr_b16 v[72:73], v100 offset:24576
v_mfma_f32_16x16x32_bf16 v[140:143], v[52:55], v[32:35], 0
ds_read_b64_tr_b16 v[74:75], v100 offset:25088
v_mfma_f32_16x16x32_bf16 v[144:147], v[48:51], v[36:39], 0
buffer_load_dwordx4 v110, s[12:15], s25 offen offset:1024 sc1 lds
s_add_u32 s25, s25, 16384
ds_read_b64_tr_b16 v[76:77], v103 offset:24576
v_mfma_f32_16x16x32_bf16 v[148:151], v[52:55], v[36:39], 0
ds_read_b64_tr_b16 v[78:79], v103 offset:25088
v_mfma_f32_16x16x32_bf16 v[152:155], v[48:51], v[40:43], 0
s_add_u32 m0, s28, 0
s_nop 0
buffer_load_dwordx4 v111, s[16:19], s26 offen lds
s_add_u32 s26, s26, 131072
ds_read_b128 v[56:59], v96 offset:24576
v_mfma_f32_16x16x32_bf16 v[156:159], v[52:55], v[40:43], 0
ds_read_b128 v[60:63], v96 offset:25600
v_mfma_f32_16x16x32_bf16 v[160:163], v[48:51], v[44:47], 0
ds_read_b128 v[64:67], v96 offset:26624
v_mfma_f32_16x16x32_bf16 v[164:167], v[52:55], v[44:47], 0
ds_read_b128 v[68:71], v96 offset:27648
s_waitcnt vmcnt(9) lgkmcnt(0)
s_barrier
v_mfma_f32_16x16x32_bf16 v[136:139], v[72:75], v[56:59], v[136:139]
s_add_u32 m0, s27, 24576
s_nop 0
buffer_load_dwordx4 v110, s[12:15], s25 offen sc1 lds
ds_read_b64_tr_b16 v[48:49], v101 offset:0
v_mfma_f32_16x16x32_bf16 v[140:143], v[76:79], v[56:59], v[140:143]
ds_read_b64_tr_b16 v[50:51], v101 offset:512
v_mfma_f32_16x16x32_bf16 v[144:147], v[72:75], v[60:63], v[144:147]
buffer_load_dwordx4 v110, s[12:15], s25 offen offset:1024 sc1 lds
s_add_u32 s25, s25, 16384
ds_read_b64_tr_b16 v[52:53], v104 offset:0
v_mfma_f32_16x16x32_bf16 v[148:151], v[76:79], v[60:63], v[148:151]
ds_read_b64_tr_b16 v[54:55], v104 offset:512
v_mfma_f32_16x16x32_bf16 v[152:155], v[72:75], v[64:67], v[152:155]
s_add_u32 m0, s28, 24576
s_nop 0
buffer_load_dwordx4 v111, s[16:19], s26 offen lds
s_add_u32 s26, s26, 131072
ds_read_b128 v[32:35], v97 offset:0
v_mfma_f32_16x16x32_bf16 v[156:159], v[76:79], v[64:67], v[156:159]
ds_read_b128 v[36:39], v97 offset:1024
v_mfma_f32_16x16x32_bf16 v[160:163], v[72:75], v[68:71], v[160:163]
ds_read_b128 v[40:43], v97 offset:2048
v_mfma_f32_16x16x32_bf16 v[164:167], v[76:79], v[68:71], v[164:167]
ds_read_b128 v[44:47], v97 offset:3072
s_waitcnt vmcnt(10) lgkmcnt(0)
s_barrier
v_mfma_f32_16x16x32_bf16 v[136:139], v[48:51], v[32:35], v[136:139]
s_add_u32 m0, s27, 49152
s_nop 0
buffer_load_dwordx4 v110, s[12:15], s25 offen sc1 lds
ds_read_b64_tr_b16 v[72:73], v101 offset:24576
v_mfma_f32_16x16x32_bf16 v[140:143], v[52:55], v[32:35], v[140:143]
ds_read_b64_tr_b16 v[74:75], v101 offset:25088
v_mfma_f32_16x16x32_bf16 v[144:147], v[48:51], v[36:39], v[144:147]
buffer_load_dwordx4 v110, s[12:15], s25 offen offset:1024 sc1 lds
s_add_u32 s25, s25, 16384
ds_read_b64_tr_b16 v[76:77], v104 offset:24576
v_mfma_f32_16x16x32_bf16 v[148:151], v[52:55], v[36:39], v[148:151]
ds_read_b64_tr_b16 v[78:79], v104 offset:25088
v_mfma_f32_16x16x32_bf16 v[152:155], v[48:51], v[40:43], v[152:155]
s_add_u32 m0, s28, 49152
s_nop 0
buffer_load_dwordx4 v111, s[16:19], s26 offen lds
s_add_u32 s26, s26, 131072
ds_read_b128 v[56:59], v97 offset:24576
v_mfma_f32_16x16x32_bf16 v[156:159], v[52:55], v[40:43], v[156:159]
ds_read_b128 v[60:63], v97 offset:25600
v_mfma_f32_16x16x32_bf16 v[160:163], v[48:51], v[44:47], v[160:163]
ds_read_b128 v[64:67], v97 offset:26624
v_mfma_f32_16x16x32_bf16 v[164:167], v[52:55], v[44:47], v[164:167]
ds_read_b128 v[68:71], v97 offset:27648
s_waitcnt vmcnt(11) lgkmcnt(0)
s_barrier
s_cmp_lg_u32 s24, 0
s_cbranch_scc1 G2_nosigz
v_lshlrev_b32 v8, 11, v235
v_mov_b32 v9, 1
s_lshr_b32 s38, s2, 4
s_lshl_b32 s38, s38, 7
s_add_u32 s38, s38, 1081344
s_mov_b64 s[46:47], exec
s_mov_b64 exec, 0xffff
buffer_atomic_add v9, v8, s[12:15], s38 offen sc1
s_mov_b64 exec, s[46:47]
G2_nosigz:
v_mfma_f32_16x16x32_bf16 v[136:139], v[72:75], v[56:59], v[136:139]
s_add_u32 m0, s27, 73728
s_nop 0
buffer_load_dwordx4 v110, s[12:15], s25 offen sc1 lds
ds_read_b64_tr_b16 v[48:49], v102 offset:0
v_mfma_f32_16x16x32_bf16 v[140:143], v[76:79], v[56:59], v[140:143]
ds_read_b64_tr_b16 v[50:51], v102 offset:512
v_mfma_f32_16x16x32_bf16 v[144:147], v[72:75], v[60:63], v[144:147]
buffer_load_dwordx4 v110, s[12:15], s25 offen offset:1024 sc1 lds
s_add_u32 s25, s25, 16384
ds_read_b64_tr_b16 v[52:53], v105 offset:0
v_mfma_f32_16x16x32_bf16 v[148:151], v[76:79], v[60:63], v[148:151]
ds_read_b64_tr_b16 v[54:55], v105 offset:512
v_mfma_f32_16x16x32_bf16 v[152:155], v[72:75], v[64:67], v[152:155]
s_add_u32 m0, s28, 73728
s_nop 0
buffer_load_dwordx4 v111, s[16:19], s26 offen lds
s_add_u32 s26, s26, 131072
ds_read_b128 v[32:35], v98 offset:0
v_mfma_f32_16x16x32_bf16 v[156:159], v[76:79], v[64:67], v[156:159]
ds_read_b128 v[36:39], v98 offset:1024
v_mfma_f32_16x16x32_bf16 v[160:163], v[72:75], v[68:71], v[160:163]
ds_read_b128 v[40:43], v98 offset:2048
v_mfma_f32_16x16x32_bf16 v[164:167], v[76:79], v[68:71], v[164:167]
ds_read_b128 v[44:47], v98 offset:3072
s_mov_b32 s39, 0
G2La_loop:
s_waitcnt vmcnt(12) lgkmcnt(0)
s_barrier
v_mfma_f32_16x16x32_bf16 v[136:139], v[48:51], v[32:35], v[136:139]
s_add_u32 m0, s27, 98304
s_nop 0
buffer_load_dwordx4 v110, s[12:15], s25 offen sc1 lds
ds_read_b64_tr_b16 v[72:73], v102 offset:24576
v_mfma_f32_16x16x32_bf16 v[140:143], v[52:55], v[32:35], v[140:143]
ds_read_b64_tr_b16 v[74:75], v102 offset:25088
v_mfma_f32_16x16x32_bf16 v[144:147], v[48:51], v[36:39], v[144:147]
buffer_load_dwordx4 v110, s[12:15], s25 offen offset:1024 sc1 lds
s_add_u32 s25, s25, 16384
ds_read_b64_tr_b16 v[76:77], v105 offset:24576
v_mfma_f32_16x16x32_bf16 v[148:151], v[52:55], v[36:39], v[148:151]
ds_read_b64_tr_b16 v[78:79], v105 offset:25088
v_mfma_f32_16x16x32_bf16 v[152:155], v[48:51], v[40:43], v[152:155]
s_add_u32 m0, s28, 98304
s_nop 0
buffer_load_dwordx4 v111, s[16:19], s26 offen lds
s_add_u32 s26, s26, 131072
ds_read_b128 v[56:59], v98 offset:24576
v_mfma_f32_16x16x32_bf16 v[156:159], v[52:55], v[40:43], v[156:159]
ds_read_b128 v[60:63], v98 offset:25600
v_mfma_f32_16x16x32_bf16 v[160:163], v[48:51], v[44:47], v[160:163]
ds_read_b128 v[64:67], v98 offset:26624
v_mfma_f32_16x16x32_bf16 v[164:167], v[52:55], v[44:47], v[164:167]
ds_read_b128 v[68:71], v98 offset:27648
s_waitcnt vmcnt(12) lgkmcnt(0)
s_barrier
v_mfma_f32_16x16x32_bf16 v[136:139], v[72:75], v[56:59], v[136:139]
s_add_u32 m0, s27, 122880
s_nop 0
buffer_load_dwordx4 v110, s[12:15], s25 offen sc1 lds
ds_read_b64_tr_b16 v[48:49], v100 offset:0
v_mfma_f32_16x16x32_bf16 v[140:143], v[76:79], v[56:59], v[140:143]
ds_read_b64_tr_b16 v[50:51], v100 offset:512
v_mfma_f32_16x16x32_bf16 v[144:147], v[72:75], v[60:63], v[144:147]
buffer_load_dwordx4 v110, s[12:15], s25 offen offset:1024 sc1 lds
s_add_u32 s25, s25, 16384
ds_read_b64_tr_b16 v[52:53], v103 offset:0
v_mfma_f32_16x16x32_bf16 v[148:151], v[76:79], v[60:63], v[148:151]
ds_read_b64_tr_b16 v[54:55], v103 offset:512
v_mfma_f32_16x16x32_bf16 v[152:155], v[72:75], v[64:67], v[152:155]
s_add_u32 m0, s28, 122880
s_nop 0
buffer_load_dwordx4 v111, s[16:19], s26 offen lds
s_add_u32 s26, s26, 131072
ds_read_b128 v[32:35], v96 offset:0
v_mfma_f32_16x16x32_bf16 v[156:159], v[76:79], v[64:67], v[156:159]
ds_read_b128 v[36:39], v96 offset:1024
v_mfma_f32_16x16x32_bf16 v[160:163], v[72:75], v[68:71], v[160:163]
ds_read_b128 v[40:43], v96 offset:2048
v_mfma_f32_16x16x32_bf16 v[164:167], v[76:79], v[68:71], v[164:167]
ds_read_b128 v[44:47], v96 offset:3072
s_waitcnt vmcnt(12) lgkmcnt(0)
s_barrier
v_mfma_f32_16x16x32_bf16 v[136:139], v[48:51], v[32:35], v[136:139]
s_add_u32 m0, s27, 0
s_nop 0
buffer_load_dwordx4 v110, s[12:15], s25 offen sc1 lds
ds_read_b64_tr_b16 v[72:73], v100 offset:24576
v_mfma_f32_16x16x32_bf16 v[140:143], v[52:55], v[32:35], v[140:143]
ds_read_b64_tr_b16 v[74:75], v100 offset:25088
v_mfma_f32_16x16x32_bf16 v[144:147], v[48:51], v[36:39], v[144:147]
buffer_load_dwordx4 v110, s[12:15], s25 offen offset:1024 sc1 lds
s_add_u32 s25, s25, 16384
ds_read_b64_tr_b16 v[76:77], v103 offset:24576
v_mfma_f32_16x16x32_bf16 v[148:151], v[52:55], v[36:39], v[148:151]
ds_read_b64_tr_b16 v[78:79], v103 offset:25088
v_mfma_f32_16x16x32_bf16 v[152:155], v[48:51], v[40:43], v[152:155]
s_add_u32 m0, s28, 0
s_nop 0
buffer_load_dwordx4 v111, s[16:19], s26 offen lds
s_add_u32 s26, s26, 131072
ds_read_b128 v[56:59], v96 offset:24576
v_mfma_f32_16x16x32_bf16 v[156:159], v[52:55], v[40:43], v[156:159]
ds_read_b128 v[60:63], v96 offset:25600
v_mfma_f32_16x16x32_bf16 v[160:163], v[48:51], v[44:47], v[160:163]
ds_read_b128 v[64:67], v96 offset:26624
v_mfma_f32_16x16x32_bf16 v[164:167], v[52:55], v[44:47], v[164:167]
ds_read_b128 v[68:71], v96 offset:27648
s_waitcnt vmcnt(12) lgkmcnt(0)
s_barrier
v_mfma_f32_16x16x32_bf16 v[136:139], v[72:75], v[56:59], v[136:139]
s_add_u32 m0, s27, 24576
s_nop 0
buffer_load_dwordx4 v110, s[12:15], s25 offen sc1 lds
ds_read_b64_tr_b16 v[48:49], v101 offset:0
v_mfma_f32_16x16x32_bf16 v[140:143], v[76:79], v[56:59], v[140:143]
ds_read_b64_tr_b16 v[50:51], v101 offset:512
v_mfma_f32_16x16x32_bf16 v[144:147], v[72:75], v[60:63], v[144:147]
buffer_load_dwordx4 v110, s[12:15], s25 offen offset:1024 sc1 lds
s_add_u32 s25, s25, 16384
ds_read_b64_tr_b16 v[52:53], v104 offset:0
v_mfma_f32_16x16x32_bf16 v[148:151], v[76:79], v[60:63], v[148:151]
ds_read_b64_tr_b16 v[54:55], v104 offset:512
v_mfma_f32_16x16x32_bf16 v[152:155], v[72:75], v[64:67], v[152:155]
s_add_u32 m0, s28, 24576
s_nop 0
buffer_load_dwordx4 v111, s[16:19], s26 offen lds
s_add_u32 s26, s26, 131072
ds_read_b128 v[32:35], v97 offset:0
v_mfma_f32_16x16x32_bf16 v[156:159], v[76:79], v[64:67], v[156:159]
ds_read_b128 v[36:39], v97 offset:1024
v_mfma_f32_16x16x32_bf16 v[160:163], v[72:75], v[68:71], v[160:163]
ds_read_b128 v[40:43], v97 offset:2048
v_mfma_f32_16x16x32_bf16 v[164:167], v[76:79], v[68:71], v[164:167]
ds_read_b128 v[44:47], v97 offset:3072
s_waitcnt vmcnt(12) lgkmcnt(0)
s_barrier
v_mfma_f32_16x16x32_bf16 v[136:139], v[48:51], v[32:35], v[136:139]
s_add_u32 m0, s27, 49152
s_nop 0
buffer_load_dwordx4 v110, s[12:15], s25 offen sc1 lds
ds_read_b64_tr_b16 v[72:73], v101 offset:24576
v_mfma_f32_16x16x32_bf16 v[140:143], v[52:55], v[32:35], v[140:143]
ds_read_b64_tr_b16 v[74:75], v101 offset:25088
v_mfma_f32_16x16x32_bf16 v[144:147], v[48:51], v[36:39], v[144:147]
buffer_load_dwordx4 v110, s[12:15], s25 offen offset:1024 sc1 lds
s_add_u32 s25, s25, 16384
ds_read_b64_tr_b16 v[76:77], v104 offset:24576
v_mfma_f32_16x16x32_bf16 v[148:151], v[52:55], v[36:39], v[148:151]
ds_read_b64_tr_b16 v[78:79], v104 offset:25088
v_mfma_f32_16x16x32_bf16 v[152:155], v[48:51], v[40:43], v[152:155]
s_add_u32 m0, s28, 49152
s_nop 0
buffer_load_dwordx4 v111, s[16:19], s26 offen lds
s_add_u32 s26, s26, 131072
ds_read_b128 v[56:59], v97 offset:24576
v_mfma_f32_16x16x32_bf16 v[156:159], v[52:55], v[40:43], v[156:159]
ds_read_b128 v[60:63], v97 offset:25600
v_mfma_f32_16x16x32_bf16 v[160:163], v[48:51], v[44:47], v[160:163]
ds_read_b128 v[64:67], v97 offset:26624
v_mfma_f32_16x16x32_bf16 v[164:167], v[52:55], v[44:47], v[164:167]
ds_read_b128 v[68:71], v97 offset:27648
s_waitcnt vmcnt(12) lgkmcnt(0)
s_barrier
v_mfma_f32_16x16x32_bf16 v[136:139], v[72:75], v[56:59], v[136:139]
s_add_u32 m0, s27, 73728
s_nop 0
buffer_load_dwordx4 v110, s[12:15], s25 offen sc1 lds
ds_read_b64_tr_b16 v[48:49], v102 offset:0
v_mfma_f32_16x16x32_bf16 v[140:143], v[76:79], v[56:59], v[140:143]
ds_read_b64_tr_b16 v[50:51], v102 offset:512
v_mfma_f32_16x16x32_bf16 v[144:147], v[72:75], v[60:63], v[144:147]
buffer_load_dwordx4 v110, s[12:15], s25 offen offset:1024 sc1 lds
s_add_u32 s25, s25, 16384
ds_read_b64_tr_b16 v[52:53], v105 offset:0
v_mfma_f32_16x16x32_bf16 v[148:151], v[76:79], v[60:63], v[148:151]
ds_read_b64_tr_b16 v[54:55], v105 offset:512
v_mfma_f32_16x16x32_bf16 v[152:155], v[72:75], v[64:67], v[152:155]
s_add_u32 m0, s28, 73728
s_nop 0
buffer_load_dwordx4 v111, s[16:19], s26 offen lds
s_add_u32 s26, s26, 131072
ds_read_b128 v[32:35], v98 offset:0
v_mfma_f32_16x16x32_bf16 v[156:159], v[76:79], v[64:67], v[156:159]
ds_read_b128 v[36:39], v98 offset:1024
v_mfma_f32_16x16x32_bf16 v[160:163], v[72:75], v[68:71], v[160:163]
ds_read_b128 v[40:43], v98 offset:2048
v_mfma_f32_16x16x32_bf16 v[164:167], v[76:79], v[68:71], v[164:167]
ds_read_b128 v[44:47], v98 offset:3072
s_add_u32 s39, s39, 1
s_cmp_lt_u32 s39, 6
s_cbranch_scc1 G2La_loop
s_waitcnt vmcnt(12) lgkmcnt(0)
s_barrier
v_mfma_f32_16x16x32_bf16 v[136:139], v[48:51], v[32:35], v[136:139]
s_add_u32 m0, s27, 98304
s_nop 0
buffer_load_dwordx4 v110, s[12:15], s25 offen sc1 lds
ds_read_b64_tr_b16 v[72:73], v102 offset:24576
v_mfma_f32_16x16x32_bf16 v[140:143], v[52:55], v[32:35], v[140:143]
ds_read_b64_tr_b16 v[74:75], v102 offset:25088
v_mfma_f32_16x16x32_bf16 v[144:147], v[48:51], v[36:39], v[144:147]
buffer_load_dwordx4 v110, s[12:15], s25 offen offset:1024 sc1 lds
s_add_u32 s25, s25, 16384
ds_read_b64_tr_b16 v[76:77], v105 offset:24576
v_mfma_f32_16x16x32_bf16 v[148:151], v[52:55], v[36:39], v[148:151]
ds_read_b64_tr_b16 v[78:79], v105 offset:25088
v_mfma_f32_16x16x32_bf16 v[152:155], v[48:51], v[40:43], v[152:155]
s_add_u32 m0, s28, 98304
s_nop 0
buffer_load_dwordx4 v111, s[16:19], s26 offen lds
s_add_u32 s26, s26, 131072
ds_read_b128 v[56:59], v98 offset:24576
v_mfma_f32_16x16x32_bf16 v[156:159], v[52:55], v[40:43], v[156:159]
ds_read_b128 v[60:63], v98 offset:25600
v_mfma_f32_16x16x32_bf16 v[160:163], v[48:51], v[44:47], v[160:163]
ds_read_b128 v[64:67], v98 offset:26624
v_mfma_f32_16x16x32_bf16 v[164:167], v[52:55], v[44:47], v[164:167]
ds_read_b128 v[68:71], v98 offset:27648
s_waitcnt vmcnt(12) lgkmcnt(0)
s_barrier
v_mfma_f32_16x16x32_bf16 v[136:139], v[72:75], v[56:59], v[136:139]
s_add_u32 m0, s27, 122880
s_nop 0
buffer_load_dwordx4 v110, s[12:15], s25 offen sc1 lds
ds_read_b64_tr_b16 v[48:49], v100 offset:0
v_mfma_f32_16x16x32_bf16 v[140:143], v[76:79], v[56:59], v[140:143]
ds_read_b64_tr_b16 v[50:51], v100 offset:512
v_mfma_f32_16x16x32_bf16 v[144:147], v[72:75], v[60:63], v[144:147]
buffer_load_dwordx4 v110, s[12:15], s25 offen offset:1024 sc1 lds
s_add_u32 s25, s25, 16384
ds_read_b64_tr_b16 v[52:53], v103 offset:0
v_mfma_f32_16x16x32_bf16 v[148:151], v[76:79], v[60:63], v[148:151]
ds_read_b64_tr_b16 v[54:55], v103 offset:512
v_mfma_f32_16x16x32_bf16 v[152:155], v[72:75], v[64:67], v[152:155]
s_add_u32 m0, s28, 122880
s_nop 0
buffer_load_dwordx4 v111, s[16:19], s26 offen lds
s_add_u32 s26, s26, 131072
ds_read_b128 v[32:35], v96 offset:0
v_mfma_f32_16x16x32_bf16 v[156:159], v[76:79], v[64:67], v[156:159]
ds_read_b128 v[36:39], v96 offset:1024
v_mfma_f32_16x16x32_bf16 v[160:163], v[72:75], v[68:71], v[160:163]
ds_read_b128 v[40:43], v96 offset:2048
v_mfma_f32_16x16x32_bf16 v[164:167], v[76:79], v[68:71], v[164:167]
ds_read_b128 v[44:47], v96 offset:3072
s_waitcnt vmcnt(12) lgkmcnt(0)
s_barrier
s_add_u32 s38, s70, 32768
s_cmp_lg_u32 s24, 0
s_cbranch_scc1 PI_16
v_mov_b32 v8, s38
buffer_load_dword v9, v8, s[12:15], 0 offen sc1
PI_16:
v_mfma_f32_16x16x32_bf16 v[136:139], v[48:51], v[32:35], v[136:139]
s_add_u32 m0, s27, 0
s_nop 0
buffer_load_dwordx4 v110, s[12:15], s25 offen sc1 lds
ds_read_b64_tr_b16 v[72:73], v100 offset:24576
v_mfma_f32_16x16x32_bf16 v[140:143], v[52:55], v[32:35], v[140:143]
ds_read_b64_tr_b16 v[74:75], v100 offset:25088
v_mfma_f32_16x16x32_bf16 v[144:147], v[48:51], v[36:39], v[144:147]
buffer_load_dwordx4 v110, s[12:15], s25 offen offset:1024 sc1 lds
s_add_u32 s25, s25, 16384
ds_read_b64_tr_b16 v[76:77], v103 offset:24576
v_mfma_f32_16x16x32_bf16 v[148:151], v[52:55], v[36:39], v[148:151]
ds_read_b64_tr_b16 v[78:79], v103 offset:25088
v_mfma_f32_16x16x32_bf16 v[152:155], v[48:51], v[40:43], v[152:155]
s_add_u32 m0, s28, 0
s_nop 0
buffer_load_dwordx4 v111, s[16:19], s26 offen lds
s_add_u32 s26, s26, 131072
ds_read_b128 v[56:59], v96 offset:24576
v_mfma_f32_16x16x32_bf16 v[156:159], v[52:55], v[40:43], v[156:159]
ds_read_b128 v[60:63], v96 offset:25600
v_mfma_f32_16x16x32_bf16 v[160:163], v[48:51], v[44:47], v[160:163]
ds_read_b128 v[64:67], v96 offset:26624
v_mfma_f32_16x16x32_bf16 v[164:167], v[52:55], v[44:47], v[164:167]
ds_read_b128 v[68:71], v96 offset:27648
s_waitcnt vmcnt(12) lgkmcnt(0)
s_barrier
v_mfma_f32_16x16x32_bf16 v[136:139], v[72:75], v[56:59], v[136:139]
s_add_u32 m0, s27, 24576
s_nop 0
buffer_load_dwordx4 v110, s[12:15], s25 offen sc1 lds
ds_read_b64_tr_b16 v[48:49], v101 offset:0
v_mfma_f32_16x16x32_bf16 v[140:143], v[76:79], v[56:59], v[140:143]
ds_read_b64_tr_b16 v[50:51], v101 offset:512
v_mfma_f32_16x16x32_bf16 v[144:147], v[72:75], v[60:63], v[144:147]
buffer_load_dwordx4 v110, s[12:15], s25 offen offset:1024 sc1 lds
s_add_u32 s25, s25, 16384
ds_read_b64_tr_b16 v[52:53], v104 offset:0
v_mfma_f32_16x16x32_bf16 v[148:151], v[76:79], v[60:63], v[148:151]
ds_read_b64_tr_b16 v[54:55], v104 offset:512
v_mfma_f32_16x16x32_bf16 v[152:155], v[72:75], v[64:67], v[152:155]
s_add_u32 m0, s28, 24576
s_nop 0
buffer_load_dwordx4 v111, s[16:19], s26 offen lds
s_add_u32 s26, s26, 131072
ds_read_b128 v[32:35], v97 offset:0
v_mfma_f32_16x16x32_bf16 v[156:159], v[76:79], v[64:67], v[156:159]
ds_read_b128 v[36:39], v97 offset:1024
v_mfma_f32_16x16x32_bf16 v[160:163], v[72:75], v[68:71], v[160:163]
ds_read_b128 v[40:43], v97 offset:2048
v_mfma_f32_16x16x32_bf16 v[164:167], v[76:79], v[68:71], v[164:167]
ds_read_b128 v[44:47], v97 offset:3072
s_waitcnt vmcnt(12) lgkmcnt(0)
s_barrier
v_mfma_f32_16x16x32_bf16 v[136:139], v[48:51], v[32:35], v[136:139]
s_add_u32 m0, s27, 49152
s_nop 0
buffer_load_dwordx4 v110, s[12:15], s25 offen sc1 lds
ds_read_b64_tr_b16 v[72:73], v101 offset:24576
v_mfma_f32_16x16x32_bf16 v[140:143], v[52:55], v[32:35], v[140:143]
ds_read_b64_tr_b16 v[74:75], v101 offset:25088
v_mfma_f32_16x16x32_bf16 v[144:147], v[48:51], v[36:39], v[144:147]
buffer_load_dwordx4 v110, s[12:15], s25 offen offset:1024 sc1 lds
s_add_u32 s25, s25, 16384
ds_read_b64_tr_b16 v[76:77], v104 offset:24576
v_mfma_f32_16x16x32_bf16 v[148:151], v[52:55], v[36:39], v[148:151]
ds_read_b64_tr_b16 v[78:79], v104 offset:25088
v_mfma_f32_16x16x32_bf16 v[152:155], v[48:51], v[40:43], v[152:155]
s_add_u32 m0, s28, 49152
s_nop 0
buffer_load_dwordx4 v111, s[16:19], s26 offen lds
s_add_u32 s26, s26, 131072
ds_read_b128 v[56:59], v97 offset:24576
v_mfma_f32_16x16x32_bf16 v[156:159], v[52:55], v[40:43], v[156:159]
ds_read_b128 v[60:63], v97 offset:25600
v_mfma_f32_16x16x32_bf16 v[160:163], v[48:51], v[44:47], v[160:163]
ds_read_b128 v[64:67], v97 offset:26624
v_mfma_f32_16x16x32_bf16 v[164:167], v[52:55], v[44:47], v[164:167]
ds_read_b128 v[68:71], v97 offset:27648
s_waitcnt vmcnt(12) lgkmcnt(0)
s_barrier
v_mfma_f32_16x16x32_bf16 v[136:139], v[72:75], v[56:59], v[136:139]
s_add_u32 m0, s27, 73728
s_nop 0
buffer_load_dwordx4 v110, s[12:15], s25 offen sc1 lds
ds_read_b64_tr_b16 v[48:49], v102 offset:0
v_mfma_f32_16x16x32_bf16 v[140:143], v[76:79], v[56:59], v[140:143]
ds_read_b64_tr_b16 v[50:51], v102 offset:512
v_mfma_f32_16x16x32_bf16 v[144:147], v[72:75], v[60:63], v[144:147]
buffer_load_dwordx4 v110, s[12:15], s25 offen offset:1024 sc1 lds
s_add_u32 s25, s25, 16384
ds_read_b64_tr_b16 v[52:53], v105 offset:0
v_mfma_f32_16x16x32_bf16 v[148:151], v[76:79], v[60:63], v[148:151]
ds_read_b64_tr_b16 v[54:55], v105 offset:512
v_mfma_f32_16x16x32_bf16 v[152:155], v[72:75], v[64:67], v[152:155]
s_add_u32 m0, s28, 73728
s_nop 0
buffer_load_dwordx4 v111, s[16:19], s26 offen lds
s_add_u32 s26, s26, 131072
ds_read_b128 v[32:35], v98 offset:0
v_mfma_f32_16x16x32_bf16 v[156:159], v[76:79], v[64:67], v[156:159]
ds_read_b128 v[36:39], v98 offset:1024
v_mfma_f32_16x16x32_bf16 v[160:163], v[72:75], v[68:71], v[160:163]
ds_read_b128 v[40:43], v98 offset:2048
v_mfma_f32_16x16x32_bf16 v[164:167], v[76:79], v[68:71], v[164:167]
ds_read_b128 v[44:47], v98 offset:3072
s_waitcnt vmcnt(12) lgkmcnt(0)
s_barrier
v_mfma_f32_16x16x32_bf16 v[136:139], v[48:51], v[32:35], v[136:139]
s_add_u32 m0, s27, 98304
s_nop 0
buffer_load_dwordx4 v110, s[12:15], s25 offen sc1 lds
ds_read_b64_tr_b16 v[72:73], v102 offset:24576
v_mfma_f32_16x16x32_bf16 v[140:143], v[52:55], v[32:35], v[140:143]
ds_read_b64_tr_b16 v[74:75], v102 offset:25088
v_mfma_f32_16x16x32_bf16 v[144:147], v[48:51], v[36:39], v[144:147]
buffer_load_dwordx4 v110, s[12:15], s25 offen offset:1024 sc1 lds
s_add_u32 s25, s25, 16384
ds_read_b64_tr_b16 v[76:77], v105 offset:24576
v_mfma_f32_16x16x32_bf16 v[148:151], v[52:55], v[36:39], v[148:151]
ds_read_b64_tr_b16 v[78:79], v105 offset:25088
v_mfma_f32_16x16x32_bf16 v[152:155], v[48:51], v[40:43], v[152:155]
s_add_u32 m0, s28, 98304
s_nop 0
buffer_load_dwordx4 v111, s[16:19], s26 offen lds
s_add_u32 s26, s26, 131072
ds_read_b128 v[56:59], v98 offset:24576
v_mfma_f32_16x16x32_bf16 v[156:159], v[52:55], v[40:43], v[156:159]
ds_read_b128 v[60:63], v98 offset:25600
v_mfma_f32_16x16x32_bf16 v[160:163], v[48:51], v[44:47], v[160:163]
ds_read_b128 v[64:67], v98 offset:26624
v_mfma_f32_16x16x32_bf16 v[164:167], v[52:55], v[44:47], v[164:167]
ds_read_b128 v[68:71], v98 offset:27648
s_waitcnt vmcnt(12) lgkmcnt(0)
s_barrier
s_cmp_lg_u32 s24, 0
s_cbranch_scc1 PC_17_done
s_mov_b32 s48, 0
PC_17_chk:
v_readfirstlane_b32 s49, v9
s_add_u32 s48, s48, 1
s_cmp_ge_u32 s49, 16
s_cbranch_scc1 PC_17_done
s_cmp_ge_u32 s48, 0x40000
s_cbranch_scc1 PC_17_done
s_sleep 4
buffer_load_dword v9, v8, s[12:15], 0 offen sc1
s_waitcnt vmcnt(0)
s_branch PC_17_chk
PC_17_done:
v_mfma_f32_16x16x32_bf16 v[136:139], v[72:75], v[56:59], v[136:139]
s_add_u32 m0, s27, 122880
s_nop 0
buffer_load_dwordx4 v110, s[12:15], s25 offen sc1 lds
ds_read_b64_tr_b16 v[48:49], v100 offset:0
v_mfma_f32_16x16x32_bf16 v[140:143], v[76:79], v[56:59], v[140:143]
ds_read_b64_tr_b16 v[50:51], v100 offset:512
v_mfma_f32_16x16x32_bf16 v[144:147], v[72:75], v[60:63], v[144:147]
buffer_load_dwordx4 v110, s[12:15], s25 offen offset:1024 sc1 lds
s_add_u32 s25, s25, 16384
ds_read_b64_tr_b16 v[52:53], v103 offset:0
v_mfma_f32_16x16x32_bf16 v[148:151], v[76:79], v[60:63], v[148:151]
ds_read_b64_tr_b16 v[54:55], v103 offset:512
v_mfma_f32_16x16x32_bf16 v[152:155], v[72:75], v[64:67], v[152:155]
s_add_u32 m0, s28, 122880
s_nop 0
buffer_load_dwordx4 v111, s[16:19], s26 offen lds
s_add_u32 s26, s26, 131072
ds_read_b128 v[32:35], v96 offset:0
v_mfma_f32_16x16x32_bf16 v[156:159], v[76:79], v[64:67], v[156:159]
ds_read_b128 v[36:39], v96 offset:1024
v_mfma_f32_16x16x32_bf16 v[160:163], v[72:75], v[68:71], v[160:163]
ds_read_b128 v[40:43], v96 offset:2048
v_mfma_f32_16x16x32_bf16 v[164:167], v[76:79], v[68:71], v[164:167]
ds_read_b128 v[44:47], v96 offset:3072
s_waitcnt vmcnt(12) lgkmcnt(0)
s_barrier
s_lshl_b32 s38, s24, 11
s_add_u32 m0, s38, 147456
s_add_u32 s39, s58, 0
buffer_load_dwordx4 v115, s[12:15], s39 offen sc1 lds
s_add_u32 m0, s38, 148480
s_add_u32 s39, s58, 16384
buffer_load_dwordx4 v115, s[12:15], s39 offen sc1 lds
v_mfma_f32_16x16x32_bf16 v[136:139], v[48:51], v[32:35], v[136:139]
s_add_u32 m0, s27, 0
s_nop 0
buffer_load_dwordx4 v110, s[12:15], s25 offen sc1 lds
ds_read_b64_tr_b16 v[72:73], v100 offset:24576
v_mfma_f32_16x16x32_bf16 v[140:143], v[52:55], v[32:35], v[140:143]
ds_read_b64_tr_b16 v[74:75], v100 offset:25088
v_mfma_f32_16x16x32_bf16 v[144:147], v[48:51], v[36:39], v[144:147]
buffer_load_dwordx4 v110, s[12:15], s25 offen offset:1024 sc1 lds
s_add_u32 s25, s25, 16384
ds_read_b64_tr_b16 v[76:77], v103 offset:24576
v_mfma_f32_16x16x32_bf16 v[148:151], v[52:55], v[36:39], v[148:151]
ds_read_b64_tr_b16 v[78:79], v103 offset:25088
v_mfma_f32_16x16x32_bf16 v[152:155], v[48:51], v[40:43], v[152:155]
s_add_u32 m0, s28, 0
s_nop 0
buffer_load_dwordx4 v111, s[16:19], s26 offen lds
s_add_u32 s26, s26, 131072
ds_read_b128 v[56:59], v96 offset:24576
v_mfma_f32_16x16x32_bf16 v[156:159], v[52:55], v[40:43], v[156:159]
ds_read_b128 v[60:63], v96 offset:25600
v_mfma_f32_16x16x32_bf16 v[160:163], v[48:51], v[44:47], v[160:163]
ds_read_b128 v[64:67], v96 offset:26624
v_mfma_f32_16x16x32_bf16 v[164:167], v[52:55], v[44:47], v[164:167]
ds_read_b128 v[68:71], v96 offset:27648
s_waitcnt vmcnt(14) lgkmcnt(0)
s_barrier
v_mfma_f32_16x16x32_bf16 v[136:139], v[72:75], v[56:59], v[136:139]
s_add_u32 m0, s27, 24576
s_nop 0
buffer_load_dwordx4 v110, s[12:15], s25 offen sc1 lds
ds_read_b64_tr_b16 v[48:49], v101 offset:0
v_mfma_f32_16x16x32_bf16 v[140:143], v[76:79], v[56:59], v[140:143]
ds_read_b64_tr_b16 v[50:51], v101 offset:512
v_mfma_f32_16x16x32_bf16 v[144:147], v[72:75], v[60:63], v[144:147]
buffer_load_dwordx4 v110, s[12:15], s25 offen offset:1024 sc1 lds
s_add_u32 s25, s25, 16384
ds_read_b64_tr_b16 v[52:53], v104 offset:0
v_mfma_f32_16x16x32_bf16 v[148:151], v[76:79], v[60:63], v[148:151]
ds_read_b64_tr_b16 v[54:55], v104 offset:512
v_mfma_f32_16x16x32_bf16 v[152:155], v[72:75], v[64:67], v[152:155]
s_add_u32 m0, s28, 24576
s_nop 0
buffer_load_dwordx4 v111, s[16:19], s26 offen lds
s_add_u32 s26, s26, 131072
ds_read_b128 v[32:35], v97 offset:0
v_mfma_f32_16x16x32_bf16 v[156:159], v[76:79], v[64:67], v[156:159]
ds_read_b128 v[36:39], v97 offset:1024
v_mfma_f32_16x16x32_bf16 v[160:163], v[72:75], v[68:71], v[160:163]
ds_read_b128 v[40:43], v97 offset:2048
v_mfma_f32_16x16x32_bf16 v[164:167], v[76:79], v[68:71], v[164:167]
ds_read_b128 v[44:47], v97 offset:3072
s_waitcnt vmcnt(14) lgkmcnt(0)
s_barrier
v_mfma_f32_16x16x32_bf16 v[136:139], v[48:51], v[32:35], v[136:139]
ds_read_b64_tr_b16 v[72:73], v101 offset:24576
v_mfma_f32_16x16x32_bf16 v[140:143], v[52:55], v[32:35], v[140:143]
ds_read_b64_tr_b16 v[74:75], v101 offset:25088
v_mfma_f32_16x16x32_bf16 v[144:147], v[48:51], v[36:39], v[144:147]
ds_read_b64_tr_b16 v[76:77], v104 offset:24576
v_mfma_f32_16x16x32_bf16 v[148:151], v[52:55], v[36:39], v[148:151]
ds_read_b64_tr_b16 v[78:79], v104 offset:25088
v_mfma_f32_16x16x32_bf16 v[152:155], v[48:51], v[40:43], v[152:155]
ds_read_b128 v[56:59], v97 offset:24576
v_mfma_f32_16x16x32_bf16 v[156:159], v[52:55], v[40:43], v[156:159]
ds_read_b128 v[60:63], v97 offset:25600
v_mfma_f32_16x16x32_bf16 v[160:163], v[48:51], v[44:47], v[160:163]
ds_read_b128 v[64:67], v97 offset:26624
v_mfma_f32_16x16x32_bf16 v[164:167], v[52:55], v[44:47], v[164:167]
ds_read_b128 v[68:71], v97 offset:27648
s_waitcnt vmcnt(11) lgkmcnt(0)
s_barrier
v_mfma_f32_16x16x32_bf16 v[136:139], v[72:75], v[56:59], v[136:139]
ds_read_b64_tr_b16 v[48:49], v102 offset:0
v_mfma_f32_16x16x32_bf16 v[140:143], v[76:79], v[56:59], v[140:143]
ds_read_b64_tr_b16 v[50:51], v102 offset:512
v_mfma_f32_16x16x32_bf16 v[144:147], v[72:75], v[60:63], v[144:147]
ds_read_b64_tr_b16 v[52:53], v105 offset:0
v_mfma_f32_16x16x32_bf16 v[148:151], v[76:79], v[60:63], v[148:151]
ds_read_b64_tr_b16 v[54:55], v105 offset:512
v_mfma_f32_16x16x32_bf16 v[152:155], v[72:75], v[64:67], v[152:155]
ds_read_b128 v[32:35], v98 offset:0
v_mfma_f32_16x16x32_bf16 v[156:159], v[76:79], v[64:67], v[156:159]
ds_read_b128 v[36:39], v98 offset:1024
v_mfma_f32_16x16x32_bf16 v[160:163], v[72:75], v[68:71], v[160:163]
ds_read_b128 v[40:43], v98 offset:2048
v_mfma_f32_16x16x32_bf16 v[164:167], v[76:79], v[68:71], v[164:167]
ds_read_b128 v[44:47], v98 offset:3072
s_waitcnt vmcnt(8) lgkmcnt(0)
s_barrier
v_mfma_f32_16x16x32_bf16 v[136:139], v[48:51], v[32:35], v[136:139]
ds_read_b64_tr_b16 v[72:73], v102 offset:24576
v_mfma_f32_16x16x32_bf16 v[140:143], v[52:55], v[32:35], v[140:143]
ds_read_b64_tr_b16 v[74:75], v102 offset:25088
v_mfma_f32_16x16x32_bf16 v[144:147], v[48:51], v[36:39], v[144:147]
ds_read_b64_tr_b16 v[76:77], v105 offset:24576
v_mfma_f32_16x16x32_bf16 v[148:151], v[52:55], v[36:39], v[148:151]
ds_read_b64_tr_b16 v[78:79], v105 offset:25088
v_mfma_f32_16x16x32_bf16 v[152:155], v[48:51], v[40:43], v[152:155]
ds_read_b128 v[56:59], v98 offset:24576
v_mfma_f32_16x16x32_bf16 v[156:159], v[52:55], v[40:43], v[156:159]
ds_read_b128 v[60:63], v98 offset:25600
v_mfma_f32_16x16x32_bf16 v[160:163], v[48:51], v[44:47], v[160:163]
ds_read_b128 v[64:67], v98 offset:26624
v_mfma_f32_16x16x32_bf16 v[164:167], v[52:55], v[44:47], v[164:167]
ds_read_b128 v[68:71], v98 offset:27648
s_waitcnt vmcnt(3) lgkmcnt(0)
s_barrier
v_mfma_f32_16x16x32_bf16 v[136:139], v[72:75], v[56:59], v[136:139]
ds_read_b64_tr_b16 v[48:49], v100 offset:0
v_mfma_f32_16x16x32_bf16 v[140:143], v[76:79], v[56:59], v[140:143]
ds_read_b64_tr_b16 v[50:51], v100 offset:512
v_mfma_f32_16x16x32_bf16 v[144:147], v[72:75], v[60:63], v[144:147]
ds_read_b64_tr_b16 v[52:53], v103 offset:0
v_mfma_f32_16x16x32_bf16 v[148:151], v[76:79], v[60:63], v[148:151]
ds_read_b64_tr_b16 v[54:55], v103 offset:512
v_mfma_f32_16x16x32_bf16 v[152:155], v[72:75], v[64:67], v[152:155]
ds_read_b128 v[32:35], v96 offset:0
v_mfma_f32_16x16x32_bf16 v[156:159], v[76:79], v[64:67], v[156:159]
ds_read_b128 v[36:39], v96 offset:1024
v_mfma_f32_16x16x32_bf16 v[160:163], v[72:75], v[68:71], v[160:163]
ds_read_b128 v[40:43], v96 offset:2048
v_mfma_f32_16x16x32_bf16 v[164:167], v[76:79], v[68:71], v[164:167]
ds_read_b128 v[44:47], v96 offset:3072
s_waitcnt vmcnt(0) lgkmcnt(0)
s_barrier
v_mfma_f32_16x16x32_bf16 v[136:139], v[48:51], v[32:35], v[136:139]
ds_read_b64_tr_b16 v[72:73], v100 offset:24576
v_mfma_f32_16x16x32_bf16 v[140:143], v[52:55], v[32:35], v[140:143]
ds_read_b64_tr_b16 v[74:75], v100 offset:25088
v_mfma_f32_16x16x32_bf16 v[144:147], v[48:51], v[36:39], v[144:147]
ds_read_b64_tr_b16 v[76:77], v103 offset:24576
v_mfma_f32_16x16x32_bf16 v[148:151], v[52:55], v[36:39], v[148:151]
ds_read_b64_tr_b16 v[78:79], v103 offset:25088
v_mfma_f32_16x16x32_bf16 v[152:155], v[48:51], v[40:43], v[152:155]
ds_read_b128 v[56:59], v96 offset:24576
v_mfma_f32_16x16x32_bf16 v[156:159], v[52:55], v[40:43], v[156:159]
ds_read_b128 v[60:63], v96 offset:25600
v_mfma_f32_16x16x32_bf16 v[160:163], v[48:51], v[44:47], v[160:163]
ds_read_b128 v[64:67], v96 offset:26624
v_mfma_f32_16x16x32_bf16 v[164:167], v[52:55], v[44:47], v[164:167]
ds_read_b128 v[68:71], v96 offset:27648
s_waitcnt lgkmcnt(0)
v_mfma_f32_16x16x32_bf16 v[136:139], v[72:75], v[56:59], v[136:139]
v_mfma_f32_16x16x32_bf16 v[140:143], v[76:79], v[56:59], v[140:143]
v_mfma_f32_16x16x32_bf16 v[144:147], v[72:75], v[60:63], v[144:147]
v_mfma_f32_16x16x32_bf16 v[148:151], v[76:79], v[60:63], v[148:151]
v_mfma_f32_16x16x32_bf16 v[152:155], v[72:75], v[64:67], v[152:155]
v_mfma_f32_16x16x32_bf16 v[156:159], v[76:79], v[64:67], v[156:159]
v_mfma_f32_16x16x32_bf16 v[160:163], v[72:75], v[68:71], v[160:163]
v_mfma_f32_16x16x32_bf16 v[164:167], v[76:79], v[68:71], v[164:167]
s_waitcnt vmcnt(0)
s_nop 7
s_barrier
s_lshl_b32 s34, s24, 12
v_add_u32 v3, s34, v110
s_xor_b32 s34, s24, 4
s_lshl_b32 s34, s34, 12
v_add_u32 v4, s34, v110
s_cmp_eq_u32 s35, 0
s_cbranch_scc1 G2_x0
ds_write_b128 v3, v[136:139] offset:0
ds_write_b128 v3, v[140:143] offset:1024
ds_write_b128 v3, v[144:147] offset:2048
ds_write_b128 v3, v[148:151] offset:3072
s_nop 1
v_mov_b32 v136, v152
v_mov_b32 v137, v153
v_mov_b32 v138, v154
v_mov_b32 v139, v155
v_mov_b32 v140, v156
v_mov_b32 v141, v157
v_mov_b32 v142, v158
v_mov_b32 v143, v159
v_mov_b32 v144, v160
v_mov_b32 v145, v161
v_mov_b32 v146, v162
v_mov_b32 v147, v163
v_mov_b32 v148, v164
v_mov_b32 v149, v165
v_mov_b32 v150, v166
v_mov_b32 v151, v167
s_branch G2_x1
G2_x0:
ds_write_b128 v3, v[152:155] offset:0
ds_write_b128 v3, v[156:159] offset:1024
ds_write_b128 v3, v[160:163] offset:2048
ds_write_b128 v3, v[164:167] offset:3072
G2_x1:
s_waitcnt lgkmcnt(0)
s_barrier
ds_read_b128 v[32:35], v4 offset:0
ds_read_b128 v[36:39], v4 offset:1024
ds_read_b128 v[40:43], v4 offset:2048
ds_read_b128 v[44:47], v4 offset:3072
ds_read_b64_tr_b16 v[48:49], v114 offset:0
ds_read_b64_tr_b16 v[50:51], v114 offset:1024
ds_read_b64_tr_b16 v[52:53], v114 offset:32
ds_read_b64_tr_b16 v[54:55], v114 offset:1056
s_waitcnt lgkmcnt(0)
v_add_f32 v136, v136, v32
v_add_f32 v137, v137, v33
v_add_f32 v138, v138, v34
v_add_f32 v139, v139, v35
v_add_f32 v140, v140, v36
v_add_f32 v141, v141, v37
v_add_f32 v142, v142, v38
v_add_f32 v143, v143, v39
v_add_f32 v144, v144, v40
v_add_f32 v145, v145, v41
v_add_f32 v146, v146, v42
v_add_f32 v147, v147, v43
v_add_f32 v148, v148, v44
v_add_f32 v149, v149, v45
v_add_f32 v150, v150, v46
v_add_f32 v151, v151, v47
v_cvt_pk_bf16_f32 v56, v136, v137
v_cvt_pk_bf16_f32 v57, v138, v139
v_cvt_pk_bf16_f32 v58, v140, v141
v_cvt_pk_bf16_f32 v59, v142, v143
s_nop 1
v_permlane16_swap_b32 v56, v58
v_permlane16_swap_b32 v57, v59
v_lshlrev_b32 v62, 16, v116
v_and_b32 v63, 0xffff0000, v116
v_sub_f32 v60, v62, v124
v_sub_f32 v61, v63, v124
v_cvt_pk_bf16_f32 v60, v60, v61
v_and_b32 v61, 0xffff0000, v60
v_lshlrev_b32 v60, 16, v60
v_mul_f32 v60, v60, v125
v_mul_f32 v61, v61, v125
v_cvt_pk_bf16_f32 v60, v60, v61
v_and_b32 v61, 0xffff0000, v60
v_lshlrev_b32 v60, 16, v60
v_lshlrev_b32 v72, 16, v48
v_and_b32 v73, 0xffff0000, v48
v_mul_f32 v60, v60, v72
v_mul_f32 v61, v61, v73
v_cvt_pk_bf16_f32 v60, v60, v61
v_and_b32 v61, 0xffff0000, v60
v_lshlrev_b32 v60, 16, v60
v_add_f32 v60, v60, v62
v_add_f32 v61, v61, v63
v_cvt_pk_bf16_f32 v60, v60, v61
v_and_b32 v61, 0xffff0000, v60
v_lshlrev_b32 v60, 16, v60
v_lshlrev_b32 v62, 16, v56
v_and_b32 v63, 0xffff0000, v56
v_add_f32 v60, v60, v62
v_add_f32 v61, v61, v63
v_cvt_pk_bf16_f32 v64, v60, v61
v_lshlrev_b32 v62, 16, v117
v_and_b32 v63, 0xffff0000, v117
v_sub_f32 v60, v62, v124
v_sub_f32 v61, v63, v124
v_cvt_pk_bf16_f32 v60, v60, v61
v_and_b32 v61, 0xffff0000, v60
v_lshlrev_b32 v60, 16, v60
v_mul_f32 v60, v60, v125
v_mul_f32 v61, v61, v125
v_cvt_pk_bf16_f32 v60, v60, v61
v_and_b32 v61, 0xffff0000, v60
v_lshlrev_b32 v60, 16, v60
v_lshlrev_b32 v72, 16, v49
v_and_b32 v73, 0xffff0000, v49
v_mul_f32 v60, v60, v72
v_mul_f32 v61, v61, v73
v_cvt_pk_bf16_f32 v60, v60, v61
v_and_b32 v61, 0xffff0000, v60
v_lshlrev_b32 v60, 16, v60
v_add_f32 v60, v60, v62
v_add_f32 v61, v61, v63
v_cvt_pk_bf16_f32 v60, v60, v61
v_and_b32 v61, 0xffff0000, v60
v_lshlrev_b32 v60, 16, v60
v_lshlrev_b32 v62, 16, v57
v_and_b32 v63, 0xffff0000, v57
v_add_f32 v60, v60, v62
v_add_f32 v61, v61, v63
v_cvt_pk_bf16_f32 v65, v60, v61
v_lshlrev_b32 v62, 16, v118
v_and_b32 v63, 0xffff0000, v118
v_sub_f32 v60, v62, v124
v_sub_f32 v61, v63, v124
v_cvt_pk_bf16_f32 v60, v60, v61
v_and_b32 v61, 0xffff0000, v60
v_lshlrev_b32 v60, 16, v60
v_mul_f32 v60, v60, v125
v_mul_f32 v61, v61, v125
v_cvt_pk_bf16_f32 v60, v60, v61
v_and_b32 v61, 0xffff0000, v60
v_lshlrev_b32 v60, 16, v60
v_lshlrev_b32 v72, 16, v50
v_and_b32 v73, 0xffff0000, v50
v_mul_f32 v60, v60, v72
v_mul_f32 v61, v61, v73
v_cvt_pk_bf16_f32 v60, v60, v61
v_and_b32 v61, 0xffff0000, v60
v_lshlrev_b32 v60, 16, v60
v_add_f32 v60, v60, v62
v_add_f32 v61, v61, v63
v_cvt_pk_bf16_f32 v60, v60, v61
v_and_b32 v61, 0xffff0000, v60
v_lshlrev_b32 v60, 16, v60
v_lshlrev_b32 v62, 16, v58
v_and_b32 v63, 0xffff0000, v58
v_add_f32 v60, v60, v62
v_add_f32 v61, v61, v63
v_cvt_pk_bf16_f32 v66, v60, v61
v_lshlrev_b32 v62, 16, v119
v_and_b32 v63, 0xffff0000, v119
v_sub_f32 v60, v62, v124
v_sub_f32 v61, v63, v124
v_cvt_pk_bf16_f32 v60, v60, v61
v_and_b32 v61, 0xffff0000, v60
v_lshlrev_b32 v60, 16, v60
v_mul_f32 v60, v60, v125
v_mul_f32 v61, v61, v125
v_cvt_pk_bf16_f32 v60, v60, v61
v_and_b32 v61, 0xffff0000, v60
v_lshlrev_b32 v60, 16, v60
v_lshlrev_b32 v72, 16, v51
v_and_b32 v73, 0xffff0000, v51
v_mul_f32 v60, v60, v72
v_mul_f32 v61, v61, v73
v_cvt_pk_bf16_f32 v60, v60, v61
v_and_b32 v61, 0xffff0000, v60
v_lshlrev_b32 v60, 16, v60
v_add_f32 v60, v60, v62
v_add_f32 v61, v61, v63
v_cvt_pk_bf16_f32 v60, v60, v61
v_and_b32 v61, 0xffff0000, v60
v_lshlrev_b32 v60, 16, v60
v_lshlrev_b32 v62, 16, v59
v_and_b32 v63, 0xffff0000, v59
v_add_f32 v60, v60, v62
v_add_f32 v61, v61, v63
v_cvt_pk_bf16_f32 v67, v60, v61
buffer_store_dwordx4 v[64:67], v112, s[20:23], 0 offen
v_cvt_pk_bf16_f32 v56, v144, v145
v_cvt_pk_bf16_f32 v57, v146, v147
v_cvt_pk_bf16_f32 v58, v148, v149
v_cvt_pk_bf16_f32 v59, v150, v151
s_nop 1
v_permlane16_swap_b32 v56, v58
v_permlane16_swap_b32 v57, v59
v_lshlrev_b32 v62, 16, v120
v_and_b32 v63, 0xffff0000, v120
v_sub_f32 v60, v62, v126
v_sub_f32 v61, v63, v126
v_cvt_pk_bf16_f32 v60, v60, v61
v_and_b32 v61, 0xffff0000, v60
v_lshlrev_b32 v60, 16, v60
v_mul_f32 v60, v60, v127
v_mul_f32 v61, v61, v127
v_cvt_pk_bf16_f32 v60, v60, v61
v_and_b32 v61, 0xffff0000, v60
v_lshlrev_b32 v60, 16, v60
v_lshlrev_b32 v72, 16, v52
v_and_b32 v73, 0xffff0000, v52
v_mul_f32 v60, v60, v72
v_mul_f32 v61, v61, v73
v_cvt_pk_bf16_f32 v60, v60, v61
v_and_b32 v61, 0xffff0000, v60
v_lshlrev_b32 v60, 16, v60
v_add_f32 v60, v60, v62
v_add_f32 v61, v61, v63
v_cvt_pk_bf16_f32 v60, v60, v61
v_and_b32 v61, 0xffff0000, v60
v_lshlrev_b32 v60, 16, v60
v_lshlrev_b32 v62, 16, v56
v_and_b32 v63, 0xffff0000, v56
v_add_f32 v60, v60, v62
v_add_f32 v61, v61, v63
v_cvt_pk_bf16_f32 v68, v60, v61
v_lshlrev_b32 v62, 16, v121
v_and_b32 v63, 0xffff0000, v121
v_sub_f32 v60, v62, v126
v_sub_f32 v61, v63, v126
v_cvt_pk_bf16_f32 v60, v60, v61
v_and_b32 v61, 0xffff0000, v60
v_lshlrev_b32 v60, 16, v60
v_mul_f32 v60, v60, v127
v_mul_f32 v61, v61, v127
v_cvt_pk_bf16_f32 v60, v60, v61
v_and_b32 v61, 0xffff0000, v60
v_lshlrev_b32 v60, 16, v60
v_lshlrev_b32 v72, 16, v53
v_and_b32 v73, 0xffff0000, v53
v_mul_f32 v60, v60, v72
v_mul_f32 v61, v61, v73
v_cvt_pk_bf16_f32 v60, v60, v61
v_and_b32 v61, 0xffff0000, v60
v_lshlrev_b32 v60, 16, v60
v_add_f32 v60, v60, v62
v_add_f32 v61, v61, v63
v_cvt_pk_bf16_f32 v60, v60, v61
v_and_b32 v61, 0xffff0000, v60
v_lshlrev_b32 v60, 16, v60
v_lshlrev_b32 v62, 16, v57
v_and_b32 v63, 0xffff0000, v57
v_add_f32 v60, v60, v62
v_add_f32 v61, v61, v63
v_cvt_pk_bf16_f32 v69, v60, v61
v_lshlrev_b32 v62, 16, v122
v_and_b32 v63, 0xffff0000, v122
v_sub_f32 v60, v62, v126
v_sub_f32 v61, v63, v126
v_cvt_pk_bf16_f32 v60, v60, v61
v_and_b32 v61, 0xffff0000, v60
v_lshlrev_b32 v60, 16, v60
v_mul_f32 v60, v60, v127
v_mul_f32 v61, v61, v127
v_cvt_pk_bf16_f32 v60, v60, v61
v_and_b32 v61, 0xffff0000, v60
v_lshlrev_b32 v60, 16, v60
v_lshlrev_b32 v72, 16, v54
v_and_b32 v73, 0xffff0000, v54
v_mul_f32 v60, v60, v72
v_mul_f32 v61, v61, v73
v_cvt_pk_bf16_f32 v60, v60, v61
v_and_b32 v61, 0xffff0000, v60
v_lshlrev_b32 v60, 16, v60
v_add_f32 v60, v60, v62
v_add_f32 v61, v61, v63
v_cvt_pk_bf16_f32 v60, v60, v61
v_and_b32 v61, 0xffff0000, v60
v_lshlrev_b32 v60, 16, v60
v_lshlrev_b32 v62, 16, v58
v_and_b32 v63, 0xffff0000, v58
v_add_f32 v60, v60, v62
v_add_f32 v61, v61, v63
v_cvt_pk_bf16_f32 v70, v60, v61
v_lshlrev_b32 v62, 16, v123
v_and_b32 v63, 0xffff0000, v123
v_sub_f32 v60, v62, v126
v_sub_f32 v61, v63, v126
v_cvt_pk_bf16_f32 v60, v60, v61
v_and_b32 v61, 0xffff0000, v60
v_lshlrev_b32 v60, 16, v60
v_mul_f32 v60, v60, v127
v_mul_f32 v61, v61, v127
v_cvt_pk_bf16_f32 v60, v60, v61
v_and_b32 v61, 0xffff0000, v60
v_lshlrev_b32 v60, 16, v60
v_lshlrev_b32 v72, 16, v55
v_and_b32 v73, 0xffff0000, v55
v_mul_f32 v60, v60, v72
v_mul_f32 v61, v61, v73
v_cvt_pk_bf16_f32 v60, v60, v61
v_and_b32 v61, 0xffff0000, v60
v_lshlrev_b32 v60, 16, v60
v_add_f32 v60, v60, v62
v_add_f32 v61, v61, v63
v_cvt_pk_bf16_f32 v60, v60, v61
v_and_b32 v61, 0xffff0000, v60
v_lshlrev_b32 v60, 16, v60
v_lshlrev_b32 v62, 16, v59
v_and_b32 v63, 0xffff0000, v59
v_add_f32 v60, v60, v62
v_add_f32 v61, v61, v63
v_cvt_pk_bf16_f32 v71, v60, v61
buffer_store_dwordx4 v[68:71], v113, s[20:23], 0 offen
F_end:
s_endpgm
.section .rodata,"a"
.p2align 6
.amdhsa_kernel parallel_sum__ssm_conv_h3__glu_gated_swiglu__prompt_kernel
.amdhsa_next_free_vgpr 256
.amdhsa_next_free_sgpr 102
.amdhsa_accum_offset 256
.amdhsa_group_segment_fixed_size 0
.amdhsa_kernarg_size 104
.amdhsa_user_sgpr_count 2
.amdhsa_user_sgpr_kernarg_segment_ptr 1
.amdhsa_system_sgpr_workgroup_id_x 1
.end_amdhsa_kernel
```
